```python
import torch

def _softmax(x, axis=-1):
    return torch.softmax(x, dim=axis)
def _gelu(x):
    return torch.nn.functional.gelu(x, approximate="tanh")
def _silu(x):
    return torch.nn.functional.silu(x)
def _sigmoid(x):
    return torch.sigmoid(x)
def _layernorm(x, axis=-1, eps=1e-5):
    m = x.mean(dim=axis, keepdim=True)
    v = x.var(dim=axis, keepdim=True, unbiased=False)
    return (x - m) / torch.sqrt(v + eps)
def _scatter_add(tgt, idx, src, axis=0):
    return tgt.clone().index_add_(axis, idx, src)
def _segment_sum(src, seg, n):
    out = torch.zeros((n,) + src.shape[1:], dtype=src.dtype)
    return out.index_add_(0, seg, src)
def _pad(x, pw):
    flat = tuple(v for pair in reversed(pw) for v in pair)
    return torch.nn.functional.pad(x, flat)

kernel_name = 'interleave_layers__sliding_block__mixer_s_mlp__prompt'

def setup_inputs():

    _w = (lambda a: (lambda t: t.to(torch.bfloat16) if t.is_floating_point() else t)(torch.as_tensor(a)))
    def _A_setup():
        B, S, D = 1, 2048, 512
        return {
            "x": _w((lambda *s: torch.randn(*s, dtype=torch.bfloat16) * 0.05)(B, S, D)),
            "wqkv": _w((lambda *s: torch.randn(*s, dtype=torch.bfloat16) * 0.1)(D, 3 * D)),
            "wo": _w((lambda *s: torch.randn(*s, dtype=torch.bfloat16) * 0.1)(D, D)),
        }
    _A_in = _A_setup()

    def _B_setup():
        B, S, D, F = 1, 2048, 512, 1792
        return {
            "x":  _w((lambda *s: torch.randn(*s, dtype=torch.bfloat16) * 0.05)(B, S, D)),
            "w1": _w((lambda *s: torch.randn(*s, dtype=torch.bfloat16) * 3.2)(D, D) * (D ** -0.5)),
            "w2": _w((lambda *s: torch.randn(*s, dtype=torch.bfloat16) * 3.2)(D, D) * (D ** -0.5)),
            "w3": _w((lambda *s: torch.randn(*s, dtype=torch.bfloat16) * 3.2)(D, F) * (D ** -0.5)),
            "w4": _w((lambda *s: torch.randn(*s, dtype=torch.bfloat16) * 3.2)(F, D) * (F ** -0.5)),
        }
    _B_in = _B_setup()

    return {
        "A_x": _A_in["x"],
        "A_wqkv": _A_in["wqkv"],
        "A_wo": _A_in["wo"],
        "B_x": _B_in["x"],
        "B_w1": _B_in["w1"],
        "B_w2": _B_in["w2"],
        "B_w3": _B_in["w3"],
        "B_w4": _B_in["w4"],
    }

def reference(A_x, A_wqkv, A_wo, B_x, B_w1, B_w2, B_w3, B_w4):
    def _A_ref(x, wqkv, wo):
        B, S, D = x.shape
        H = 32; Dh = D // H; W = 256
        qkv = (lambda x, *d: x.permute(*d))((x @ wqkv).reshape(B, S, 3, H, Dh), 2, 0, 3, 1, 4)
        q, k, v = qkv[0], qkv[1], qkv[2]
        scores = torch.einsum("bhqd,bhkd->bhqk", q, k) * (Dh ** -0.5)
        idx = torch.arange(S)
        mask = (idx[:, None] - idx[None, :] >= 0) & (idx[:, None] - idx[None, :] < W)
        scores = torch.where(mask[None, None], scores, -1e9)
        p = _softmax(scores, axis=-1)
        o = torch.einsum("bhqk,bhkd->bhqd", p, v)
        return (lambda x, *d: x.permute(*d))(o, 0, 2, 1, 3).reshape(B, S, D) @ wo

    def _B_ref(x, w1, w2, w3, w4):
        B, S, D = x.shape
        h = _gelu(_layernorm(x, axis=-1) @ w1)
        c = D // 4
        g0 = _pad(h[:, :, 0*c:1*c], ((0, 0), (1, 0), (0, 0)))[:, :S, :]
        g1 = _pad(h[:, :, 1*c:2*c], ((0, 0), (0, 1), (0, 0)))[:, 1:, :]
        g2 = _pad(h[:, :, 2*c:3*c], ((0, 0), (2, 0), (0, 0)))[:, :S, :]
        g3 = _pad(h[:, :, 3*c:   ], ((0, 0), (0, 2), (0, 0)))[:, 2:, :]
        hs = torch.concatenate([g0, g1, g2, g3], axis=-1) @ w2
        x1 = x + hs
        h2 = _gelu(_layernorm(x1, axis=-1) @ w3) @ w4
        return x1 + h2

    x = A_x
    x = x + _A_ref(_layernorm(x, axis=-1), A_wqkv, A_wo)
    x = x + _B_ref(_layernorm(x, axis=-1), B_w1, B_w2, B_w3, B_w4)
    x = x + _A_ref(_layernorm(x, axis=-1), A_wqkv, A_wo)
    x = x + _B_ref(_layernorm(x, axis=-1), B_w1, B_w2, B_w3, B_w4)
    return x
```

```asm
; @launch grid=(256,1,1) block=(256,1,1) lds=163840
.amdgcn_target "amdgcn-amd-amdhsa--gfx950"
.text
.globl interleave_layers__sliding_block__mixer_s_mlp__prompt_kernel
.p2align 8
.type interleave_layers__sliding_block__mixer_s_mlp__prompt_kernel,@function
interleave_layers__sliding_block__mixer_s_mlp__prompt_kernel:
s_cmp_ge_u32 s2, 256
s_cbranch_scc1 L_end
s_load_dwordx16 s[76:91], s[0:1], 0
s_load_dwordx4 s[92:95], s[0:1], 64
s_load_dwordx2 s[96:97], s[0:1], 80
v_lshrrev_b32 v1, 6, v0
v_and_b32 v0, 63, v0
s_getpc_b64 s[12:13]
L_pc:
s_lshr_b32 s3, s2, 3
s_mov_b32 s15, 0x20000
v_lshl_add_u32 v2, s3, 2, v1
s_and_b32 s13, s13, 0xffff
v_mad_u32_u24 v2, v2, 3, 48
v_lshlrev_b32 v3, 4, v1
v_cmp_gt_u32 vcc, 16, v0
s_mov_b32 s14, L_code_end-L_pc
s_nop 1
v_cndmask_b32 v2, v2, v3, vcc
v_add_lshl_u32 v2, v2, v0, 7
s_mov_b64 exec, 0x7ffff
buffer_load_dword v37, v2, s[12:15], 0 offen
s_mov_b64 exec, -1
v_readfirstlane_b32 s6, v1
s_and_b32 s3, s2, 7
s_lshl_b32 s4, s3, 2
s_lshr_b32 s3, s2, 6
s_add_u32 s4, s4, s3
s_bfe_u32 s5, s2, 0x30003
s_and_b32 s48, s6, 1
s_lshr_b32 s49, s6, 1
s_lshl_b32 s56, s6, 14
s_lshl_b32 s63, s5, 7
s_mul_i32 s57, s6, 393216
s_add_u32 s57, s57, s63
v_lshrrev_b32 v234, 3, v0
v_lshrrev_b32 v235, 2, v0
v_and_b32 v235, 4, v235
v_xor_b32 v235, v0, v235
v_and_b32 v235, 7, v235
v_lshlrev_b32 v235, 4, v235
v_mul_u32_u24 v15, 3072, v234
v_add_u32 v15, v15, v235
v_add_u32 v16, 23552, v15
v_add_u32 v17, 47104, v15
v_add_u32 v18, 70656, v15
v_xor_b32 v192, v0, v234
v_and_b32 v192, 7, v192
v_lshlrev_b32 v192, 4, v192
v_lshl_add_u32 v192, v234, 10, v192
v_xor_b32 v193, 0x2010, v192
v_mul_u32_u24 v194, 3072, v234
v_and_b32 v195, 7, v0
v_lshl_add_u32 v194, v195, 7, v194
s_lshl2_add_u32 s99, s2, s6
v_lshlrev_b32 v244, 7, v0
s_mul_i32 s66, s99, 1536
s_lshl_b32 s50, s4, 16
s_add_u32 s51, s50, 31457280
s_lshl_b32 s63, s5, 2
s_add_u32 s63, s63, s6
s_lshl_b32 s63, s63, 2
s_lshl3_add_u32 s67, s6, s5
s_lshl2_add_u32 s67, s67, s51
s_lshl_b32 s63, s63, 5
s_add_u32 s75, s51, s63
s_add_u32 s75, s75, 4096
v_and_b32 v232, 31, v0
v_lshrrev_b32 v233, 5, v0
v_lshlrev_b32 v28, 2, v232
v_mov_b32 v236, 0
v_mov_b32 v237, 0
v_mov_b32 v238, 0
v_mov_b32 v239, 0
v_lshlrev_b32 v1, 4, v0
s_lshl_b32 s64, s6, 10
s_add_u32 s64, s64, s51
v_mov_b32 v39, 0
s_lshl_b32 s98, s4, 16
s_add_u32 s98, s98, s56
s_waitcnt lgkmcnt(0)
s_mov_b32 s8, s78
s_and_b32 s9, s79, 0xffff
s_mov_b32 s10, 1572864
s_mov_b32 s11, 0x20000
s_mov_b64 exec, 0xfff
buffer_load_dword v37, v244, s[8:11], s66 offen
s_mov_b64 exec, -1
s_mov_b32 s36, s76
s_and_b32 s37, s77, 0xffff
s_mov_b32 s38, 2097152
s_mov_b32 s39, 0x20000
s_lshl2_add_u32 s66, s5, s6
s_lshl_b32 s66, s66, 11
s_lshl_b32 s65, s4, 16
s_add_u32 s66, s66, s65
s_mov_b64 exec, 0xffff
buffer_load_dword v37, v244, s[36:39], s66 offen nt
s_mov_b64 exec, -1
s_mov_b32 s32, s96
s_and_b32 s33, s97, 0xffff
s_mov_b32 s34, 268435456
s_mov_b32 s35, 0x20000
s_lshr_b32 s97, s2, 3
s_lshl2_add_u32 s97, s97, s6
s_lshl_b32 s97, s97, 10
s_mov_b32 s44, s94
s_and_b32 s45, s95, 0xffff
s_mov_b32 s46, 256
s_mov_b32 s47, 0x20000
s_cmp_eq_u32 s5, 0
s_cbranch_scc0 L_nz
s_add_u32 s65, s64, 4096
buffer_store_dwordx4 v[236:239], v1, s[32:35], s64 offen sc1
buffer_store_dwordx4 v[236:239], v1, s[32:35], s65 offen sc1
s_add_u32 s65, s50, s56
v_lshlrev_b32 v240, 10, v234
s_add_u32 s65, s65, 16777216
v_lshl_add_u32 v240, v195, 4, v240
s_add_u32 s64, s65, 8192
buffer_store_dwordx4 v[236:239], v240, s[32:35], s64 offen sc1
buffer_store_dwordx4 v[236:239], v240, s[32:35], s65 offen sc1
buffer_load_dword v37, v244, s[44:47], 0 offen sc1
L_nz:
s_add_u32 m0, s56, 0
s_nop 0
buffer_load_dwordx4 v192, s[36:39], s98 offen offset:0 lds
s_add_u32 m0, s56, 896
s_nop 0
buffer_load_dwordx4 v192, s[36:39], s98 offen offset:128 lds
s_add_u32 m0, s56, 1792
s_nop 0
buffer_load_dwordx4 v192, s[36:39], s98 offen offset:256 lds
s_add_u32 m0, s56, 2688
s_nop 0
buffer_load_dwordx4 v192, s[36:39], s98 offen offset:384 lds
s_add_u32 m0, s56, 3584
s_nop 0
buffer_load_dwordx4 v192, s[36:39], s98 offen offset:512 lds
s_mov_b32 s12, s80
s_and_b32 s13, s81, 0xffff
s_mov_b32 s14, 524288
s_mov_b32 s15, 0x20000
s_mov_b32 s16, s84
s_and_b32 s17, s85, 0xffff
s_mov_b32 s18, 524288
s_mov_b32 s19, 0x20000
s_mov_b32 s20, s86
s_and_b32 s21, s87, 0xffff
s_mov_b32 s22, 524288
s_mov_b32 s23, 0x20000
s_mov_b32 s24, s88
s_and_b32 s25, s89, 0xffff
s_mov_b32 s26, 1835008
s_add_u32 m0, s56, 4480
s_nop 0
buffer_load_dwordx4 v192, s[36:39], s98 offen offset:640 lds
s_mov_b32 s27, 0x20000
s_mov_b32 s28, s90
s_and_b32 s29, s91, 0xffff
s_mov_b32 s30, 1835008
s_mov_b32 s31, 0x20000
s_mov_b32 s40, s92
s_and_b32 s41, s93, 0xffff
s_mov_b32 s42, 2097152
s_mov_b32 s43, 0x20000
s_mov_b32 s96, s50
s_mov_b32 s7, 0
s_mov_b32 s52, 0
s_mov_b32 s72, 0
s_mov_b32 s53, 100000
s_add_u32 m0, s56, 5376
s_nop 0
buffer_load_dwordx4 v192, s[36:39], s98 offen offset:768 lds
s_lshl_b32 s3, s5, 1
s_add_u32 s3, s3, s49
s_lshl_b32 s55, s3, 11
s_lshl_b32 s63, s48, 10
s_add_u32 s71, s55, s63
s_lshl_b32 s63, s48, 15
s_add_u32 s55, s55, s63
s_lshr_b32 s64, s3, 3
s_lshl_b32 s64, s64, 14
s_and_b32 s65, s3, 7
s_lshl_b32 s65, s65, 10
s_add_u32 s70, s64, s65
s_add_u32 s70, s70, s63
s_lshr_b32 s64, s3, 2
s_add_u32 m0, s56, 6272
s_nop 0
buffer_load_dwordx4 v192, s[36:39], s98 offen offset:896 lds
s_lshl_b32 s64, s64, 10
s_and_b32 s65, s3, 3
s_lshl_b32 s65, s65, 2
s_add_u32 s68, s64, s65
s_lshl_b32 s63, s48, 12
s_add_u32 s68, s68, s63
s_lshl_b32 s63, s5, 7
s_lshl_b32 s58, s6, 17
s_add_u32 s58, s58, s63
s_mul_i32 s60, s6, 393216
s_add_u32 s60, s60, s63
s_mul_i32 s59, s6, 458752
s_mul_i32 s64, s5, 384
s_add_u32 s59, s59, s64
s_add_u32 m0, s56, 8192
s_nop 0
buffer_load_dwordx4 v193, s[36:39], s98 offen offset:0 lds
s_lshl_b32 s64, s6, 16
s_add_u32 s64, s64, s63
s_add_u32 s61, s64, 1572864
s_mul_i32 s65, s6, 458752
s_lshl_b32 s66, s5, 6
s_add_u32 s65, s65, s66
s_add_u32 s73, s65, 3072
s_lshl_b32 s64, s49, 15
s_lshl_b32 s65, s48, 13
s_add_u32 s74, s64, s65
v_mul_u32_u24 v11, 1024, v234
v_add_u32 v11, v11, v235
v_add_u32 v12, 7168, v11
v_add_u32 v13, 14336, v11
s_add_u32 m0, s56, 9088
s_nop 0
buffer_load_dwordx4 v193, s[36:39], s98 offen offset:128 lds
v_add_u32 v14, 21504, v11
v_mul_u32_u24 v19, 3584, v234
v_add_u32 v19, v19, v235
v_add_u32 v20, 27648, v19
v_add_u32 v21, 55296, v19
v_add_u32 v22, 82944, v19
s_lshl_b32 s63, s4, 16
s_lshl_b32 s64, s48, 15
s_add_u32 s63, s63, s64
s_lshl_b32 s64, s3, 6
s_add_u32 s69, s63, s64
v_mov_b32 v237, 1073741824
v_cmp_eq_u32 vcc, 0, v0
s_nop 1
v_cndmask_b32 v27, v237, 0, vcc
v_mov_b32 v239, 0
s_add_u32 m0, s56, 9984
s_nop 0
buffer_load_dwordx4 v193, s[36:39], s98 offen offset:256 lds
s_lshl_b32 s63, s6, 9
s_add_u32 s63, s63, 147456
v_lshl_add_u32 v240, v0, 3, s63
ds_write_b64 v240, v[238:239]
s_lshl_b32 s63, s48, 15
s_lshl_b32 s64, s49, 14
s_add_u32 s63, s63, s64
v_add_u32 v2, s63, v1
v_add_u32 v3, 4096, v2
v_add_u32 v4, 8192, v2
v_add_u32 v5, 12288, v2
v_bfe_u32 v238, v0, 2, 2
v_lshl_add_u32 v238, v233, 2, v238
v_bfe_u32 v239, v0, 4, 1
s_add_u32 m0, s56, 10880
s_nop 0
buffer_load_dwordx4 v193, s[36:39], s98 offen offset:384 lds
v_and_b32 v240, 3, v0
v_lshlrev_b32 v240, 3, v240
v_lshl_add_u32 v241, v239, 5, v240
v_bfe_u32 v242, v0, 3, 1
v_xor_b32 v242, s49, v242
v_lshl_add_u32 v242, v242, 6, v241
v_lshl_add_u32 v242, v238, 7, v242
s_lshl_b32 s63, s49, 15
v_add_u32 v6, s63, v242
v_xor_b32 v7, 64, v6
v_add_u32 v8, 65536, v6
v_add_u32 v9, 65536, v7
s_lshl_b32 s64, s49, 5
v_xor_b32 v241, s64, v241
s_add_u32 m0, s56, 11776
s_nop 0
buffer_load_dwordx4 v193, s[36:39], s98 offen offset:512 lds
v_lshl_add_u32 v241, v238, 6, v241
s_add_u32 s63, s63, 81920
v_add_u32 v10, s63, v241
s_lshl_b32 s63, s6, 12
s_add_u32 s63, s63, 131072
v_add_u32 v23, s63, v1
v_xor_b32 v24, 0x2000, v23
s_lshl_b32 s63, s49, 7
s_add_u32 s63, s63, 147456
v_lshl_add_u32 v25, v233, 4, s63
s_lshl_b32 s64, s48, 7
s_xor_b32 s63, s63, s64
v_lshl_add_u32 v26, v232, 2, s63
v_lshrrev_b32 v238, 2, v0
s_add_u32 m0, s56, 12672
s_nop 0
buffer_load_dwordx4 v193, s[36:39], s98 offen offset:640 lds
v_min_u32 v238, 4, v238
s_sub_u32 s63, s4, 4
v_add_u32 v238, s63, v238
v_max_i32 v238, 0, v238
v_lshlrev_b32 v238, 16, v238
v_and_b32 v239, 3, v0
v_lshl_add_u32 v238, v239, 7, v238
s_lshl_b32 s63, s5, 9
s_add_u32 s63, s63, 31461376
v_add_u32 v29, s63, v238
s_lshl_b32 s63, s48, 1
s_add_u32 s63, s63, s4
s_sub_u32 s63, s63, 1
s_cmp_lt_u32 s63, 32
s_cselect_b32 s64, s63, s4
s_cselect_b32 s65, 0, 1073741824
s_add_u32 m0, s56, 13568
s_nop 0
buffer_load_dwordx4 v193, s[36:39], s98 offen offset:768 lds
s_lshl_b32 s64, s64, 16
s_mul_i32 s66, s48, 896
s_lshl_b32 s63, s49, 11
s_add_u32 s66, s66, s63
s_add_u32 s66, s66, s64
s_add_u32 s66, s66, 31461504
v_add_u32 v238, s51, v28
v_lshl_add_u32 v239, v239, 8, s66
v_cmp_gt_u32 vcc, 32, v0
s_nop 1
v_cndmask_b32 v30, v239, v238, vcc
s_add_u32 s64, s64, 16777216
s_or_b32 s64, s64, s65
s_add_u32 s65, s50, 6291456
s_lshl_b32 s66, s48, 5
s_add_u32 m0, s56, 14464
s_nop 0
buffer_load_dwordx4 v193, s[36:39], s98 offen offset:896 lds
v_lshl_add_u32 v241, v233, 5, s64
v_lshl_add_u32 v242, v233, 9, s65
s_sub_u32 s63, s66, s49
s_sub_u32 s63, s63, 1
v_add_u32 v238, s63, v232
v_cmp_gt_u32 vcc, 64, v238
s_nop 1
v_cndmask_b32 v239, v241, v242, vcc
v_cndmask_b32 v243, 1, 31, vcc
v_bfe_u32 v240, v238, 5, 1
v_lshl_add_u32 v239, v240, 15, v239
v_and_b32 v240, v243, v238
v_lshl_add_u32 v239, v240, 4, v239
s_lshl_b32 s63, s49, 14
s_add_u32 s63, s63, 0
v_add_u32 v31, s63, v239
s_mul_i32 s62, s97, 12
s_mov_b32 exec_hi, 0
buffer_load_dword v37, v194, s[8:11], s62 offen offset:1024
s_mov_b32 exec_hi, -1
s_add_u32 s63, s66, s49
s_add_u32 s63, s63, 1
v_add_u32 v238, s63, v232
v_cmp_gt_u32 vcc, 64, v238
s_nop 1
v_cndmask_b32 v239, v241, v242, vcc
v_cndmask_b32 v243, 1, 31, vcc
v_bfe_u32 v240, v238, 5, 1
v_lshl_add_u32 v239, v240, 15, v239
v_and_b32 v240, v243, v238
v_lshl_add_u32 v239, v240, 4, v239
s_lshl_b32 s63, s49, 14
s_add_u32 s63, s63, 8192
v_add_u32 v32, s63, v239
s_cmp_eq_u32 s48, 0
s_cselect_b64 vcc, -1, 0
s_add_u32 m0, s56, 65536
s_add_u32 s62, s57, 1024
buffer_load_dwordx4 v15, s[8:11], s62 offen offset:0 lds
v_mov_b32 v238, v31
v_cndmask_b32 v31, v31, v32, vcc
v_cndmask_b32 v32, v32, v238, vcc
s_mul_i32 s63, s48, 30
v_subrev_u32 v238, s63, v232
v_cmp_gt_u32 vcc, 2, v238
v_lshl_add_u32 v238, v233, 1, v238
v_lshlrev_b32 v238, 4, v238
v_cndmask_b32 v38, v237, v238, vcc
v_and_b32 v33, 0x2f0, v1
s_mul_i32 s63, s48, 768
s_sub_u32 s63, 2097152, s63
v_add_u32 v33, s63, v33
v_lshrrev_b32 v234, 3, v232
buffer_load_dwordx4 v16, s[8:11], s62 offen offset:1024 lds
v_xor_b32 v235, v234, v233
v_and_b32 v235, 1, v235
v_and_b32 v242, 7, v0
v_xor_b32 v235, v235, v242
v_lshlrev_b32 v235, 4, v235
v_lshl_add_u32 v235, v242, 7, v235
v_lshl_add_u32 v235, v234, 13, v235
s_lshl_b32 s63, s48, 15
s_lshl_b32 s64, s49, 12
s_add_u32 s64, s64, s63
s_lshl_b32 s65, s5, 10
s_add_u32 s65, s65, s63
s_lshl_b32 s66, s49, 6
s_add_u32 s65, s65, s66
buffer_load_dwordx4 v17, s[8:11], s62 offen offset:2048 lds
v_add_u32 v236, s64, v235
v_xor_b32 v237, 32, v236
v_xor_b32 v238, 64, v236
v_xor_b32 v239, 96, v236
v_xor_b32 v240, s65, v235
v_xor_b32 v241, 32, v240
s_lshl_b32 s63, s6, 8
s_add_u32 s63, s63, 150528
v_lshl_add_u32 v242, v0, 2, s63
v_xor_b32 v243, 0x200, v242
v_mov_b32 v232, 0
v_mov_b32 v233, 0
v_mov_b32 v234, 0
v_mov_b32 v235, 0
buffer_load_dwordx4 v18, s[8:11], s62 offen offset:3072 lds
v_lshrrev_b32 v168, 2, v0
v_lshrrev_b32 v169, 4, v0
v_xor_b32 v168, v168, v169
v_and_b32 v168, 1, v168
v_add_u32 v168, -1, v168
v_and_b32 v168, 0x3f803f80, v168
v_mov_b32 v169, v168
v_mov_b32 v170, v168
v_mov_b32 v171, v168
s_getreg_b32 s3, hwreg(HW_REG_XCC_ID, 0, 4)
s_lshl_b32 s63, s4, 3
s_cmp_eq_u32 s51, s67
s_cselect_b32 s63, s63, 256
v_mov_b32 v247, 1
v_add_u32 v246, s63, v27
s_waitcnt vmcnt(5)
s_barrier
ds_read_b128 v[72:75], v236 offset:0
ds_read_b128 v[76:79], v237 offset:0
ds_read_b128 v[80:83], v238 offset:0
ds_read_b128 v[84:87], v239 offset:0
ds_read_b128 v[88:91], v236 offset:1024
ds_read_b128 v[92:95], v237 offset:1024
ds_read_b128 v[96:99], v238 offset:1024
ds_read_b128 v[100:103], v239 offset:1024
ds_read_b128 v[104:107], v236 offset:2048
ds_read_b128 v[108:111], v237 offset:2048
ds_read_b128 v[112:115], v238 offset:2048
ds_read_b128 v[116:119], v239 offset:2048
ds_read_b128 v[120:123], v236 offset:3072
ds_read_b128 v[124:127], v237 offset:3072
ds_read_b128 v[128:131], v238 offset:3072
ds_read_b128 v[132:135], v239 offset:3072
ds_read_b128 v[248:251], v240
ds_read_b128 v[252:255], v241
buffer_store_dword v247, v246, s[44:47], 0 offen sc1
s_mov_b32 s98, 0x3f803f80
s_waitcnt lgkmcnt(0)
s_barrier
s_lshl_b32 s63, s99, 9
s_load_dwordx2 s[0:1], s[12:13], s63 offset:60
s_load_dwordx2 s[0:1], s[12:13], s63 offset:188
s_load_dwordx2 s[0:1], s[12:13], s63 offset:316
s_load_dwordx2 s[0:1], s[12:13], s63 offset:444
s_mul_i32 s62, s97, 12
s_mov_b32 exec_hi, 0
buffer_load_dword v37, v194, s[8:11], s62 offen offset:2048
s_mov_b32 exec_hi, -1
v_dot2c_f32_bf16 v232, s98, v72
v_dot2c_f32_bf16 v234, v72, v72
v_dot2c_f32_bf16 v233, s98, v73
v_dot2c_f32_bf16 v235, v73, v73
v_dot2c_f32_bf16 v232, s98, v74
v_dot2c_f32_bf16 v234, v74, v74
v_dot2c_f32_bf16 v233, s98, v75
v_dot2c_f32_bf16 v235, v75, v75
v_permlane32_swap_b32 v72, v74
v_permlane32_swap_b32 v73, v75
v_dot2c_f32_bf16 v232, s98, v76
s_add_u32 m0, s56, 69632
s_add_u32 s62, s57, 99328
buffer_load_dwordx4 v15, s[8:11], s62 offen offset:0 lds
v_dot2c_f32_bf16 v234, v76, v76
v_dot2c_f32_bf16 v233, s98, v77
v_dot2c_f32_bf16 v235, v77, v77
v_dot2c_f32_bf16 v232, s98, v78
v_dot2c_f32_bf16 v234, v78, v78
v_dot2c_f32_bf16 v233, s98, v79
v_dot2c_f32_bf16 v235, v79, v79
v_permlane32_swap_b32 v76, v78
v_permlane32_swap_b32 v77, v79
v_dot2c_f32_bf16 v232, s98, v80
v_dot2c_f32_bf16 v234, v80, v80
buffer_load_dwordx4 v16, s[8:11], s62 offen offset:1024 lds
v_dot2c_f32_bf16 v233, s98, v81
v_dot2c_f32_bf16 v235, v81, v81
v_dot2c_f32_bf16 v232, s98, v82
v_dot2c_f32_bf16 v234, v82, v82
v_dot2c_f32_bf16 v233, s98, v83
v_dot2c_f32_bf16 v235, v83, v83
v_permlane32_swap_b32 v80, v82
v_permlane32_swap_b32 v81, v83
v_dot2c_f32_bf16 v232, s98, v84
v_dot2c_f32_bf16 v234, v84, v84
v_dot2c_f32_bf16 v233, s98, v85
buffer_load_dwordx4 v17, s[8:11], s62 offen offset:2048 lds
v_dot2c_f32_bf16 v235, v85, v85
v_dot2c_f32_bf16 v232, s98, v86
v_dot2c_f32_bf16 v234, v86, v86
v_dot2c_f32_bf16 v233, s98, v87
v_dot2c_f32_bf16 v235, v87, v87
v_permlane32_swap_b32 v84, v86
v_permlane32_swap_b32 v85, v87
v_dot2c_f32_bf16 v232, s98, v88
v_dot2c_f32_bf16 v234, v88, v88
v_dot2c_f32_bf16 v233, s98, v89
v_dot2c_f32_bf16 v235, v89, v89
buffer_load_dwordx4 v18, s[8:11], s62 offen offset:3072 lds
v_dot2c_f32_bf16 v232, s98, v90
v_dot2c_f32_bf16 v234, v90, v90
v_dot2c_f32_bf16 v233, s98, v91
v_dot2c_f32_bf16 v235, v91, v91
v_permlane32_swap_b32 v88, v90
v_permlane32_swap_b32 v89, v91
v_dot2c_f32_bf16 v232, s98, v92
v_dot2c_f32_bf16 v234, v92, v92
v_dot2c_f32_bf16 v233, s98, v93
v_dot2c_f32_bf16 v235, v93, v93
v_dot2c_f32_bf16 v232, s98, v94
s_add_u32 m0, s56, 73728
s_add_u32 s62, s57, 197632
buffer_load_dwordx4 v15, s[8:11], s62 offen offset:0 lds
v_dot2c_f32_bf16 v234, v94, v94
v_dot2c_f32_bf16 v233, s98, v95
v_dot2c_f32_bf16 v235, v95, v95
v_permlane32_swap_b32 v92, v94
v_permlane32_swap_b32 v93, v95
v_dot2c_f32_bf16 v232, s98, v96
v_dot2c_f32_bf16 v234, v96, v96
v_dot2c_f32_bf16 v233, s98, v97
v_dot2c_f32_bf16 v235, v97, v97
v_dot2c_f32_bf16 v232, s98, v98
v_dot2c_f32_bf16 v234, v98, v98
buffer_load_dwordx4 v16, s[8:11], s62 offen offset:1024 lds
v_dot2c_f32_bf16 v233, s98, v99
v_dot2c_f32_bf16 v235, v99, v99
v_permlane32_swap_b32 v96, v98
v_permlane32_swap_b32 v97, v99
v_dot2c_f32_bf16 v232, s98, v100
v_dot2c_f32_bf16 v234, v100, v100
v_dot2c_f32_bf16 v233, s98, v101
v_dot2c_f32_bf16 v235, v101, v101
v_dot2c_f32_bf16 v232, s98, v102
v_dot2c_f32_bf16 v234, v102, v102
v_dot2c_f32_bf16 v233, s98, v103
buffer_load_dwordx4 v17, s[8:11], s62 offen offset:2048 lds
v_dot2c_f32_bf16 v235, v103, v103
v_permlane32_swap_b32 v100, v102
v_permlane32_swap_b32 v101, v103
v_dot2c_f32_bf16 v232, s98, v104
v_dot2c_f32_bf16 v234, v104, v104
v_dot2c_f32_bf16 v233, s98, v105
v_dot2c_f32_bf16 v235, v105, v105
v_dot2c_f32_bf16 v232, s98, v106
v_dot2c_f32_bf16 v234, v106, v106
v_dot2c_f32_bf16 v233, s98, v107
v_dot2c_f32_bf16 v235, v107, v107
buffer_load_dwordx4 v18, s[8:11], s62 offen offset:3072 lds
v_permlane32_swap_b32 v104, v106
v_permlane32_swap_b32 v105, v107
v_dot2c_f32_bf16 v232, s98, v108
v_dot2c_f32_bf16 v234, v108, v108
v_dot2c_f32_bf16 v233, s98, v109
v_dot2c_f32_bf16 v235, v109, v109
v_dot2c_f32_bf16 v232, s98, v110
v_dot2c_f32_bf16 v234, v110, v110
v_dot2c_f32_bf16 v233, s98, v111
v_dot2c_f32_bf16 v235, v111, v111
s_add_u32 m0, s56, 77824
s_add_u32 s62, s57, 295936
buffer_load_dwordx4 v15, s[8:11], s62 offen offset:0 lds
v_permlane32_swap_b32 v108, v110
v_permlane32_swap_b32 v109, v111
v_dot2c_f32_bf16 v232, s98, v112
v_dot2c_f32_bf16 v234, v112, v112
v_dot2c_f32_bf16 v233, s98, v113
v_dot2c_f32_bf16 v235, v113, v113
v_dot2c_f32_bf16 v232, s98, v114
v_dot2c_f32_bf16 v234, v114, v114
v_dot2c_f32_bf16 v233, s98, v115
v_dot2c_f32_bf16 v235, v115, v115
v_permlane32_swap_b32 v112, v114
buffer_load_dwordx4 v16, s[8:11], s62 offen offset:1024 lds
v_permlane32_swap_b32 v113, v115
v_dot2c_f32_bf16 v232, s98, v116
v_dot2c_f32_bf16 v234, v116, v116
v_dot2c_f32_bf16 v233, s98, v117
v_dot2c_f32_bf16 v235, v117, v117
v_dot2c_f32_bf16 v232, s98, v118
v_dot2c_f32_bf16 v234, v118, v118
v_dot2c_f32_bf16 v233, s98, v119
v_dot2c_f32_bf16 v235, v119, v119
v_permlane32_swap_b32 v116, v118
v_permlane32_swap_b32 v117, v119
buffer_load_dwordx4 v17, s[8:11], s62 offen offset:2048 lds
v_dot2c_f32_bf16 v232, s98, v120
v_dot2c_f32_bf16 v234, v120, v120
v_dot2c_f32_bf16 v233, s98, v121
v_dot2c_f32_bf16 v235, v121, v121
v_dot2c_f32_bf16 v232, s98, v122
v_dot2c_f32_bf16 v234, v122, v122
v_dot2c_f32_bf16 v233, s98, v123
v_dot2c_f32_bf16 v235, v123, v123
v_permlane32_swap_b32 v120, v122
v_permlane32_swap_b32 v121, v123
v_dot2c_f32_bf16 v232, s98, v124
buffer_load_dwordx4 v18, s[8:11], s62 offen offset:3072 lds
v_dot2c_f32_bf16 v234, v124, v124
v_dot2c_f32_bf16 v233, s98, v125
v_dot2c_f32_bf16 v235, v125, v125
v_dot2c_f32_bf16 v232, s98, v126
v_dot2c_f32_bf16 v234, v126, v126
v_dot2c_f32_bf16 v233, s98, v127
v_dot2c_f32_bf16 v235, v127, v127
v_permlane32_swap_b32 v124, v126
v_permlane32_swap_b32 v125, v127
v_dot2c_f32_bf16 v232, s98, v128
v_dot2c_f32_bf16 v234, v128, v128
s_add_u32 m0, s56, 0
s_add_u32 s62, s57, 2048
buffer_load_dwordx4 v15, s[8:11], s62 offen offset:0 lds
v_dot2c_f32_bf16 v233, s98, v129
v_dot2c_f32_bf16 v235, v129, v129
v_dot2c_f32_bf16 v232, s98, v130
v_dot2c_f32_bf16 v234, v130, v130
v_dot2c_f32_bf16 v233, s98, v131
v_dot2c_f32_bf16 v235, v131, v131
v_permlane32_swap_b32 v128, v130
v_permlane32_swap_b32 v129, v131
v_dot2c_f32_bf16 v232, s98, v132
v_dot2c_f32_bf16 v234, v132, v132
v_dot2c_f32_bf16 v233, s98, v133
buffer_load_dwordx4 v16, s[8:11], s62 offen offset:1024 lds
v_dot2c_f32_bf16 v235, v133, v133
v_dot2c_f32_bf16 v232, s98, v134
v_dot2c_f32_bf16 v234, v134, v134
v_dot2c_f32_bf16 v233, s98, v135
v_dot2c_f32_bf16 v235, v135, v135
v_permlane32_swap_b32 v132, v134
v_permlane32_swap_b32 v133, v135
v_permlane32_swap_b32 v248, v250
v_permlane32_swap_b32 v249, v251
v_permlane32_swap_b32 v252, v254
v_permlane32_swap_b32 v253, v255
buffer_load_dwordx4 v17, s[8:11], s62 offen offset:2048 lds
v_add_f32 v232, v232, v233
v_add_f32 v234, v234, v235
v_lshlrev_b32 v40, 16, v248
v_and_b32 v41, 0xffff0000, v248
v_lshlrev_b32 v42, 16, v249
v_and_b32 v43, 0xffff0000, v249
v_lshlrev_b32 v44, 16, v250
v_and_b32 v45, 0xffff0000, v250
v_lshlrev_b32 v46, 16, v251
v_and_b32 v47, 0xffff0000, v251
v_lshlrev_b32 v48, 16, v252
buffer_load_dwordx4 v18, s[8:11], s62 offen offset:3072 lds
v_and_b32 v49, 0xffff0000, v252
v_lshlrev_b32 v50, 16, v253
v_and_b32 v51, 0xffff0000, v253
v_lshlrev_b32 v52, 16, v254
v_and_b32 v53, 0xffff0000, v254
v_lshlrev_b32 v54, 16, v255
v_and_b32 v55, 0xffff0000, v255
v_permlane32_swap_b32 v232, v234
v_add_f32 v232, v232, v234
ds_write_b32 v242, v232
s_waitcnt vmcnt(4)
s_waitcnt lgkmcnt(0)
s_barrier
ds_read_b64_tr_b16 a[4:5], v9 offset:0
ds_read_b64_tr_b16 a[6:7], v9 offset:1024
ds_read_b64_tr_b16 a[0:1], v8 offset:0
ds_read_b64_tr_b16 a[2:3], v8 offset:1024
ds_read_b64_tr_b16 a[12:13], v9 offset:2048
ds_read_b64_tr_b16 a[14:15], v9 offset:3072
ds_read_b64_tr_b16 a[8:9], v8 offset:2048
ds_read_b64_tr_b16 a[10:11], v8 offset:3072
ds_read_b32 v233, v243
s_waitcnt lgkmcnt(7)
v_mfma_f32_32x32x16_bf16 v[152:167], a[4:7], v[72:75], 0
ds_read_b64_tr_b16 a[20:21], v9 offset:4096
ds_read_b64_tr_b16 a[22:23], v9 offset:5120
ds_read_b64_tr_b16 a[16:17], v8 offset:4096
ds_read_b64_tr_b16 a[18:19], v8 offset:5120
s_add_u32 m0, s56, 4096
s_add_u32 s62, s57, 100352
buffer_load_dwordx4 v15, s[8:11], s62 offen offset:0 lds
s_waitcnt lgkmcnt(9)
v_mfma_f32_32x32x16_bf16 v[136:151], a[0:3], v[72:75], 0
ds_read_b64_tr_b16 a[28:29], v9 offset:6144
ds_read_b64_tr_b16 a[30:31], v9 offset:7168
ds_read_b64_tr_b16 a[24:25], v8 offset:6144
ds_read_b64_tr_b16 a[26:27], v8 offset:7168
buffer_load_dwordx4 v16, s[8:11], s62 offen offset:1024 lds
s_waitcnt lgkmcnt(11)
v_mfma_f32_32x32x16_bf16 v[152:167], a[12:15], v[76:79], v[152:167]
ds_read_b64_tr_b16 a[36:37], v9 offset:8192
ds_read_b64_tr_b16 a[38:39], v9 offset:9216
ds_read_b64_tr_b16 a[32:33], v8 offset:8192
ds_read_b64_tr_b16 a[34:35], v8 offset:9216
s_waitcnt lgkmcnt(12)
v_add_f32 v232, v232, v233
v_mul_f32 v232, 0x3b000000, v232
v_mfma_f32_32x32x16_bf16 v[136:151], a[8:11], v[76:79], v[136:151]
ds_read_b64_tr_b16 a[44:45], v9 offset:10240
ds_read_b64_tr_b16 a[46:47], v9 offset:11264
ds_read_b64_tr_b16 a[40:41], v8 offset:10240
ds_read_b64_tr_b16 a[42:43], v8 offset:11264
buffer_load_dwordx4 v17, s[8:11], s62 offen offset:2048 lds
v_mov_b32 v233, v232
s_waitcnt lgkmcnt(14)
v_mfma_f32_32x32x16_bf16 v[152:167], a[20:23], v[80:83], v[152:167]
ds_read_b64_tr_b16 a[52:53], v9 offset:12288
ds_read_b64_tr_b16 a[54:55], v9 offset:13312
ds_read_b64_tr_b16 a[48:49], v8 offset:12288
ds_read_b64_tr_b16 a[50:51], v8 offset:13312
v_permlane32_swap_b32 v232, v233
s_waitcnt lgkmcnt(15)
v_mfma_f32_32x32x16_bf16 v[136:151], a[16:19], v[80:83], v[136:151]
ds_read_b64_tr_b16 a[60:61], v9 offset:14336
ds_read_b64_tr_b16 a[62:63], v9 offset:15360
ds_read_b64_tr_b16 a[56:57], v8 offset:14336
ds_read_b64_tr_b16 a[58:59], v8 offset:15360
buffer_load_dwordx4 v18, s[8:11], s62 offen offset:3072 lds
v_mul_f32 v34, -1.0, v232
s_waitcnt lgkmcnt(15)
v_mfma_f32_32x32x16_bf16 v[152:167], a[28:31], v[84:87], v[152:167]
ds_read_b64_tr_b16 a[68:69], v9 offset:16384
ds_read_b64_tr_b16 a[70:71], v9 offset:17408
ds_read_b64_tr_b16 a[64:65], v8 offset:16384
ds_read_b64_tr_b16 a[66:67], v8 offset:17408
v_fmac_f32 v233, v34, v232
v_mfma_f32_32x32x16_bf16 v[136:151], a[24:27], v[84:87], v[136:151]
ds_read_b64_tr_b16 a[76:77], v9 offset:18432
ds_read_b64_tr_b16 a[78:79], v9 offset:19456
ds_read_b64_tr_b16 a[72:73], v8 offset:18432
ds_read_b64_tr_b16 a[74:75], v8 offset:19456
s_mul_i32 s62, s97, 12
s_mov_b32 exec_hi, 0
buffer_load_dword v37, v194, s[8:11], s62 offen offset:0
s_mov_b32 exec_hi, -1
v_max_f32 v233, 0, v233
s_waitcnt lgkmcnt(15)
v_mfma_f32_32x32x16_bf16 v[152:167], a[36:39], v[88:91], v[152:167]
ds_read_b64_tr_b16 a[84:85], v9 offset:20480
ds_read_b64_tr_b16 a[86:87], v9 offset:21504
ds_read_b64_tr_b16 a[80:81], v8 offset:20480
ds_read_b64_tr_b16 a[82:83], v8 offset:21504
s_add_u32 m0, s56, 8192
s_add_u32 s62, s57, 198656
buffer_load_dwordx4 v15, s[8:11], s62 offen offset:0 lds
v_add_f32 v232, 0x3727c5ac, v233
v_mfma_f32_32x32x16_bf16 v[136:151], a[32:35], v[88:91], v[136:151]
ds_read_b64_tr_b16 a[92:93], v9 offset:22528
ds_read_b64_tr_b16 a[94:95], v9 offset:23552
ds_read_b64_tr_b16 a[88:89], v8 offset:22528
ds_read_b64_tr_b16 a[90:91], v8 offset:23552
v_rsq_f32 v35, v232
v_mfma_f32_32x32x16_bf16 v[152:167], a[44:47], v[92:95], v[152:167]
ds_read_b64_tr_b16 a[100:101], v9 offset:24576
ds_read_b64_tr_b16 a[102:103], v9 offset:25600
ds_read_b64_tr_b16 a[96:97], v8 offset:24576
ds_read_b64_tr_b16 a[98:99], v8 offset:25600
buffer_load_dwordx4 v16, s[8:11], s62 offen offset:1024 lds
s_lshl_b32 s63, s6, 8
s_add_u32 s63, s63, 149504
v_lshl_add_u32 v248, v0, 2, s63
v_mfma_f32_32x32x16_bf16 v[136:151], a[40:43], v[92:95], v[136:151]
ds_read_b64_tr_b16 a[108:109], v9 offset:26624
ds_read_b64_tr_b16 a[110:111], v9 offset:27648
ds_read_b64_tr_b16 a[104:105], v8 offset:26624
ds_read_b64_tr_b16 a[106:107], v8 offset:27648
v_cmp_gt_u32 vcc, 32, v0
s_waitcnt lgkmcnt(15)
v_mfma_f32_32x32x16_bf16 v[152:167], a[52:55], v[96:99], v[152:167]
ds_read_b64_tr_b16 a[116:117], v9 offset:28672
ds_read_b64_tr_b16 a[118:119], v9 offset:29696
ds_read_b64_tr_b16 a[112:113], v8 offset:28672
ds_read_b64_tr_b16 a[114:115], v8 offset:29696
buffer_load_dwordx4 v17, s[8:11], s62 offen offset:2048 lds
v_mul_f32 v36, 0x3eb8aa3b, v35
v_mfma_f32_32x32x16_bf16 v[136:151], a[48:51], v[96:99], v[136:151]
ds_read_b64_tr_b16 a[124:125], v9 offset:30720
ds_read_b64_tr_b16 a[126:127], v9 offset:31744
ds_read_b64_tr_b16 a[120:121], v8 offset:30720
ds_read_b64_tr_b16 a[122:123], v8 offset:31744
v_cndmask_b32 v249, v34, v35, vcc
v_mfma_f32_32x32x16_bf16 v[152:167], a[60:63], v[100:103], v[152:167]
ds_write_b32 v248, v249
buffer_load_dwordx4 v18, s[8:11], s62 offen offset:3072 lds
v_mfma_f32_32x32x16_bf16 v[136:151], a[56:59], v[100:103], v[136:151]
s_add_u32 m0, s56, 12288
s_add_u32 s62, s57, 296960
buffer_load_dwordx4 v15, s[8:11], s62 offen offset:0 lds
s_waitcnt lgkmcnt(0)
s_barrier
v_mfma_f32_32x32x16_bf16 v[152:167], a[68:71], v[104:107], v[152:167]
v_mfma_f32_32x32x16_bf16 v[136:151], a[64:67], v[104:107], v[136:151]
buffer_load_dwordx4 v16, s[8:11], s62 offen offset:1024 lds
v_mfma_f32_32x32x16_bf16 v[152:167], a[76:79], v[108:111], v[152:167]
v_mfma_f32_32x32x16_bf16 v[136:151], a[72:75], v[108:111], v[136:151]
buffer_load_dwordx4 v17, s[8:11], s62 offen offset:2048 lds
v_mfma_f32_32x32x16_bf16 v[152:167], a[84:87], v[112:115], v[152:167]
v_mfma_f32_32x32x16_bf16 v[136:151], a[80:83], v[112:115], v[136:151]
buffer_load_dwordx4 v18, s[8:11], s62 offen offset:3072 lds
v_mfma_f32_32x32x16_bf16 v[152:167], a[92:95], v[116:119], v[152:167]
v_mfma_f32_32x32x16_bf16 v[136:151], a[88:91], v[116:119], v[136:151]
s_sub_u32 s63, s4, 4
v_min_u32 v184, 5, v0
v_add_u32 v184, s63, v184
v_med3_i32 v184, v184, 0, 31
s_lshl_b32 s63, s6, 8
v_lshl_add_u32 v184, v184, 3, s63
buffer_load_dword v186, v184, s[44:47], 0 offen sc1
v_mfma_f32_32x32x16_bf16 v[152:167], a[100:103], v[120:123], v[152:167]
v_mfma_f32_32x32x16_bf16 v[136:151], a[96:99], v[120:123], v[136:151]
v_mfma_f32_32x32x16_bf16 v[152:167], a[108:111], v[124:127], v[152:167]
s_add_u32 m0, s56, 65536
s_add_u32 s62, s57, 0
buffer_load_dwordx4 v15, s[8:11], s62 offen offset:0 lds
v_mfma_f32_32x32x16_bf16 v[136:151], a[104:107], v[124:127], v[136:151]
v_mfma_f32_32x32x16_bf16 v[152:167], a[116:119], v[128:131], v[152:167]
buffer_load_dwordx4 v16, s[8:11], s62 offen offset:1024 lds
v_mfma_f32_32x32x16_bf16 v[136:151], a[112:115], v[128:131], v[136:151]
v_mfma_f32_32x32x16_bf16 v[152:167], a[124:127], v[132:135], v[152:167]
buffer_load_dwordx4 v17, s[8:11], s62 offen offset:2048 lds
v_mfma_f32_32x32x16_bf16 v[136:151], a[120:123], v[132:135], v[136:151]
s_nop 9
ds_write_b128 v23, v[152:155] offset:0
ds_write_b128 v23, v[156:159] offset:1024
ds_write_b128 v23, v[160:163] offset:2048
ds_write_b128 v23, v[164:167] offset:3072
s_waitcnt vmcnt(4)
s_barrier
s_cmp_eq_u32 s48, 0
s_cbranch_scc0 L_c1
ds_read_b64_tr_b16 a[132:133], v7 offset:0
ds_read_b64_tr_b16 a[134:135], v7 offset:1024
ds_read_b64_tr_b16 a[128:129], v6 offset:0
ds_read_b64_tr_b16 a[130:131], v6 offset:1024
ds_read_b64_tr_b16 a[140:141], v7 offset:2048
ds_read_b64_tr_b16 a[142:143], v7 offset:3072
ds_read_b64_tr_b16 a[136:137], v6 offset:2048
ds_read_b64_tr_b16 a[138:139], v6 offset:3072
ds_read_b64_tr_b16 a[148:149], v7 offset:4096
ds_read_b64_tr_b16 a[150:151], v7 offset:5120
ds_read_b64_tr_b16 a[144:145], v6 offset:4096
ds_read_b64_tr_b16 a[146:147], v6 offset:5120
ds_read_b64_tr_b16 a[156:157], v7 offset:6144
ds_read_b64_tr_b16 a[158:159], v7 offset:7168
ds_read_b64_tr_b16 a[152:153], v6 offset:6144
ds_read_b64_tr_b16 a[154:155], v6 offset:7168
v_mfma_f32_16x16x32_bf16 v[176:179], v[168:171], a[0:3], 0
ds_read_b64_tr_b16 a[164:165], v7 offset:8192
ds_read_b64_tr_b16 a[166:167], v7 offset:9216
ds_read_b64_tr_b16 a[160:161], v6 offset:8192
v_mfma_f32_16x16x32_bf16 v[176:179], v[168:171], a[8:11], v[176:179]
ds_read_b64_tr_b16 a[162:163], v6 offset:9216
ds_read_b64_tr_b16 a[172:173], v7 offset:10240
ds_read_b64_tr_b16 a[174:175], v7 offset:11264
v_mfma_f32_16x16x32_bf16 v[176:179], v[168:171], a[16:19], v[176:179]
ds_read_b64_tr_b16 a[168:169], v6 offset:10240
ds_read_b64_tr_b16 a[170:171], v6 offset:11264
ds_read_b64_tr_b16 a[180:181], v7 offset:12288
v_mfma_f32_16x16x32_bf16 v[176:179], v[168:171], a[24:27], v[176:179]
ds_read_b64_tr_b16 a[182:183], v7 offset:13312
ds_read_b64_tr_b16 a[176:177], v6 offset:12288
ds_read_b64_tr_b16 a[178:179], v6 offset:13312
v_mfma_f32_16x16x32_bf16 v[176:179], v[168:171], a[32:35], v[176:179]
ds_read_b64_tr_b16 a[188:189], v7 offset:14336
ds_read_b64_tr_b16 a[190:191], v7 offset:15360
ds_read_b64_tr_b16 a[184:185], v6 offset:14336
v_mfma_f32_16x16x32_bf16 v[176:179], v[168:171], a[40:43], v[176:179]
ds_read_b64_tr_b16 a[186:187], v6 offset:15360
ds_read_b64_tr_b16 a[196:197], v7 offset:16384
ds_read_b64_tr_b16 a[198:199], v7 offset:17408
v_mfma_f32_16x16x32_bf16 v[176:179], v[168:171], a[48:51], v[176:179]
ds_read_b64_tr_b16 a[192:193], v6 offset:16384
ds_read_b64_tr_b16 a[194:195], v6 offset:17408
ds_read_b64_tr_b16 a[204:205], v7 offset:18432
buffer_load_dwordx4 v18, s[8:11], s62 offen offset:3072 lds
v_mfma_f32_16x16x32_bf16 v[176:179], v[168:171], a[56:59], v[176:179]
ds_read_b64_tr_b16 a[206:207], v7 offset:19456
ds_read_b64_tr_b16 a[200:201], v6 offset:18432
ds_read_b64_tr_b16 a[202:203], v6 offset:19456
v_mfma_f32_16x16x32_bf16 v[176:179], v[168:171], a[64:67], v[176:179]
ds_read_b64_tr_b16 a[212:213], v7 offset:20480
ds_read_b64_tr_b16 a[214:215], v7 offset:21504
ds_read_b64_tr_b16 a[208:209], v6 offset:20480
s_add_u32 m0, s56, 69632
s_add_u32 s62, s57, 98304
buffer_load_dwordx4 v15, s[8:11], s62 offen offset:0 lds
v_mfma_f32_16x16x32_bf16 v[176:179], v[168:171], a[72:75], v[176:179]
ds_read_b64_tr_b16 a[210:211], v6 offset:21504
ds_read_b64_tr_b16 a[220:221], v7 offset:22528
ds_read_b64_tr_b16 a[222:223], v7 offset:23552
v_mfma_f32_16x16x32_bf16 v[176:179], v[168:171], a[80:83], v[176:179]
ds_read_b64_tr_b16 a[216:217], v6 offset:22528
ds_read_b64_tr_b16 a[218:219], v6 offset:23552
ds_read_b64_tr_b16 a[228:229], v7 offset:24576
v_mfma_f32_16x16x32_bf16 v[176:179], v[168:171], a[88:91], v[176:179]
ds_read_b64_tr_b16 a[230:231], v7 offset:25600
ds_read_b64_tr_b16 a[224:225], v6 offset:24576
ds_read_b64_tr_b16 a[226:227], v6 offset:25600
buffer_load_dwordx4 v16, s[8:11], s62 offen offset:1024 lds
v_mfma_f32_16x16x32_bf16 v[176:179], v[168:171], a[96:99], v[176:179]
ds_read_b64_tr_b16 a[236:237], v7 offset:26624
ds_read_b64_tr_b16 a[238:239], v7 offset:27648
ds_read_b64_tr_b16 a[232:233], v6 offset:26624
v_mfma_f32_16x16x32_bf16 v[176:179], v[168:171], a[104:107], v[176:179]
ds_read_b64_tr_b16 a[234:235], v6 offset:27648
ds_read_b64_tr_b16 a[244:245], v7 offset:28672
ds_read_b64_tr_b16 a[246:247], v7 offset:29696
buffer_load_dwordx4 v17, s[8:11], s62 offen offset:2048 lds
v_mfma_f32_16x16x32_bf16 v[176:179], v[168:171], a[112:115], v[176:179]
ds_read_b64_tr_b16 a[240:241], v6 offset:28672
ds_read_b64_tr_b16 a[242:243], v6 offset:29696
ds_read_b64_tr_b16 a[252:253], v7 offset:30720
v_mfma_f32_16x16x32_bf16 v[176:179], v[168:171], a[120:123], v[176:179]
ds_read_b64_tr_b16 a[254:255], v7 offset:31744
ds_read_b64_tr_b16 a[248:249], v6 offset:30720
ds_read_b64_tr_b16 a[250:251], v6 offset:31744
s_waitcnt lgkmcnt(15)
v_mfma_f32_16x16x32_bf16 v[56:59], v[168:171], a[128:131], 0
s_lshl_b32 s63, s97, 2
s_mov_b32 exec_hi, 0
buffer_load_dword v37, v244, s[12:15], s63 offen
s_mov_b32 exec_hi, -1
v_mfma_f32_16x16x32_bf16 v[56:59], v[168:171], a[136:139], v[56:59]
v_mfma_f32_16x16x32_bf16 v[56:59], v[168:171], a[144:147], v[56:59]
v_mfma_f32_16x16x32_bf16 v[56:59], v[168:171], a[152:155], v[56:59]
v_mov_b32 v192, 1
v_mov_b32 v193, 1
v_mov_b32 v194, 1
v_mov_b32 v195, 1
v_mfma_f32_16x16x32_bf16 v[56:59], v[168:171], a[160:163], v[56:59]
v_mfma_f32_16x16x32_bf16 v[56:59], v[168:171], a[168:171], v[56:59]
s_lshl_b32 s65, s7, 30
v_or_b32 v196, s65, v1
v_mfma_f32_16x16x32_bf16 v[56:59], v[168:171], a[176:179], v[56:59]
v_mfma_f32_16x16x32_bf16 v[56:59], v[168:171], a[184:187], v[56:59]
v_mfma_f32_16x16x32_bf16 v[56:59], v[168:171], a[192:195], v[56:59]
s_sub_u32 exec_lo, s7, 1
s_mov_b32 exec_hi, 0
ds_add_f32 v26, v176 offset:0
s_mov_b64 exec, -1
s_add_u32 s65, s50, s55
s_add_u32 s65, s65, 4194304
buffer_store_dwordx4 v[192:195], v196, s[32:35], s65 offen offset:0 sc1
buffer_store_dwordx4 v[192:195], v196, s[32:35], s65 offen offset:1024 sc1
v_mfma_f32_16x16x32_bf16 v[56:59], v[168:171], a[200:203], v[56:59]
v_mfma_f32_16x16x32_bf16 v[56:59], v[168:171], a[208:211], v[56:59]
s_add_u32 s65, s50, s70
s_add_u32 s65, s65, 12582912
buffer_store_dwordx4 v[192:195], v196, s[32:35], s65 offen offset:0 sc1
v_mfma_f32_16x16x32_bf16 v[56:59], v[168:171], a[216:219], v[56:59]
s_waitcnt lgkmcnt(13)
v_mfma_f32_16x16x32_bf16 v[56:59], v[168:171], a[224:227], v[56:59]
s_waitcnt lgkmcnt(9)
v_mfma_f32_16x16x32_bf16 v[56:59], v[168:171], a[232:235], v[56:59]
s_andn2_b32 s65, s68, 15
s_add_u32 s65, s65, s50
s_add_u32 s65, s65, 14680064
buffer_store_dwordx4 v[192:195], v196, s[32:35], s65 offen offset:0 sc1
s_waitcnt lgkmcnt(5)
v_mfma_f32_16x16x32_bf16 v[56:59], v[168:171], a[240:243], v[56:59]
s_waitcnt lgkmcnt(1)
v_mfma_f32_16x16x32_bf16 v[56:59], v[168:171], a[248:251], v[56:59]
s_branch L_c2
L_c1:
ds_read_b64_tr_b16 a[132:133], v7 offset:0
ds_read_b64_tr_b16 a[134:135], v7 offset:1024
ds_read_b64_tr_b16 a[128:129], v6 offset:0
ds_read_b64_tr_b16 a[130:131], v6 offset:1024
ds_read_b64_tr_b16 a[140:141], v7 offset:2048
ds_read_b64_tr_b16 a[142:143], v7 offset:3072
ds_read_b64_tr_b16 a[136:137], v6 offset:2048
ds_read_b64_tr_b16 a[138:139], v6 offset:3072
ds_read_b64_tr_b16 a[148:149], v7 offset:4096
ds_read_b64_tr_b16 a[150:151], v7 offset:5120
ds_read_b64_tr_b16 a[144:145], v6 offset:4096
ds_read_b64_tr_b16 a[146:147], v6 offset:5120
ds_read_b64_tr_b16 a[156:157], v7 offset:6144
ds_read_b64_tr_b16 a[158:159], v7 offset:7168
ds_read_b64_tr_b16 a[152:153], v6 offset:6144
ds_read_b64_tr_b16 a[154:155], v6 offset:7168
v_mfma_f32_16x16x32_bf16 v[176:179], v[168:171], a[4:7], 0
ds_read_b64_tr_b16 a[164:165], v7 offset:8192
ds_read_b64_tr_b16 a[166:167], v7 offset:9216
ds_read_b64_tr_b16 a[160:161], v6 offset:8192
v_mfma_f32_16x16x32_bf16 v[176:179], v[168:171], a[12:15], v[176:179]
ds_read_b64_tr_b16 a[162:163], v6 offset:9216
ds_read_b64_tr_b16 a[172:173], v7 offset:10240
ds_read_b64_tr_b16 a[174:175], v7 offset:11264
v_mfma_f32_16x16x32_bf16 v[176:179], v[168:171], a[20:23], v[176:179]
ds_read_b64_tr_b16 a[168:169], v6 offset:10240
ds_read_b64_tr_b16 a[170:171], v6 offset:11264
ds_read_b64_tr_b16 a[180:181], v7 offset:12288
v_mfma_f32_16x16x32_bf16 v[176:179], v[168:171], a[28:31], v[176:179]
ds_read_b64_tr_b16 a[182:183], v7 offset:13312
ds_read_b64_tr_b16 a[176:177], v6 offset:12288
ds_read_b64_tr_b16 a[178:179], v6 offset:13312
v_mfma_f32_16x16x32_bf16 v[176:179], v[168:171], a[36:39], v[176:179]
ds_read_b64_tr_b16 a[188:189], v7 offset:14336
ds_read_b64_tr_b16 a[190:191], v7 offset:15360
ds_read_b64_tr_b16 a[184:185], v6 offset:14336
v_mfma_f32_16x16x32_bf16 v[176:179], v[168:171], a[44:47], v[176:179]
ds_read_b64_tr_b16 a[186:187], v6 offset:15360
ds_read_b64_tr_b16 a[196:197], v7 offset:16384
ds_read_b64_tr_b16 a[198:199], v7 offset:17408
v_mfma_f32_16x16x32_bf16 v[176:179], v[168:171], a[52:55], v[176:179]
ds_read_b64_tr_b16 a[192:193], v6 offset:16384
ds_read_b64_tr_b16 a[194:195], v6 offset:17408
ds_read_b64_tr_b16 a[204:205], v7 offset:18432
buffer_load_dwordx4 v18, s[8:11], s62 offen offset:3072 lds
v_mfma_f32_16x16x32_bf16 v[176:179], v[168:171], a[60:63], v[176:179]
ds_read_b64_tr_b16 a[206:207], v7 offset:19456
ds_read_b64_tr_b16 a[200:201], v6 offset:18432
ds_read_b64_tr_b16 a[202:203], v6 offset:19456
v_mfma_f32_16x16x32_bf16 v[176:179], v[168:171], a[68:71], v[176:179]
ds_read_b64_tr_b16 a[212:213], v7 offset:20480
ds_read_b64_tr_b16 a[214:215], v7 offset:21504
ds_read_b64_tr_b16 a[208:209], v6 offset:20480
s_add_u32 m0, s56, 69632
s_add_u32 s62, s57, 98304
buffer_load_dwordx4 v15, s[8:11], s62 offen offset:0 lds
v_mfma_f32_16x16x32_bf16 v[176:179], v[168:171], a[76:79], v[176:179]
ds_read_b64_tr_b16 a[210:211], v6 offset:21504
ds_read_b64_tr_b16 a[220:221], v7 offset:22528
ds_read_b64_tr_b16 a[222:223], v7 offset:23552
v_mfma_f32_16x16x32_bf16 v[176:179], v[168:171], a[84:87], v[176:179]
ds_read_b64_tr_b16 a[216:217], v6 offset:22528
ds_read_b64_tr_b16 a[218:219], v6 offset:23552
ds_read_b64_tr_b16 a[228:229], v7 offset:24576
v_mfma_f32_16x16x32_bf16 v[176:179], v[168:171], a[92:95], v[176:179]
ds_read_b64_tr_b16 a[230:231], v7 offset:25600
ds_read_b64_tr_b16 a[224:225], v6 offset:24576
ds_read_b64_tr_b16 a[226:227], v6 offset:25600
buffer_load_dwordx4 v16, s[8:11], s62 offen offset:1024 lds
v_mfma_f32_16x16x32_bf16 v[176:179], v[168:171], a[100:103], v[176:179]
ds_read_b64_tr_b16 a[236:237], v7 offset:26624
ds_read_b64_tr_b16 a[238:239], v7 offset:27648
ds_read_b64_tr_b16 a[232:233], v6 offset:26624
v_mfma_f32_16x16x32_bf16 v[176:179], v[168:171], a[108:111], v[176:179]
ds_read_b64_tr_b16 a[234:235], v6 offset:27648
ds_read_b64_tr_b16 a[244:245], v7 offset:28672
ds_read_b64_tr_b16 a[246:247], v7 offset:29696
buffer_load_dwordx4 v17, s[8:11], s62 offen offset:2048 lds
v_mfma_f32_16x16x32_bf16 v[176:179], v[168:171], a[116:119], v[176:179]
ds_read_b64_tr_b16 a[240:241], v6 offset:28672
ds_read_b64_tr_b16 a[242:243], v6 offset:29696
ds_read_b64_tr_b16 a[252:253], v7 offset:30720
v_mfma_f32_16x16x32_bf16 v[176:179], v[168:171], a[124:127], v[176:179]
ds_read_b64_tr_b16 a[254:255], v7 offset:31744
ds_read_b64_tr_b16 a[248:249], v6 offset:30720
ds_read_b64_tr_b16 a[250:251], v6 offset:31744
s_waitcnt lgkmcnt(15)
v_mfma_f32_16x16x32_bf16 v[56:59], v[168:171], a[132:135], 0
s_lshl_b32 s63, s97, 2
s_mov_b32 exec_hi, 0
buffer_load_dword v37, v244, s[12:15], s63 offen
s_mov_b32 exec_hi, -1
v_mfma_f32_16x16x32_bf16 v[56:59], v[168:171], a[140:143], v[56:59]
v_mfma_f32_16x16x32_bf16 v[56:59], v[168:171], a[148:151], v[56:59]
v_mfma_f32_16x16x32_bf16 v[56:59], v[168:171], a[156:159], v[56:59]
v_mov_b32 v192, 1
v_mov_b32 v193, 1
v_mov_b32 v194, 1
v_mov_b32 v195, 1
v_mfma_f32_16x16x32_bf16 v[56:59], v[168:171], a[164:167], v[56:59]
v_mfma_f32_16x16x32_bf16 v[56:59], v[168:171], a[172:175], v[56:59]
s_lshl_b32 s65, s7, 30
v_or_b32 v196, s65, v1
v_mfma_f32_16x16x32_bf16 v[56:59], v[168:171], a[180:183], v[56:59]
v_mfma_f32_16x16x32_bf16 v[56:59], v[168:171], a[188:191], v[56:59]
v_mfma_f32_16x16x32_bf16 v[56:59], v[168:171], a[196:199], v[56:59]
s_sub_u32 exec_lo, s7, 1
s_mov_b32 exec_hi, 0
ds_add_f32 v26, v176 offset:0
s_mov_b64 exec, -1
s_add_u32 s65, s50, s55
s_add_u32 s65, s65, 4194304
buffer_store_dwordx4 v[192:195], v196, s[32:35], s65 offen offset:0 sc1
buffer_store_dwordx4 v[192:195], v196, s[32:35], s65 offen offset:1024 sc1
v_mfma_f32_16x16x32_bf16 v[56:59], v[168:171], a[204:207], v[56:59]
v_mfma_f32_16x16x32_bf16 v[56:59], v[168:171], a[212:215], v[56:59]
s_add_u32 s65, s50, s70
s_add_u32 s65, s65, 12582912
buffer_store_dwordx4 v[192:195], v196, s[32:35], s65 offen offset:0 sc1
v_mfma_f32_16x16x32_bf16 v[56:59], v[168:171], a[220:223], v[56:59]
s_waitcnt lgkmcnt(15)
v_mfma_f32_16x16x32_bf16 v[56:59], v[168:171], a[228:231], v[56:59]
s_waitcnt lgkmcnt(11)
v_mfma_f32_16x16x32_bf16 v[56:59], v[168:171], a[236:239], v[56:59]
s_andn2_b32 s65, s68, 15
s_add_u32 s65, s65, s50
s_add_u32 s65, s65, 14680064
buffer_store_dwordx4 v[192:195], v196, s[32:35], s65 offen offset:0 sc1
s_waitcnt lgkmcnt(7)
v_mfma_f32_16x16x32_bf16 v[56:59], v[168:171], a[244:247], v[56:59]
s_waitcnt lgkmcnt(3)
v_mfma_f32_16x16x32_bf16 v[56:59], v[168:171], a[252:255], v[56:59]
L_c2:
s_or_b32 exec_hi, s7, s49
s_cselect_b32 exec_lo, 0, -1
s_mov_b32 exec_hi, 0
s_nop 8
ds_write_b32 v26, v56 offset:3072
s_mov_b64 exec, -1
s_waitcnt vmcnt(12)
s_cmp_eq_u32 s6, 0
s_cbranch_scc0 L_hs2
L_hs1:
v_cmp_eq_u32 vcc, 0, v186
s_cbranch_vccz L_hs2
buffer_load_dword v186, v184, s[44:47], 0 offen sc1
s_sub_u32 s53, s53, 1
s_waitcnt vmcnt(0)
s_cbranch_scc0 L_hs1
s_endpgm
L_hs2:
s_waitcnt lgkmcnt(0)
s_barrier
L_top:
v_mfma_f32_32x32x16_bf16 v[216:231], v[72:75], a[132:135], 0
ds_read_b128 v[184:187], v25 offset:0
ds_read_b128 v[188:191], v25 offset:32
ds_read_b128 v[192:195], v25 offset:64
ds_read_b128 v[196:199], v25 offset:96
buffer_load_dwordx4 v18, s[8:11], s62 offen offset:3072 lds
v_mfma_f32_32x32x16_bf16 v[200:215], v[72:75], a[128:131], 0
ds_read_b128 v[168:171], v24 offset:0
ds_read_b128 v[172:175], v24 offset:1024
ds_read_b128 v[176:179], v24 offset:2048
ds_read_b128 v[180:183], v24 offset:3072
v_mfma_f32_32x32x16_bf16 v[216:231], v[76:79], a[140:143], v[216:231]
s_add_u32 m0, s56, 73728
s_add_u32 s62, s57, 196608
buffer_load_dwordx4 v15, s[8:11], s62 offen offset:0 lds
s_waitcnt lgkmcnt(7)
v_fmac_f32 v136, v184, v34
v_fmac_f32 v137, v185, v34
v_fmac_f32 v138, v186, v34
v_fmac_f32 v139, v187, v34
v_mfma_f32_32x32x16_bf16 v[200:215], v[76:79], a[136:139], v[200:215]
s_waitcnt lgkmcnt(6)
v_fmac_f32 v140, v188, v34
v_fmac_f32 v141, v189, v34
v_fmac_f32 v142, v190, v34
v_fmac_f32 v143, v191, v34
v_mfma_f32_32x32x16_bf16 v[216:231], v[80:83], a[148:151], v[216:231]
buffer_load_dwordx4 v16, s[8:11], s62 offen offset:1024 lds
s_waitcnt lgkmcnt(5)
v_fmac_f32 v144, v192, v34
v_fmac_f32 v145, v193, v34
v_fmac_f32 v146, v194, v34
v_mfma_f32_32x32x16_bf16 v[200:215], v[80:83], a[144:147], v[200:215]
ds_read_b32 v57, v26 offset:3072
v_fmac_f32 v147, v195, v34
s_waitcnt lgkmcnt(5)
v_fmac_f32 v148, v196, v34
v_fmac_f32 v149, v197, v34
v_fmac_f32 v150, v198, v34
v_mfma_f32_32x32x16_bf16 v[216:231], v[84:87], a[156:159], v[216:231]
buffer_load_dwordx4 v17, s[8:11], s62 offen offset:2048 lds
v_fmac_f32 v151, v199, v34
v_mul_f32 v136, v136, v35
v_mul_f32 v137, v137, v35
v_mul_f32 v138, v138, v35
v_mfma_f32_32x32x16_bf16 v[200:215], v[84:87], a[152:155], v[200:215]
v_mul_f32 v139, v139, v35
v_mul_f32 v140, v140, v35
v_mul_f32 v141, v141, v35
v_mul_f32 v142, v142, v35
v_mfma_f32_32x32x16_bf16 v[216:231], v[88:91], a[164:167], v[216:231]
buffer_load_dwordx4 v18, s[8:11], s62 offen offset:3072 lds
v_mul_f32 v143, v143, v35
v_mul_f32 v144, v144, v35
v_mul_f32 v145, v145, v35
v_mfma_f32_32x32x16_bf16 v[200:215], v[88:91], a[160:163], v[200:215]
v_mul_f32 v146, v146, v35
v_mul_f32 v147, v147, v35
v_mul_f32 v148, v148, v35
v_mul_f32 v149, v149, v35
s_waitcnt lgkmcnt(0)
v_add_f32 v56, v56, v57
s_cmp_gt_u32 s49, s7
s_cselect_b32 exec_lo, -1, 0
s_mov_b32 exec_hi, 0
ds_write_b32 v26, v56 offset:256
s_mov_b64 exec, -1
v_mfma_f32_32x32x16_bf16 v[216:231], v[92:95], a[172:175], v[216:231]
s_add_u32 m0, s56, 77824
s_add_u32 s62, s57, 294912
buffer_load_dwordx4 v15, s[8:11], s62 offen offset:0 lds
v_mul_f32 v150, v150, v35
v_mul_f32 v151, v151, v35
v_fmac_f32 v136, v168, v35
v_fmac_f32 v137, v169, v35
v_mfma_f32_32x32x16_bf16 v[200:215], v[92:95], a[168:171], v[200:215]
v_fmac_f32 v138, v170, v35
v_fmac_f32 v139, v171, v35
v_fmac_f32 v140, v172, v35
v_fmac_f32 v141, v173, v35
v_mfma_f32_32x32x16_bf16 v[216:231], v[96:99], a[180:183], v[216:231]
buffer_load_dwordx4 v16, s[8:11], s62 offen offset:1024 lds
v_fmac_f32 v142, v174, v35
v_fmac_f32 v143, v175, v35
v_fmac_f32 v144, v176, v35
v_fmac_f32 v145, v177, v35
v_mfma_f32_32x32x16_bf16 v[200:215], v[96:99], a[176:179], v[200:215]
v_fmac_f32 v146, v178, v35
v_fmac_f32 v147, v179, v35
v_fmac_f32 v148, v180, v35
v_mfma_f32_32x32x16_bf16 v[216:231], v[100:103], a[188:191], v[216:231]
buffer_load_dwordx4 v17, s[8:11], s62 offen offset:2048 lds
v_fmac_f32 v149, v181, v35
v_fmac_f32 v150, v182, v35
v_fmac_f32 v151, v183, v35
v_cvt_pk_bf16_f32 v248, v136, v137
v_mfma_f32_32x32x16_bf16 v[200:215], v[100:103], a[184:187], v[200:215]
v_cvt_pk_bf16_f32 v249, v138, v139
v_cvt_pk_bf16_f32 v250, v140, v141
v_cvt_pk_bf16_f32 v251, v142, v143
v_cvt_pk_bf16_f32 v252, v144, v145
v_mfma_f32_32x32x16_bf16 v[216:231], v[104:107], a[196:199], v[216:231]
buffer_load_dwordx4 v18, s[8:11], s62 offen offset:3072 lds
v_cvt_pk_bf16_f32 v253, v146, v147
v_cvt_pk_bf16_f32 v254, v148, v149
v_cvt_pk_bf16_f32 v255, v150, v151
s_add_u32 s66, s96, s55
v_mfma_f32_32x32x16_bf16 v[200:215], v[104:107], a[192:195], v[200:215]
s_add_u32 s66, s66, 0
buffer_store_dwordx4 v[248:251], v1, s[32:35], s66 offen offset:0 sc1
buffer_store_dwordx4 v[252:255], v1, s[32:35], s66 offen offset:1024 sc1
v_mfma_f32_32x32x16_bf16 v[216:231], v[108:111], a[204:207], v[216:231]
v_lshrrev_b32 v248, 5, v0
s_lshl_b32 s63, s6, 8
s_add_u32 s63, s63, 149504
v_lshl_add_u32 v248, v248, 4, s63
v_mfma_f32_32x32x16_bf16 v[200:215], v[108:111], a[200:203], v[200:215]
s_add_u32 m0, s56, 0
s_add_u32 s62, s58, 0
buffer_load_dwordx4 v11, s[12:15], s62 offen offset:0 lds
s_lshl_b32 s63, s49, 7
s_add_u32 s63, s63, 147712
v_add_u32 v250, s63, v28
v_mfma_f32_32x32x16_bf16 v[216:231], v[112:115], a[212:215], v[216:231]
ds_read_b128 v[184:187], v248 offset:128
ds_read_b128 v[188:191], v248 offset:160
ds_read_b128 v[192:195], v248 offset:192
ds_read_b128 v[196:199], v248 offset:224
v_mfma_f32_32x32x16_bf16 v[200:215], v[112:115], a[208:211], v[200:215]
ds_read_b128 v[232:235], v248 offset:0
ds_read_b128 v[236:239], v248 offset:32
ds_read_b128 v[240:243], v248 offset:64
buffer_load_dwordx4 v12, s[12:15], s62 offen offset:1024 lds
v_mfma_f32_32x32x16_bf16 v[216:231], v[116:119], a[220:223], v[216:231]
ds_read_b128 v[244:247], v248 offset:96
s_add_u32 s64, s72, s71
s_sub_u32 s65, s4, 4
s_cselect_b32 s65, 0, s65
s_cselect_b32 s77, 0, 32768
s_cselect_b32 s98, 0x200, -1
s_cselect_b32 s99, 1073741824, 0
s_cselect_b32 s86, -1, 0xffff
s_mov_b32 s87, s86
v_mfma_f32_32x32x16_bf16 v[200:215], v[116:119], a[216:219], v[200:215]
s_lshl_b32 s65, s65, 16
s_add_u32 s76, s65, s64
s_add_u32 s77, s77, s76
v_mfma_f32_32x32x16_bf16 v[216:231], v[120:123], a[228:231], v[216:231]
buffer_load_dwordx4 v13, s[12:15], s62 offen offset:2048 lds
s_waitcnt lgkmcnt(8)
s_barrier
v_and_b32 v64, s98, v1
v_or_b32 v68, s99, v33
s_sub_u32 s65, s4, 3
s_cselect_b32 s65, 0, s65
s_cselect_b32 s79, 0, 32768
s_cselect_b32 s98, 0x200, -1
s_cselect_b32 s99, 1073741824, 0
s_cselect_b32 s88, -1, 0xffff
v_mfma_f32_32x32x16_bf16 v[200:215], v[120:123], a[224:227], v[200:215]
s_mov_b32 s89, s88
s_lshl_b32 s65, s65, 16
s_add_u32 s78, s65, s64
s_add_u32 s79, s79, s78
v_mfma_f32_32x32x16_bf16 v[216:231], v[124:127], a[236:239], v[216:231]
ds_read_b32 v250, v250
buffer_load_dwordx4 v14, s[12:15], s62 offen offset:3072 lds
v_and_b32 v65, s98, v1
v_or_b32 v69, s99, v33
s_sub_u32 s65, s4, 2
s_cselect_b32 s65, 0, s65
s_cselect_b32 s81, 0, 32768
s_cselect_b32 s98, 0x200, -1
s_cselect_b32 s99, 1073741824, 0
s_cselect_b32 s90, -1, 0xffff
v_mfma_f32_32x32x16_bf16 v[200:215], v[124:127], a[232:235], v[200:215]
s_mov_b32 s91, s90
s_lshl_b32 s65, s65, 16
s_add_u32 s80, s65, s64
s_add_u32 s81, s81, s80
v_mfma_f32_32x32x16_bf16 v[216:231], v[128:131], a[244:247], v[216:231]
v_and_b32 v66, s98, v1
v_or_b32 v70, s99, v33
s_sub_u32 s65, s4, 1
s_cselect_b32 s65, 0, s65
s_cselect_b32 s83, 0, 32768
s_cselect_b32 s98, 0x200, -1
s_cselect_b32 s99, 1073741824, 0
s_cselect_b32 s92, -1, 0xffff
v_mfma_f32_32x32x16_bf16 v[200:215], v[128:131], a[240:243], v[200:215]
s_add_u32 m0, s56, 4096
s_add_u32 s62, s58, 32768
buffer_load_dwordx4 v11, s[12:15], s62 offen offset:0 lds
s_mov_b32 s93, s92
s_lshl_b32 s65, s65, 16
s_add_u32 s82, s65, s64
s_add_u32 s83, s83, s82
v_mfma_f32_32x32x16_bf16 v[216:231], v[132:135], a[252:255], v[216:231]
v_and_b32 v67, s98, v1
v_or_b32 v71, s99, v33
s_add_u32 s84, s96, s71
v_mfma_f32_32x32x16_bf16 v[200:215], v[132:135], a[248:251], v[200:215]
s_add_u32 s85, s84, 32768
s_mov_b32 s94, 0xffff
s_mov_b32 s95, 0xffff
s_nop 4
ds_write_b128 v23, v[216:219] offset:0
ds_write_b128 v23, v[220:223] offset:1024
ds_write_b128 v23, v[224:227] offset:2048
ds_write_b128 v23, v[228:231] offset:3072
s_waitcnt vmcnt(7)
s_waitcnt lgkmcnt(0)
s_barrier
ds_read_b128 v[168:171], v24 offset:0
ds_read_b128 v[172:175], v24 offset:1024
ds_read_b128 v[176:179], v24 offset:2048
ds_read_b128 v[180:183], v24 offset:3072
v_pk_fma_f32 v[200:201], v[184:185], v[250:251], v[200:201] op_sel_hi:[1,0,1]
v_pk_fma_f32 v[202:203], v[186:187], v[250:251], v[202:203] op_sel_hi:[1,0,1]
v_pk_fma_f32 v[204:205], v[188:189], v[250:251], v[204:205] op_sel_hi:[1,0,1]
v_pk_fma_f32 v[206:207], v[190:191], v[250:251], v[206:207] op_sel_hi:[1,0,1]
v_pk_fma_f32 v[208:209], v[192:193], v[250:251], v[208:209] op_sel_hi:[1,0,1]
v_pk_fma_f32 v[210:211], v[194:195], v[250:251], v[210:211] op_sel_hi:[1,0,1]
v_pk_fma_f32 v[212:213], v[196:197], v[250:251], v[212:213] op_sel_hi:[1,0,1]
v_pk_fma_f32 v[214:215], v[198:199], v[250:251], v[214:215] op_sel_hi:[1,0,1]
ds_read_b64_tr_b16 a[4:5], v9 offset:0
ds_read_b64_tr_b16 a[6:7], v9 offset:1024
ds_read_b64_tr_b16 a[0:1], v8 offset:0
ds_read_b64_tr_b16 a[2:3], v8 offset:1024
ds_read_b64_tr_b16 a[12:13], v9 offset:2048
ds_read_b64_tr_b16 a[14:15], v9 offset:3072
ds_read_b64_tr_b16 a[8:9], v8 offset:2048
ds_read_b64_tr_b16 a[10:11], v8 offset:3072
s_waitcnt lgkmcnt(11)
v_pk_add_f32 v[200:201], v[200:201], v[168:169]
v_pk_add_f32 v[202:203], v[202:203], v[170:171]
s_waitcnt lgkmcnt(10)
v_pk_add_f32 v[204:205], v[204:205], v[172:173]
v_pk_add_f32 v[206:207], v[206:207], v[174:175]
s_waitcnt lgkmcnt(9)
v_pk_add_f32 v[208:209], v[208:209], v[176:177]
v_pk_add_f32 v[210:211], v[210:211], v[178:179]
s_waitcnt lgkmcnt(8)
v_pk_add_f32 v[212:213], v[212:213], v[180:181]
v_pk_add_f32 v[214:215], v[214:215], v[182:183]
v_pk_mul_f32 v[200:201], v[200:201], v[232:233]
v_pk_mul_f32 v[202:203], v[202:203], v[234:235]
v_pk_mul_f32 v[204:205], v[204:205], v[236:237]
v_pk_mul_f32 v[206:207], v[206:207], v[238:239]
v_pk_mul_f32 v[208:209], v[208:209], v[240:241]
v_pk_mul_f32 v[210:211], v[210:211], v[242:243]
v_pk_mul_f32 v[212:213], v[212:213], v[244:245]
v_pk_mul_f32 v[214:215], v[214:215], v[246:247]
v_cvt_pk_bf16_f32 v248, v200, v201
v_cvt_pk_bf16_f32 v249, v202, v203
v_cvt_pk_bf16_f32 v250, v204, v205
v_cvt_pk_bf16_f32 v251, v206, v207
v_cvt_pk_bf16_f32 v252, v208, v209
v_cvt_pk_bf16_f32 v253, v210, v211
v_cvt_pk_bf16_f32 v254, v212, v213
v_cvt_pk_bf16_f32 v255, v214, v215
s_add_u32 s66, s96, s55
s_add_u32 s66, s66, 2097152
buffer_store_dwordx4 v[248:251], v1, s[32:35], s66 offen offset:0 sc1
buffer_store_dwordx4 v[252:255], v1, s[32:35], s66 offen offset:1024 sc1
s_waitcnt lgkmcnt(6)
v_mfma_f32_32x32x16_bf16 v[152:167], a[4:7], v[72:75], 0
ds_read_b64_tr_b16 a[20:21], v9 offset:4096
ds_read_b64_tr_b16 a[22:23], v9 offset:5120
ds_read_b64_tr_b16 a[16:17], v8 offset:4096
buffer_load_dwordx4 v12, s[12:15], s62 offen offset:1024 lds
v_and_b32 v232, 31, v0
v_lshrrev_b32 v233, 5, v0
v_lshlrev_b32 v233, 2, v233
v_sub_u32 v232, v232, v233
v_sub_u32 v216, -1, v232
s_waitcnt lgkmcnt(7)
v_mfma_f32_32x32x16_bf16 v[136:151], a[0:3], v[72:75], 0
ds_read_b64_tr_b16 a[18:19], v8 offset:5120
ds_read_b64_tr_b16 a[28:29], v9 offset:6144
ds_read_b64_tr_b16 a[30:31], v9 offset:7168
v_sub_u32 v217, 0, v232
v_sub_u32 v218, 1, v232
v_sub_u32 v219, 2, v232
v_sub_u32 v220, 7, v232
s_waitcnt lgkmcnt(8)
v_mfma_f32_32x32x16_bf16 v[152:167], a[12:15], v[76:79], v[152:167]
ds_read_b64_tr_b16 a[24:25], v8 offset:6144
ds_read_b64_tr_b16 a[26:27], v8 offset:7168
buffer_load_dwordx4 v13, s[12:15], s62 offen offset:2048 lds
v_sub_u32 v221, 8, v232
v_sub_u32 v222, 9, v232
v_sub_u32 v223, 10, v232
v_sub_u32 v224, 15, v232
s_waitcnt lgkmcnt(8)
v_mfma_f32_32x32x16_bf16 v[136:151], a[8:11], v[76:79], v[136:151]
ds_read_b64_tr_b16 a[36:37], v9 offset:8192
ds_read_b64_tr_b16 a[38:39], v9 offset:9216
ds_read_b64_tr_b16 a[32:33], v8 offset:8192
v_sub_u32 v225, 16, v232
v_sub_u32 v226, 17, v232
v_sub_u32 v227, 18, v232
v_sub_u32 v228, 23, v232
s_waitcnt lgkmcnt(9)
v_mfma_f32_32x32x16_bf16 v[152:167], a[20:23], v[80:83], v[152:167]
ds_read_b64_tr_b16 a[34:35], v8 offset:9216
ds_read_b64_tr_b16 a[44:45], v9 offset:10240
ds_read_b64_tr_b16 a[46:47], v9 offset:11264
buffer_load_dwordx4 v14, s[12:15], s62 offen offset:3072 lds
v_sub_u32 v229, 24, v232
v_sub_u32 v230, 25, v232
v_sub_u32 v231, 26, v232
v_ashrrev_i32 v216, 31, v216
s_waitcnt lgkmcnt(10)
v_mfma_f32_32x32x16_bf16 v[136:151], a[16:19], v[80:83], v[136:151]
ds_read_b64_tr_b16 a[40:41], v8 offset:10240
ds_read_b64_tr_b16 a[42:43], v8 offset:11264
v_ashrrev_i32 v217, 31, v217
v_ashrrev_i32 v218, 31, v218
v_ashrrev_i32 v219, 31, v219
v_ashrrev_i32 v220, 31, v220
s_waitcnt lgkmcnt(10)
v_mfma_f32_32x32x16_bf16 v[152:167], a[28:31], v[84:87], v[152:167]
ds_read_b64_tr_b16 a[52:53], v9 offset:12288
ds_read_b64_tr_b16 a[54:55], v9 offset:13312
ds_read_b64_tr_b16 a[48:49], v8 offset:12288
s_add_u32 m0, s56, 8192
s_add_u32 s62, s58, 65536
buffer_load_dwordx4 v11, s[12:15], s62 offen offset:0 lds
v_ashrrev_i32 v221, 31, v221
v_ashrrev_i32 v222, 31, v222
v_ashrrev_i32 v223, 31, v223
v_ashrrev_i32 v224, 31, v224
s_waitcnt lgkmcnt(11)
v_mfma_f32_32x32x16_bf16 v[136:151], a[24:27], v[84:87], v[136:151]
ds_read_b64_tr_b16 a[50:51], v8 offset:13312
ds_read_b64_tr_b16 a[60:61], v9 offset:14336
ds_read_b64_tr_b16 a[62:63], v9 offset:15360
v_ashrrev_i32 v225, 31, v225
v_ashrrev_i32 v226, 31, v226
v_ashrrev_i32 v227, 31, v227
v_ashrrev_i32 v228, 31, v228
s_waitcnt lgkmcnt(12)
v_mfma_f32_32x32x16_bf16 v[152:167], a[36:39], v[88:91], v[152:167]
ds_read_b64_tr_b16 a[56:57], v8 offset:14336
ds_read_b64_tr_b16 a[58:59], v8 offset:15360
buffer_load_dwordx4 v12, s[12:15], s62 offen offset:1024 lds
v_ashrrev_i32 v229, 31, v229
v_ashrrev_i32 v230, 31, v230
v_ashrrev_i32 v231, 31, v231
v_bfi_b32 v56, s94, v216, v217
v_bfi_b32 v57, s94, v218, v219
s_waitcnt lgkmcnt(12)
v_mfma_f32_32x32x16_bf16 v[136:151], a[32:35], v[88:91], v[136:151]
ds_read_b64_tr_b16 a[68:69], v9 offset:16384
ds_read_b64_tr_b16 a[70:71], v9 offset:17408
ds_read_b64_tr_b16 a[64:65], v8 offset:16384
v_bfi_b32 v58, s94, v220, v221
v_bfi_b32 v59, s94, v222, v223
v_bfi_b32 v60, s94, v224, v225
v_bfi_b32 v61, s94, v226, v227
s_waitcnt lgkmcnt(13)
v_mfma_f32_32x32x16_bf16 v[152:167], a[44:47], v[92:95], v[152:167]
ds_read_b64_tr_b16 a[66:67], v8 offset:17408
ds_read_b64_tr_b16 a[76:77], v9 offset:18432
ds_read_b64_tr_b16 a[78:79], v9 offset:19456
buffer_load_dwordx4 v13, s[12:15], s62 offen offset:2048 lds
v_bfi_b32 v62, s94, v228, v229
v_bfi_b32 v63, s94, v230, v231
s_lshl_b32 s65, s49, 12
s_lshl_b32 s64, s48, 10
s_waitcnt lgkmcnt(14)
v_mfma_f32_32x32x16_bf16 v[136:151], a[40:43], v[92:95], v[136:151]
ds_read_b64_tr_b16 a[72:73], v8 offset:18432
ds_read_b64_tr_b16 a[74:75], v8 offset:19456
s_add_u32 s65, s65, 150528
s_add_u32 s65, s65, s64
s_add_u32 s66, s65, s64
v_add_u32 v232, s65, v1
s_waitcnt lgkmcnt(14)
v_mfma_f32_32x32x16_bf16 v[152:167], a[52:55], v[96:99], v[152:167]
ds_read_b64_tr_b16 a[84:85], v9 offset:20480
ds_read_b64_tr_b16 a[86:87], v9 offset:21504
ds_read_b64_tr_b16 a[80:81], v8 offset:20480
buffer_load_dwordx4 v14, s[12:15], s62 offen offset:3072 lds
v_add_u32 v233, s66, v1
s_mov_b32 s98, 0x3f803f80
v_accvgpr_write_b32 a128, s98
v_accvgpr_write_b32 a129, s98
s_waitcnt lgkmcnt(15)
v_mfma_f32_32x32x16_bf16 v[136:151], a[48:51], v[96:99], v[136:151]
ds_read_b64_tr_b16 a[82:83], v8 offset:21504
ds_read_b64_tr_b16 a[92:93], v9 offset:22528
ds_read_b64_tr_b16 a[94:95], v9 offset:23552
v_accvgpr_write_b32 a130, s98
v_accvgpr_write_b32 a131, s98
v_accvgpr_write_b32 a132, s98
v_accvgpr_write_b32 a133, s98
s_waitcnt lgkmcnt(15)
v_mfma_f32_32x32x16_bf16 v[152:167], a[60:63], v[100:103], v[152:167]
ds_read_b64_tr_b16 a[88:89], v8 offset:22528
ds_read_b64_tr_b16 a[90:91], v8 offset:23552
s_add_u32 m0, s56, 12288
s_add_u32 s62, s58, 98304
buffer_load_dwordx4 v11, s[12:15], s62 offen offset:0 lds
v_accvgpr_write_b32 a134, s98
v_accvgpr_write_b32 a135, s98
v_accvgpr_write_b32 a136, s98
v_accvgpr_write_b32 a137, s98
s_waitcnt lgkmcnt(15)
v_mfma_f32_32x32x16_bf16 v[136:151], a[56:59], v[100:103], v[136:151]
ds_read_b64_tr_b16 a[100:101], v9 offset:24576
ds_read_b64_tr_b16 a[102:103], v9 offset:25600
ds_read_b64_tr_b16 a[96:97], v8 offset:24576
v_accvgpr_write_b32 a138, s98
v_accvgpr_write_b32 a139, s98
v_accvgpr_write_b32 a140, s98
v_accvgpr_write_b32 a141, s98
s_waitcnt lgkmcnt(15)
v_mfma_f32_32x32x16_bf16 v[152:167], a[68:71], v[104:107], v[152:167]
ds_read_b64_tr_b16 a[98:99], v8 offset:25600
ds_read_b64_tr_b16 a[108:109], v9 offset:26624
ds_read_b64_tr_b16 a[110:111], v9 offset:27648
buffer_load_dwordx4 v12, s[12:15], s62 offen offset:1024 lds
v_accvgpr_write_b32 a142, s98
v_accvgpr_write_b32 a143, s98
v_accvgpr_write_b32 a144, s98
v_accvgpr_write_b32 a145, s98
v_accvgpr_write_b32 a146, s98
v_mfma_f32_32x32x16_bf16 v[136:151], a[64:67], v[104:107], v[136:151]
ds_read_b64_tr_b16 a[104:105], v8 offset:26624
ds_read_b64_tr_b16 a[106:107], v8 offset:27648
v_accvgpr_write_b32 a147, s98
v_accvgpr_write_b32 a148, s98
v_accvgpr_write_b32 a149, s98
v_accvgpr_write_b32 a150, s98
s_waitcnt lgkmcnt(15)
v_mfma_f32_32x32x16_bf16 v[152:167], a[76:79], v[108:111], v[152:167]
ds_read_b64_tr_b16 a[116:117], v9 offset:28672
ds_read_b64_tr_b16 a[118:119], v9 offset:29696
ds_read_b64_tr_b16 a[112:113], v8 offset:28672
buffer_load_dwordx4 v13, s[12:15], s62 offen offset:2048 lds
v_accvgpr_write_b32 a151, s98
v_accvgpr_write_b32 a152, s98
v_accvgpr_write_b32 a153, s98
v_accvgpr_write_b32 a154, s98
v_mfma_f32_32x32x16_bf16 v[136:151], a[72:75], v[108:111], v[136:151]
ds_read_b64_tr_b16 a[114:115], v8 offset:29696
ds_read_b64_tr_b16 a[124:125], v9 offset:30720
ds_read_b64_tr_b16 a[126:127], v9 offset:31744
v_accvgpr_write_b32 a155, s98
v_accvgpr_write_b32 a156, s98
v_accvgpr_write_b32 a157, s98
v_accvgpr_write_b32 a158, s98
s_waitcnt lgkmcnt(15)
v_mfma_f32_32x32x16_bf16 v[152:167], a[84:87], v[112:115], v[152:167]
ds_read_b64_tr_b16 a[120:121], v8 offset:30720
ds_read_b64_tr_b16 a[122:123], v8 offset:31744
buffer_load_dwordx4 v14, s[12:15], s62 offen offset:3072 lds
v_accvgpr_write_b32 a159, s98
v_accvgpr_write_b32 a160, s98
v_accvgpr_write_b32 a161, s98
v_accvgpr_write_b32 a162, s98
v_mfma_f32_32x32x16_bf16 v[136:151], a[80:83], v[112:115], v[136:151]
v_accvgpr_write_b32 a163, s98
v_accvgpr_write_b32 a164, s98
v_accvgpr_write_b32 a165, s98
v_accvgpr_write_b32 a166, s98
v_mfma_f32_32x32x16_bf16 v[152:167], a[92:95], v[116:119], v[152:167]
s_add_u32 s63, s3, 32
v_mov_b32 v37, s63
s_waitcnt vmcnt(11)
buffer_store_dword v37, v27, s[32:35], s75 offen sc1
s_barrier
v_accvgpr_write_b32 a167, s98
v_accvgpr_write_b32 a168, s98
v_accvgpr_write_b32 a169, s98
v_accvgpr_write_b32 a170, s98
s_waitcnt lgkmcnt(15)
v_mfma_f32_32x32x16_bf16 v[136:151], a[88:91], v[116:119], v[136:151]
v_accvgpr_write_b32 a171, s98
v_accvgpr_write_b32 a172, s98
v_accvgpr_write_b32 a173, s98
v_accvgpr_write_b32 a174, s98
v_bfe_u32 v184, v0, 4, 1
v_and_b32 v185, 7, v0
s_waitcnt lgkmcnt(14)
v_mfma_f32_32x32x16_bf16 v[152:167], a[100:103], v[120:123], v[152:167]
v_accvgpr_write_b32 a175, s98
v_accvgpr_write_b32 a176, s98
v_accvgpr_write_b32 a177, s98
v_accvgpr_write_b32 a178, s98
v_accvgpr_write_b32 a179, s98
v_lshlrev_b32 v184, 14, v184
s_waitcnt lgkmcnt(12)
v_mfma_f32_32x32x16_bf16 v[136:151], a[96:99], v[120:123], v[136:151]
v_accvgpr_write_b32 a180, s98
v_accvgpr_write_b32 a181, s98
v_accvgpr_write_b32 a182, s98
v_accvgpr_write_b32 a183, s98
v_bfe_u32 v186, v0, 3, 1
s_waitcnt lgkmcnt(10)
v_mfma_f32_32x32x16_bf16 v[152:167], a[108:111], v[124:127], v[152:167]
v_accvgpr_write_b32 a184, s98
v_accvgpr_write_b32 a185, s98
v_accvgpr_write_b32 a186, s98
v_accvgpr_write_b32 a187, s98
v_and_or_b32 v184, v0, 15, v184
v_lshlrev_b32 v185, 7, v185
s_waitcnt lgkmcnt(8)
v_mfma_f32_32x32x16_bf16 v[136:151], a[104:107], v[124:127], v[136:151]
v_accvgpr_write_b32 a188, s98
v_accvgpr_write_b32 a189, s98
v_accvgpr_write_b32 a190, s98
v_accvgpr_write_b32 a191, s98
v_lshlrev_b32 v184, 7, v184
s_waitcnt lgkmcnt(6)
v_mfma_f32_32x32x16_bf16 v[152:167], a[116:119], v[128:131], v[152:167]
v_accvgpr_write_b32 a192, s98
v_accvgpr_write_b32 a193, s98
v_accvgpr_write_b32 a194, s98
v_accvgpr_write_b32 a195, s98
s_sub_u32 s65, s68, s70
s_add_u32 s65, s65, 2097152
v_mad_u32_u24 v185, v186, s65, v185
s_waitcnt lgkmcnt(4)
v_mfma_f32_32x32x16_bf16 v[136:151], a[112:115], v[128:131], v[136:151]
s_add_u32 s65, s50, s55
s_add_u32 s65, s65, 4194304
buffer_load_dword v37, v184, s[32:35], s65 offen sc1
s_add_u32 s65, s50, s70
s_add_u32 s65, s65, 12582912
buffer_load_dword v37, v185, s[32:35], s65 offen sc1
v_accvgpr_write_b32 a196, s98
v_accvgpr_write_b32 a197, s98
v_accvgpr_write_b32 a198, s98
v_accvgpr_write_b32 a199, s98
s_waitcnt lgkmcnt(2)
v_mfma_f32_32x32x16_bf16 v[152:167], a[124:127], v[132:135], v[152:167]
buffer_load_dword v37, v28, s[32:35], s51 offen sc1
v_accvgpr_write_b32 a200, s98
v_accvgpr_write_b32 a201, s98
v_accvgpr_write_b32 a202, s98
v_accvgpr_write_b32 a203, s98
s_waitcnt lgkmcnt(0)
v_mfma_f32_32x32x16_bf16 v[136:151], a[120:123], v[132:135], v[136:151]
v_accvgpr_write_b32 a204, s98
v_accvgpr_write_b32 a205, s98
v_accvgpr_write_b32 a206, s98
v_accvgpr_write_b32 a207, s98
v_lshlrev_b32 v187, 7, v0
s_lshl2_add_u32 s65, s2, s6
s_mul_i32 s65, s65, 512
s_cmp_eq_u32 s7, 0
s_cselect_b64 exec, 15, 1
buffer_load_dword v37, v187, s[16:19], s65 offen
buffer_load_dword v37, v187, s[20:23], s65 offen
s_mov_b64 exec, -1
ds_write_b128 v23, v[152:155] offset:0
ds_write_b128 v23, v[156:159] offset:1024
ds_write_b128 v23, v[160:163] offset:2048
ds_write_b128 v23, v[164:167] offset:3072
s_cmp_eq_u32 s7, 0
s_cbranch_scc0 L_cj1
v_lshrrev_b32 v168, 2, v0
v_lshrrev_b32 v169, 4, v0
v_xor_b32 v168, v168, v169
v_and_b32 v168, 1, v168
v_add_u32 v168, -1, v168
v_and_b32 v168, 0x3f803f80, v168
v_mov_b32 v169, v168
v_mov_b32 v170, v168
v_mov_b32 v171, v168
s_nop 2
s_cmp_eq_u32 s48, 0
s_cbranch_scc0 L_cb2
v_mfma_f32_16x16x32_bf16 v[172:175], v[168:171], a[0:3], 0
v_mfma_f32_16x16x32_bf16 v[176:179], v[168:171], a[8:11], 0
v_mfma_f32_16x16x32_bf16 v[172:175], v[168:171], a[16:19], v[172:175]
v_mfma_f32_16x16x32_bf16 v[176:179], v[168:171], a[24:27], v[176:179]
v_mfma_f32_16x16x32_bf16 v[172:175], v[168:171], a[32:35], v[172:175]
v_mfma_f32_16x16x32_bf16 v[176:179], v[168:171], a[40:43], v[176:179]
v_mfma_f32_16x16x32_bf16 v[172:175], v[168:171], a[48:51], v[172:175]
v_mfma_f32_16x16x32_bf16 v[176:179], v[168:171], a[56:59], v[176:179]
v_mfma_f32_16x16x32_bf16 v[172:175], v[168:171], a[64:67], v[172:175]
v_mfma_f32_16x16x32_bf16 v[176:179], v[168:171], a[72:75], v[176:179]
v_mfma_f32_16x16x32_bf16 v[172:175], v[168:171], a[80:83], v[172:175]
v_mfma_f32_16x16x32_bf16 v[176:179], v[168:171], a[88:91], v[176:179]
v_mfma_f32_16x16x32_bf16 v[172:175], v[168:171], a[96:99], v[172:175]
v_mfma_f32_16x16x32_bf16 v[176:179], v[168:171], a[104:107], v[176:179]
v_mfma_f32_16x16x32_bf16 v[172:175], v[168:171], a[112:115], v[172:175]
v_mfma_f32_16x16x32_bf16 v[176:179], v[168:171], a[120:123], v[176:179]
s_nop 11
s_branch L_ce3
L_cb2:
v_mfma_f32_16x16x32_bf16 v[172:175], v[168:171], a[4:7], 0
v_mfma_f32_16x16x32_bf16 v[176:179], v[168:171], a[12:15], 0
v_mfma_f32_16x16x32_bf16 v[172:175], v[168:171], a[20:23], v[172:175]
v_mfma_f32_16x16x32_bf16 v[176:179], v[168:171], a[28:31], v[176:179]
v_mfma_f32_16x16x32_bf16 v[172:175], v[168:171], a[36:39], v[172:175]
v_mfma_f32_16x16x32_bf16 v[176:179], v[168:171], a[44:47], v[176:179]
v_mfma_f32_16x16x32_bf16 v[172:175], v[168:171], a[52:55], v[172:175]
v_mfma_f32_16x16x32_bf16 v[176:179], v[168:171], a[60:63], v[176:179]
v_mfma_f32_16x16x32_bf16 v[172:175], v[168:171], a[68:71], v[172:175]
v_mfma_f32_16x16x32_bf16 v[176:179], v[168:171], a[76:79], v[176:179]
v_mfma_f32_16x16x32_bf16 v[172:175], v[168:171], a[84:87], v[172:175]
v_mfma_f32_16x16x32_bf16 v[176:179], v[168:171], a[92:95], v[176:179]
v_mfma_f32_16x16x32_bf16 v[172:175], v[168:171], a[100:103], v[172:175]
v_mfma_f32_16x16x32_bf16 v[176:179], v[168:171], a[108:111], v[176:179]
v_mfma_f32_16x16x32_bf16 v[172:175], v[168:171], a[116:119], v[172:175]
v_mfma_f32_16x16x32_bf16 v[176:179], v[168:171], a[124:127], v[176:179]
s_nop 11
L_ce3:
v_add_f32 v172, v172, v176
s_mov_b32 exec_hi, 0
ds_add_f32 v26, v172 offset:512
s_mov_b32 exec_hi, -1
L_cj1:
s_waitcnt lgkmcnt(0)
s_barrier
ds_read_b128 v[184:187], v25 offset:512
ds_read_b128 v[188:191], v25 offset:544
ds_read_b128 v[192:195], v25 offset:576
ds_read_b128 v[196:199], v25 offset:608
ds_read_b128 v[168:171], v24 offset:0
ds_read_b128 v[172:175], v24 offset:1024
ds_read_b128 v[176:179], v24 offset:2048
ds_read_b128 v[180:183], v24 offset:3072
s_waitcnt lgkmcnt(7)
v_pk_fma_f32 v[136:137], v[184:185], v[34:35], v[136:137] op_sel_hi:[1,0,1]
v_pk_fma_f32 v[138:139], v[186:187], v[34:35], v[138:139] op_sel_hi:[1,0,1]
s_waitcnt lgkmcnt(6)
v_pk_fma_f32 v[140:141], v[188:189], v[34:35], v[140:141] op_sel_hi:[1,0,1]
v_pk_fma_f32 v[142:143], v[190:191], v[34:35], v[142:143] op_sel_hi:[1,0,1]
s_waitcnt lgkmcnt(5)
v_pk_fma_f32 v[144:145], v[192:193], v[34:35], v[144:145] op_sel_hi:[1,0,1]
v_pk_fma_f32 v[146:147], v[194:195], v[34:35], v[146:147] op_sel_hi:[1,0,1]
s_waitcnt lgkmcnt(4)
v_pk_fma_f32 v[148:149], v[196:197], v[34:35], v[148:149] op_sel_hi:[1,0,1]
v_pk_fma_f32 v[150:151], v[198:199], v[34:35], v[150:151] op_sel_hi:[1,0,1]
buffer_load_dword v37, v29, s[32:35], 0 offen sc1
s_waitcnt lgkmcnt(3)
v_pk_add_f32 v[136:137], v[136:137], v[168:169]
v_pk_add_f32 v[138:139], v[138:139], v[170:171]
s_waitcnt lgkmcnt(2)
v_pk_add_f32 v[140:141], v[140:141], v[172:173]
v_pk_add_f32 v[142:143], v[142:143], v[174:175]
s_waitcnt lgkmcnt(1)
v_pk_add_f32 v[144:145], v[144:145], v[176:177]
v_pk_add_f32 v[146:147], v[146:147], v[178:179]
s_waitcnt lgkmcnt(0)
v_pk_add_f32 v[148:149], v[148:149], v[180:181]
v_pk_add_f32 v[150:151], v[150:151], v[182:183]
v_pk_mul_f32 v[136:137], v[136:137], v[36:37] op_sel_hi:[1,0]
v_pk_mul_f32 v[138:139], v[138:139], v[36:37] op_sel_hi:[1,0]
v_pk_mul_f32 v[140:141], v[140:141], v[36:37] op_sel_hi:[1,0]
v_pk_mul_f32 v[142:143], v[142:143], v[36:37] op_sel_hi:[1,0]
v_pk_mul_f32 v[144:145], v[144:145], v[36:37] op_sel_hi:[1,0]
v_pk_mul_f32 v[146:147], v[146:147], v[36:37] op_sel_hi:[1,0]
v_pk_mul_f32 v[148:149], v[148:149], v[36:37] op_sel_hi:[1,0]
v_pk_mul_f32 v[150:151], v[150:151], v[36:37] op_sel_hi:[1,0]
v_cvt_pk_bf16_f32 v248, v136, v137
v_cvt_pk_bf16_f32 v249, v138, v139
v_cvt_pk_bf16_f32 v250, v140, v141
v_cvt_pk_bf16_f32 v251, v142, v143
v_cvt_pk_bf16_f32 v252, v144, v145
v_cvt_pk_bf16_f32 v253, v146, v147
v_cvt_pk_bf16_f32 v254, v148, v149
v_cvt_pk_bf16_f32 v255, v150, v151
ds_write_b128 v232, v[248:251]
ds_write_b128 v232, v[252:255] offset:2048
s_waitcnt vmcnt(7)
s_waitcnt lgkmcnt(0)
s_barrier
ds_read_b128 v[112:115], v233
ds_read_b128 v[116:119], v233 offset:1024
s_add_u32 s63, s52, 32
s_waitcnt vmcnt(0)
v_cmp_gt_u32 vcc, s63, v37
s_cbranch_vccnz L_pl4
L_pd5:
buffer_load_dwordx4 v[104:107], v1, s[32:35], s84 offen sc1
buffer_load_dwordx4 v[72:75], v64, s[32:35], s76 offen sc1
buffer_load_dwordx4 v[108:111], v1, s[32:35], s85 offen sc1
ds_read_b64_tr_b16 a[4:5], v7 offset:0
ds_read_b64_tr_b16 a[6:7], v7 offset:1024
ds_read_b64_tr_b16 a[0:1], v6 offset:0
ds_read_b64_tr_b16 a[2:3], v6 offset:1024
ds_read_b64_tr_b16 a[12:13], v7 offset:2048
ds_read_b64_tr_b16 a[14:15], v7 offset:3072
ds_read_b64_tr_b16 a[8:9], v6 offset:2048
ds_read_b64_tr_b16 a[10:11], v6 offset:3072
buffer_load_dwordx4 v[76:79], v64, s[32:35], s77 offen sc1
ds_read_b64_tr_b16 a[20:21], v7 offset:4096
ds_read_b64_tr_b16 a[22:23], v7 offset:5120
ds_read_b64_tr_b16 a[16:17], v6 offset:4096
ds_read_b64_tr_b16 a[18:19], v6 offset:5120
ds_read_b64_tr_b16 a[28:29], v7 offset:6144
ds_read_b64_tr_b16 a[30:31], v7 offset:7168
ds_read_b64_tr_b16 a[24:25], v6 offset:6144
ds_read_b64_tr_b16 a[26:27], v6 offset:7168
buffer_load_dwordx4 v[80:83], v65, s[32:35], s78 offen sc1
ds_read_b64_tr_b16 a[36:37], v7 offset:8192
ds_read_b64_tr_b16 a[38:39], v7 offset:9216
ds_read_b64_tr_b16 a[32:33], v6 offset:8192
ds_read_b64_tr_b16 a[34:35], v6 offset:9216
ds_read_b64_tr_b16 a[44:45], v7 offset:10240
ds_read_b64_tr_b16 a[46:47], v7 offset:11264
ds_read_b64_tr_b16 a[40:41], v6 offset:10240
ds_read_b64_tr_b16 a[42:43], v6 offset:11264
buffer_load_dwordx4 v[84:87], v65, s[32:35], s79 offen sc1
ds_read_b64_tr_b16 a[52:53], v7 offset:12288
ds_read_b64_tr_b16 a[54:55], v7 offset:13312
ds_read_b64_tr_b16 a[48:49], v6 offset:12288
ds_read_b64_tr_b16 a[50:51], v6 offset:13312
ds_read_b64_tr_b16 a[60:61], v7 offset:14336
ds_read_b64_tr_b16 a[62:63], v7 offset:15360
ds_read_b64_tr_b16 a[56:57], v6 offset:14336
ds_read_b64_tr_b16 a[58:59], v6 offset:15360
buffer_load_dwordx4 v[88:91], v66, s[32:35], s80 offen sc1
ds_read_b64_tr_b16 a[68:69], v7 offset:16384
ds_read_b64_tr_b16 a[70:71], v7 offset:17408
ds_read_b64_tr_b16 a[64:65], v6 offset:16384
ds_read_b64_tr_b16 a[66:67], v6 offset:17408
ds_read_b64_tr_b16 a[76:77], v7 offset:18432
ds_read_b64_tr_b16 a[78:79], v7 offset:19456
ds_read_b64_tr_b16 a[72:73], v6 offset:18432
ds_read_b64_tr_b16 a[74:75], v6 offset:19456
buffer_load_dwordx4 v[92:95], v66, s[32:35], s81 offen sc1
ds_read_b64_tr_b16 a[84:85], v7 offset:20480
ds_read_b64_tr_b16 a[86:87], v7 offset:21504
ds_read_b64_tr_b16 a[80:81], v6 offset:20480
ds_read_b64_tr_b16 a[82:83], v6 offset:21504
ds_read_b64_tr_b16 a[92:93], v7 offset:22528
ds_read_b64_tr_b16 a[94:95], v7 offset:23552
ds_read_b64_tr_b16 a[88:89], v6 offset:22528
ds_read_b64_tr_b16 a[90:91], v6 offset:23552
buffer_load_dwordx4 v[96:99], v67, s[32:35], s82 offen sc1
ds_read_b64_tr_b16 a[100:101], v7 offset:24576
ds_read_b64_tr_b16 a[102:103], v7 offset:25600
ds_read_b64_tr_b16 a[96:97], v6 offset:24576
ds_read_b64_tr_b16 a[98:99], v6 offset:25600
ds_read_b64_tr_b16 a[108:109], v7 offset:26624
ds_read_b64_tr_b16 a[110:111], v7 offset:27648
ds_read_b64_tr_b16 a[104:105], v6 offset:26624
ds_read_b64_tr_b16 a[106:107], v6 offset:27648
buffer_load_dwordx4 v[100:103], v67, s[32:35], s83 offen sc1
ds_read_b64_tr_b16 a[116:117], v7 offset:28672
ds_read_b64_tr_b16 a[118:119], v7 offset:29696
ds_read_b64_tr_b16 a[112:113], v6 offset:28672
ds_read_b64_tr_b16 a[114:115], v6 offset:29696
ds_read_b64_tr_b16 a[124:125], v7 offset:30720
ds_read_b64_tr_b16 a[126:127], v7 offset:31744
ds_read_b64_tr_b16 a[120:121], v6 offset:30720
ds_read_b64_tr_b16 a[122:123], v6 offset:31744
s_waitcnt vmcnt(9) lgkmcnt(15)
v_mfma_f32_32x32x16_bf16 v[168:183], v[104:107], v[112:115], 0
s_mov_b64 exec, s[86:87]
buffer_load_dwordx4 a[136:139], v68, s[32:35], s77 offen offset:0 sc1
buffer_load_dwordx4 a[140:143], v68, s[32:35], s77 offen offset:1024 sc1
s_mov_b64 exec, -1
s_waitcnt vmcnt(10)
v_mfma_f32_32x32x16_bf16 v[136:151], v[72:75], v[112:115], 0
s_waitcnt vmcnt(9)
v_mfma_f32_32x32x16_bf16 v[232:247], v[108:111], v[116:119], 0
s_waitcnt vmcnt(8)
v_mfma_f32_32x32x16_bf16 v[152:167], v[76:79], v[116:119], 0
v_mfma_f32_32x32x16_bf16 v[184:199], v[76:79], v[112:115], 0
s_waitcnt vmcnt(7)
v_mfma_f32_32x32x16_bf16 v[200:215], v[80:83], v[112:115], 0
s_nop 4
v_bfi_b32 v168, v216, v168, v136
s_lshl_b32 s63, s97, 2
s_load_dwordx2 s[0:1], s[16:17], s63 offset:444
s_load_dwordx2 s[0:1], s[16:17], s63 offset:1468
s_load_dwordx2 s[0:1], s[16:17], s63 offset:2492
s_load_dwordx2 s[0:1], s[16:17], s63 offset:3516
v_bfi_b32 v169, v217, v169, v137
v_bfi_b32 v170, v218, v170, v138
v_bfi_b32 v171, v219, v171, v139
v_bfi_b32 v172, v220, v172, v140
v_bfi_b32 v173, v221, v173, v141
v_bfi_b32 v174, v222, v174, v142
v_bfi_b32 v175, v223, v175, v143
v_bfi_b32 v176, v224, v176, v144
v_bfi_b32 v177, v225, v177, v145
v_bfi_b32 v178, v226, v178, v146
v_bfi_b32 v179, v227, v179, v147
v_bfi_b32 v180, v228, v180, v148
s_mov_b64 exec, s[88:89]
buffer_load_dwordx4 a[144:147], v69, s[32:35], s78 offen offset:0 sc1
buffer_load_dwordx4 a[148:151], v69, s[32:35], s78 offen offset:1024 sc1
s_mov_b64 exec, -1
v_bfi_b32 v181, v229, v181, v149
v_bfi_b32 v182, v230, v182, v150
v_bfi_b32 v183, v231, v183, v151
v_mfma_f32_32x32x16_bf16 v[136:151], v[80:83], v[116:119], 0
v_max_f32 v248, v168, v169
v_max_f32 v249, v170, v171
v_max3_f32 v248, v172, v173, v248
v_max3_f32 v249, v174, v175, v249
v_max3_f32 v248, v176, v177, v248
v_max3_f32 v249, v178, v179, v249
v_max3_f32 v248, v180, v181, v248
v_max3_f32 v249, v182, v183, v249
v_bfi_b32 v232, v216, v232, v152
v_bfi_b32 v233, v217, v233, v153
v_bfi_b32 v234, v218, v234, v154
v_bfi_b32 v235, v219, v235, v155
v_bfi_b32 v236, v220, v236, v156
v_bfi_b32 v237, v221, v237, v157
v_bfi_b32 v238, v222, v238, v158
s_mov_b64 exec, s[88:89]
buffer_load_dwordx4 a[152:155], v69, s[32:35], s79 offen offset:0 sc1
buffer_load_dwordx4 a[156:159], v69, s[32:35], s79 offen offset:1024 sc1
s_mov_b64 exec, -1
v_bfi_b32 v239, v223, v239, v159
v_bfi_b32 v240, v224, v240, v160
v_bfi_b32 v241, v225, v241, v161
v_bfi_b32 v242, v226, v242, v162
v_bfi_b32 v243, v227, v243, v163
v_bfi_b32 v244, v228, v244, v164
v_bfi_b32 v245, v229, v245, v165
v_bfi_b32 v246, v230, v246, v166
v_bfi_b32 v247, v231, v247, v167
s_waitcnt vmcnt(10)
v_mfma_f32_32x32x16_bf16 v[152:167], v[84:87], v[112:115], 0
v_max_f32 v250, v232, v233
v_max_f32 v251, v234, v235
v_max3_f32 v250, v236, v237, v250
v_max3_f32 v251, v238, v239, v251
v_max3_f32 v250, v240, v241, v250
v_max3_f32 v251, v242, v243, v251
v_max3_f32 v250, v244, v245, v250
v_max3_f32 v251, v246, v247, v251
s_mov_b64 exec, s[90:91]
buffer_load_dwordx4 a[160:163], v70, s[32:35], s80 offen offset:0 sc1
buffer_load_dwordx4 a[164:167], v70, s[32:35], s80 offen offset:1024 sc1
s_mov_b64 exec, -1
v_max3_f32 v248, v184, v185, v248
v_max3_f32 v249, v186, v187, v249
v_max3_f32 v248, v188, v189, v248
v_max3_f32 v249, v190, v191, v249
v_max3_f32 v248, v192, v193, v248
v_max3_f32 v249, v194, v195, v249
v_max3_f32 v248, v196, v197, v248
v_max3_f32 v249, v198, v199, v249
v_mfma_f32_32x32x16_bf16 v[184:199], v[84:87], v[116:119], 0
v_max3_f32 v248, v200, v201, v248
v_max3_f32 v249, v202, v203, v249
v_max3_f32 v248, v204, v205, v248
v_max3_f32 v249, v206, v207, v249
v_max3_f32 v248, v208, v209, v248
v_max3_f32 v249, v210, v211, v249
v_max3_f32 v248, v212, v213, v248
v_max3_f32 v249, v214, v215, v249
s_waitcnt vmcnt(11)
v_mfma_f32_32x32x16_bf16 v[200:215], v[88:91], v[112:115], 0
v_max3_f32 v250, v136, v137, v250
s_mov_b64 exec, s[90:91]
buffer_load_dwordx4 a[168:171], v70, s[32:35], s81 offen offset:0 sc1
buffer_load_dwordx4 a[172:175], v70, s[32:35], s81 offen offset:1024 sc1
s_mov_b64 exec, -1
v_max3_f32 v251, v138, v139, v251
v_max3_f32 v250, v140, v141, v250
v_max3_f32 v251, v142, v143, v251
v_max3_f32 v250, v144, v145, v250
v_max3_f32 v251, v146, v147, v251
v_max3_f32 v250, v148, v149, v250
v_max3_f32 v251, v150, v151, v251
v_mfma_f32_32x32x16_bf16 v[136:151], v[88:91], v[116:119], 0
v_max3_f32 v248, v152, v153, v248
v_max3_f32 v249, v154, v155, v249
v_max3_f32 v248, v156, v157, v248
v_max3_f32 v249, v158, v159, v249
v_max3_f32 v248, v160, v161, v248
v_max3_f32 v249, v162, v163, v249
v_max3_f32 v248, v164, v165, v248
v_max3_f32 v249, v166, v167, v249
s_waitcnt vmcnt(12)
v_mfma_f32_32x32x16_bf16 v[152:167], v[92:95], v[112:115], 0
v_max3_f32 v250, v184, v185, v250
v_max3_f32 v251, v186, v187, v251
s_mov_b64 exec, s[92:93]
buffer_load_dwordx4 a[176:179], v71, s[32:35], s82 offen offset:0 sc1
buffer_load_dwordx4 a[180:183], v71, s[32:35], s82 offen offset:1024 sc1
s_mov_b64 exec, -1
v_max3_f32 v250, v188, v189, v250
v_max3_f32 v251, v190, v191, v251
v_max3_f32 v250, v192, v193, v250
v_max3_f32 v251, v194, v195, v251
v_max3_f32 v250, v196, v197, v250
v_max3_f32 v251, v198, v199, v251
v_mfma_f32_32x32x16_bf16 v[184:199], v[92:95], v[116:119], 0
v_max3_f32 v248, v200, v201, v248
v_max3_f32 v249, v202, v203, v249
v_max3_f32 v248, v204, v205, v248
v_max3_f32 v249, v206, v207, v249
v_max3_f32 v248, v208, v209, v248
v_max3_f32 v249, v210, v211, v249
v_max3_f32 v248, v212, v213, v248
v_max3_f32 v249, v214, v215, v249
s_waitcnt vmcnt(13)
v_mfma_f32_32x32x16_bf16 v[200:215], v[96:99], v[112:115], 0
v_max3_f32 v250, v136, v137, v250
v_max3_f32 v251, v138, v139, v251
s_mov_b64 exec, s[92:93]
buffer_load_dwordx4 a[184:187], v71, s[32:35], s83 offen offset:0 sc1
buffer_load_dwordx4 a[188:191], v71, s[32:35], s83 offen offset:1024 sc1
s_mov_b64 exec, -1
v_max3_f32 v250, v140, v141, v250
v_max3_f32 v251, v142, v143, v251
v_max3_f32 v250, v144, v145, v250
v_max3_f32 v251, v146, v147, v251
v_max3_f32 v250, v148, v149, v250
v_max3_f32 v251, v150, v151, v251
v_mfma_f32_32x32x16_bf16 v[136:151], v[96:99], v[116:119], 0
v_max3_f32 v248, v152, v153, v248
v_max3_f32 v249, v154, v155, v249
v_max3_f32 v248, v156, v157, v248
v_max3_f32 v249, v158, v159, v249
v_max3_f32 v248, v160, v161, v248
v_max3_f32 v249, v162, v163, v249
v_max3_f32 v248, v164, v165, v248
v_max3_f32 v249, v166, v167, v249
s_waitcnt vmcnt(14)
v_mfma_f32_32x32x16_bf16 v[152:167], v[100:103], v[112:115], 0
v_max3_f32 v250, v184, v185, v250
v_max3_f32 v251, v186, v187, v251
v_max3_f32 v250, v188, v189, v250
s_mov_b64 exec, s[86:87]
buffer_load_dwordx4 a[128:131], v68, s[32:35], s76 offen offset:0 sc1
buffer_load_dwordx4 a[132:135], v68, s[32:35], s76 offen offset:1024 sc1
s_mov_b64 exec, -1
v_max3_f32 v251, v190, v191, v251
v_max3_f32 v250, v192, v193, v250
v_max3_f32 v251, v194, v195, v251
v_max3_f32 v250, v196, v197, v250
v_max3_f32 v251, v198, v199, v251
v_mfma_f32_32x32x16_bf16 v[184:199], v[100:103], v[116:119], 0
v_max3_f32 v248, v200, v201, v248
v_max3_f32 v249, v202, v203, v249
v_max3_f32 v248, v204, v205, v248
v_max3_f32 v249, v206, v207, v249
v_max3_f32 v248, v208, v209, v248
v_max3_f32 v249, v210, v211, v249
v_max3_f32 v248, v212, v213, v248
v_max3_f32 v249, v214, v215, v249
v_mfma_f32_32x32x16_bf16 v[200:215], v[104:107], v[116:119], 0
v_max3_f32 v250, v136, v137, v250
v_max3_f32 v251, v138, v139, v251
v_max3_f32 v250, v140, v141, v250
s_mov_b64 exec, s[94:95]
buffer_load_dwordx4 a[192:195], v33, s[32:35], s84 offen offset:0 sc1
buffer_load_dwordx4 a[196:199], v33, s[32:35], s84 offen offset:1024 sc1
s_mov_b64 exec, -1
v_max3_f32 v251, v142, v143, v251
v_max3_f32 v250, v144, v145, v250
v_max3_f32 v251, v146, v147, v251
v_max3_f32 v250, v148, v149, v250
v_max3_f32 v251, v150, v151, v251
v_max3_f32 v248, v152, v153, v248
v_max3_f32 v249, v154, v155, v249
v_max3_f32 v248, v156, v157, v248
v_max3_f32 v249, v158, v159, v249
v_max3_f32 v248, v160, v161, v248
v_max3_f32 v249, v162, v163, v249
v_max3_f32 v248, v164, v165, v248
v_max3_f32 v249, v166, v167, v249
v_max3_f32 v250, v184, v185, v250
v_max3_f32 v251, v186, v187, v251
v_max3_f32 v250, v188, v189, v250
v_max3_f32 v251, v190, v191, v251
v_max3_f32 v250, v192, v193, v250
v_max3_f32 v251, v194, v195, v251
s_mov_b64 exec, s[94:95]
buffer_load_dwordx4 a[200:203], v33, s[32:35], s85 offen offset:0 sc1
buffer_load_dwordx4 a[204:207], v33, s[32:35], s85 offen offset:1024 sc1
s_mov_b64 exec, -1
v_max3_f32 v250, v196, v197, v250
v_max3_f32 v251, v198, v199, v251
v_max3_f32 v250, v200, v201, v250
v_max3_f32 v251, v202, v203, v251
v_max3_f32 v250, v204, v205, v250
v_max3_f32 v251, v206, v207, v251
v_max3_f32 v250, v208, v209, v250
v_max3_f32 v251, v210, v211, v251
v_max3_f32 v250, v212, v213, v250
v_max3_f32 v251, v214, v215, v251
v_max_f32 v248, v248, v249
v_mov_b32 v249, v248
v_max_f32 v250, v250, v251
v_mov_b32 v251, v250
v_permlane32_swap_b32 v248, v249
v_max_f32 v248, v248, v249
v_permlane32_swap_b32 v250, v251
v_max_f32 v250, v250, v251
s_waitcnt lgkmcnt(0)
s_barrier
v_and_b32 v123, 7, v0
v_add_lshl_u32 v123, v123, 8, 9
buffer_load_dword v124, v123, s[32:35], s51 offen sc1
v_lshlrev_b32 v126, 7, v0
s_lshl2_add_u32 s65, s2, s6
s_mul_i32 s65, s65, 1792
s_cmp_eq_u32 s7, 0
s_cselect_b64 exec, 16383, 1
buffer_load_dword v37, v126, s[24:27], s65 offen
buffer_load_dword v37, v126, s[28:31], s65 offen
s_mov_b64 exec, -1
v_mul_f32 v184, -1.0, v248
s_lshl_b32 s63, s97, 2
s_load_dwordx2 s[0:1], s[20:21], s63 offset:444
s_load_dwordx2 s[0:1], s[20:21], s63 offset:1468
s_load_dwordx2 s[0:1], s[20:21], s63 offset:2492
s_load_dwordx2 s[0:1], s[20:21], s63 offset:3516
v_mov_b32 v185, v184
v_mov_b32 v186, v184
v_mov_b32 v187, v184
s_lshl_b32 s64, s7, 30
v_or_b32 v15, s64, v15
v_or_b32 v16, s64, v16
v_or_b32 v17, s64, v17
v_or_b32 v18, s64, v18
v_mov_b32 v188, v184
v_mov_b32 v189, v184
v_mov_b32 v190, v184
v_mov_b32 v191, v184
v_mov_b32 v192, v184
v_mov_b32 v193, v184
v_mov_b32 v194, v184
v_mov_b32 v195, v184
v_mov_b32 v196, v184
v_mov_b32 v197, v184
v_mov_b32 v198, v184
v_mov_b32 v199, v184
s_nop 1
v_mfma_f32_32x32x16_bf16 v[136:151], v[76:79], v[112:115], v[184:199]
v_mfma_f32_32x32x16_bf16 v[152:167], v[80:83], v[112:115], v[184:199]
s_nop 10
v_exp_f32 v136, v136
v_exp_f32 v137, v137
v_exp_f32 v138, v138
v_exp_f32 v139, v139
v_exp_f32 v140, v140
v_exp_f32 v141, v141
v_exp_f32 v142, v142
v_exp_f32 v143, v143
v_cvt_pk_bf16_f32 v128, v136, v137
v_cvt_pk_bf16_f32 v129, v138, v139
v_cvt_pk_bf16_f32 v130, v140, v141
v_cvt_pk_bf16_f32 v131, v142, v143
v_exp_f32 v144, v144
v_exp_f32 v145, v145
s_waitcnt vmcnt(22)
v_mfma_f32_32x32x16_bf16 v[200:215], a[136:139], v[128:131], 0
v_exp_f32 v146, v146
v_exp_f32 v147, v147
v_exp_f32 v148, v148
v_exp_f32 v149, v149
v_exp_f32 v150, v150
v_exp_f32 v151, v151
v_cvt_pk_bf16_f32 v132, v144, v145
v_cvt_pk_bf16_f32 v133, v146, v147
v_cvt_pk_bf16_f32 v134, v148, v149
v_cvt_pk_bf16_f32 v135, v150, v151
v_mfma_f32_32x32x16_bf16 v[136:151], v[84:87], v[112:115], v[184:199]
v_exp_f32 v152, v152
v_exp_f32 v153, v153
s_waitcnt vmcnt(21)
v_mfma_f32_32x32x16_bf16 v[200:215], a[140:143], v[132:135], v[200:215]
v_exp_f32 v154, v154
v_exp_f32 v155, v155
v_exp_f32 v156, v156
v_exp_f32 v157, v157
v_exp_f32 v158, v158
v_exp_f32 v159, v159
v_cvt_pk_bf16_f32 v128, v152, v153
v_cvt_pk_bf16_f32 v129, v154, v155
v_cvt_pk_bf16_f32 v130, v156, v157
v_cvt_pk_bf16_f32 v131, v158, v159
v_exp_f32 v160, v160
v_exp_f32 v161, v161
s_waitcnt vmcnt(20)
v_mfma_f32_32x32x16_bf16 v[200:215], a[144:147], v[128:131], v[200:215]
v_exp_f32 v162, v162
v_exp_f32 v163, v163
v_exp_f32 v164, v164
v_exp_f32 v165, v165
v_exp_f32 v166, v166
v_exp_f32 v167, v167
v_cvt_pk_bf16_f32 v132, v160, v161
v_cvt_pk_bf16_f32 v133, v162, v163
v_cvt_pk_bf16_f32 v134, v164, v165
v_cvt_pk_bf16_f32 v135, v166, v167
v_mfma_f32_32x32x16_bf16 v[152:167], v[88:91], v[112:115], v[184:199]
v_exp_f32 v136, v136
v_exp_f32 v137, v137
s_waitcnt vmcnt(19)
v_mfma_f32_32x32x16_bf16 v[200:215], a[148:151], v[132:135], v[200:215]
v_exp_f32 v138, v138
v_exp_f32 v139, v139
v_exp_f32 v140, v140
v_exp_f32 v141, v141
v_exp_f32 v142, v142
v_exp_f32 v143, v143
v_cvt_pk_bf16_f32 v128, v136, v137
v_cvt_pk_bf16_f32 v129, v138, v139
v_cvt_pk_bf16_f32 v130, v140, v141
v_cvt_pk_bf16_f32 v131, v142, v143
v_exp_f32 v144, v144
v_exp_f32 v145, v145
s_waitcnt vmcnt(18)
v_mfma_f32_32x32x16_bf16 v[200:215], a[152:155], v[128:131], v[200:215]
v_exp_f32 v146, v146
v_exp_f32 v147, v147
v_exp_f32 v148, v148
v_exp_f32 v149, v149
v_exp_f32 v150, v150
v_exp_f32 v151, v151
v_cvt_pk_bf16_f32 v132, v144, v145
v_cvt_pk_bf16_f32 v133, v146, v147
v_cvt_pk_bf16_f32 v134, v148, v149
v_cvt_pk_bf16_f32 v135, v150, v151
v_mfma_f32_32x32x16_bf16 v[136:151], v[92:95], v[112:115], v[184:199]
v_exp_f32 v152, v152
v_exp_f32 v153, v153
s_waitcnt vmcnt(17)
v_mfma_f32_32x32x16_bf16 v[200:215], a[156:159], v[132:135], v[200:215]
v_exp_f32 v154, v154
v_exp_f32 v155, v155
v_exp_f32 v156, v156
v_exp_f32 v157, v157
v_exp_f32 v158, v158
v_exp_f32 v159, v159
s_add_u32 m0, s56, 0
s_add_u32 s62, s58, 0
buffer_load_dwordx4 v11, s[16:19], s62 offen offset:0 lds
v_cvt_pk_bf16_f32 v128, v152, v153
v_cvt_pk_bf16_f32 v129, v154, v155
v_cvt_pk_bf16_f32 v130, v156, v157
v_cvt_pk_bf16_f32 v131, v158, v159
v_exp_f32 v160, v160
v_exp_f32 v161, v161
s_waitcnt vmcnt(17)
v_mfma_f32_32x32x16_bf16 v[200:215], a[160:163], v[128:131], v[200:215]
v_exp_f32 v162, v162
v_exp_f32 v163, v163
v_exp_f32 v164, v164
v_exp_f32 v165, v165
buffer_load_dwordx4 v12, s[16:19], s62 offen offset:1024 lds
v_exp_f32 v166, v166
v_exp_f32 v167, v167
v_cvt_pk_bf16_f32 v132, v160, v161
v_cvt_pk_bf16_f32 v133, v162, v163
v_cvt_pk_bf16_f32 v134, v164, v165
v_cvt_pk_bf16_f32 v135, v166, v167
v_mfma_f32_32x32x16_bf16 v[152:167], v[96:99], v[112:115], v[184:199]
v_exp_f32 v136, v136
v_exp_f32 v137, v137
s_waitcnt vmcnt(17)
v_mfma_f32_32x32x16_bf16 v[200:215], a[164:167], v[132:135], v[200:215]
v_exp_f32 v138, v138
buffer_load_dwordx4 v13, s[16:19], s62 offen offset:2048 lds
v_exp_f32 v139, v139
v_exp_f32 v140, v140
v_exp_f32 v141, v141
v_exp_f32 v142, v142
v_exp_f32 v143, v143
v_cvt_pk_bf16_f32 v128, v136, v137
v_cvt_pk_bf16_f32 v129, v138, v139
v_cvt_pk_bf16_f32 v130, v140, v141
v_cvt_pk_bf16_f32 v131, v142, v143
v_exp_f32 v144, v144
v_exp_f32 v145, v145
buffer_load_dwordx4 v14, s[16:19], s62 offen offset:3072 lds
s_waitcnt vmcnt(18)
v_mfma_f32_32x32x16_bf16 v[200:215], a[168:171], v[128:131], v[200:215]
v_exp_f32 v146, v146
v_exp_f32 v147, v147
v_exp_f32 v148, v148
v_exp_f32 v149, v149
v_exp_f32 v150, v150
v_exp_f32 v151, v151
v_cvt_pk_bf16_f32 v132, v144, v145
v_cvt_pk_bf16_f32 v133, v146, v147
v_cvt_pk_bf16_f32 v134, v148, v149
v_cvt_pk_bf16_f32 v135, v150, v151
s_add_u32 m0, s56, 4096
s_add_u32 s62, s58, 32768
buffer_load_dwordx4 v11, s[16:19], s62 offen offset:0 lds
v_mfma_f32_32x32x16_bf16 v[136:151], v[100:103], v[112:115], v[184:199]
v_exp_f32 v152, v152
v_exp_f32 v153, v153
s_waitcnt vmcnt(18)
v_mfma_f32_32x32x16_bf16 v[200:215], a[172:175], v[132:135], v[200:215]
v_exp_f32 v154, v154
v_exp_f32 v155, v155
v_exp_f32 v156, v156
v_exp_f32 v157, v157
v_exp_f32 v158, v158
v_exp_f32 v159, v159
v_cvt_pk_bf16_f32 v128, v152, v153
buffer_load_dwordx4 v12, s[16:19], s62 offen offset:1024 lds
v_cvt_pk_bf16_f32 v129, v154, v155
v_cvt_pk_bf16_f32 v130, v156, v157
v_cvt_pk_bf16_f32 v131, v158, v159
v_exp_f32 v160, v160
v_exp_f32 v161, v161
s_waitcnt vmcnt(18)
v_mfma_f32_32x32x16_bf16 v[200:215], a[176:179], v[128:131], v[200:215]
v_exp_f32 v162, v162
v_exp_f32 v163, v163
v_exp_f32 v164, v164
v_exp_f32 v165, v165
v_exp_f32 v166, v166
buffer_load_dwordx4 v13, s[16:19], s62 offen offset:2048 lds
v_exp_f32 v167, v167
v_cvt_pk_bf16_f32 v132, v160, v161
v_cvt_pk_bf16_f32 v133, v162, v163
v_cvt_pk_bf16_f32 v134, v164, v165
v_cvt_pk_bf16_f32 v135, v166, v167
v_mul_f32 v184, -1.0, v250
v_mov_b32 v185, v184
v_mov_b32 v186, v184
v_mov_b32 v187, v184
v_mov_b32 v188, v184
v_mov_b32 v189, v184
buffer_load_dwordx4 v14, s[16:19], s62 offen offset:3072 lds
v_mov_b32 v190, v184
v_mov_b32 v191, v184
v_mov_b32 v192, v184
v_mov_b32 v193, v184
v_mov_b32 v194, v184
s_mul_i32 s63, s97, 14
s_load_dwordx2 s[0:1], s[24:25], s63 offset:444
s_load_dwordx2 s[0:1], s[24:25], s63 offset:5564
s_load_dwordx2 s[0:1], s[24:25], s63 offset:7612
s_load_dwordx2 s[0:1], s[24:25], s63 offset:12732
v_mov_b32 v195, v184
v_mov_b32 v196, v184
v_mov_b32 v197, v184
v_mov_b32 v198, v184
v_mov_b32 v199, v184
s_nop 1
v_mfma_f32_32x32x16_bf16 v[152:167], v[80:83], v[116:119], v[184:199]
s_add_u32 m0, s56, 8192
s_add_u32 s62, s58, 65536
buffer_load_dwordx4 v11, s[16:19], s62 offen offset:0 lds
v_exp_f32 v136, v136
v_exp_f32 v137, v137
s_waitcnt vmcnt(20)
v_mfma_f32_32x32x16_bf16 v[200:215], a[180:183], v[132:135], v[200:215]
v_exp_f32 v138, v138
v_exp_f32 v139, v139
v_exp_f32 v140, v140
v_exp_f32 v141, v141
v_exp_f32 v142, v142
v_exp_f32 v143, v143
v_cvt_pk_bf16_f32 v128, v136, v137
v_cvt_pk_bf16_f32 v129, v138, v139
buffer_load_dwordx4 v12, s[16:19], s62 offen offset:1024 lds
v_cvt_pk_bf16_f32 v130, v140, v141
v_cvt_pk_bf16_f32 v131, v142, v143
v_exp_f32 v144, v144
v_exp_f32 v145, v145
s_waitcnt vmcnt(20)
v_mfma_f32_32x32x16_bf16 v[200:215], a[184:187], v[128:131], v[200:215]
v_exp_f32 v146, v146
v_exp_f32 v147, v147
v_exp_f32 v148, v148
v_exp_f32 v149, v149
v_exp_f32 v150, v150
v_exp_f32 v151, v151
buffer_load_dwordx4 v13, s[16:19], s62 offen offset:2048 lds
v_cvt_pk_bf16_f32 v132, v144, v145
v_cvt_pk_bf16_f32 v133, v146, v147
v_cvt_pk_bf16_f32 v134, v148, v149
v_cvt_pk_bf16_f32 v135, v150, v151
v_mfma_f32_32x32x16_bf16 v[136:151], v[84:87], v[116:119], v[184:199]
v_sub_f32 v168, v168, v248
v_sub_f32 v169, v169, v248
s_waitcnt vmcnt(20)
v_mfma_f32_32x32x16_bf16 v[200:215], a[188:191], v[132:135], v[200:215]
v_sub_f32 v170, v170, v248
v_sub_f32 v171, v171, v248
v_sub_f32 v172, v172, v248
buffer_load_dwordx4 v14, s[16:19], s62 offen offset:3072 lds
v_sub_f32 v173, v173, v248
v_sub_f32 v174, v174, v248
v_sub_f32 v175, v175, v248
v_sub_f32 v176, v176, v248
v_sub_f32 v177, v177, v248
v_sub_f32 v178, v178, v248
v_sub_f32 v179, v179, v248
v_sub_f32 v180, v180, v248
v_sub_f32 v181, v181, v248
v_sub_f32 v182, v182, v248
v_sub_f32 v183, v183, v248
s_add_u32 m0, s56, 12288
s_add_u32 s62, s58, 98304
buffer_load_dwordx4 v11, s[16:19], s62 offen offset:0 lds
v_exp_f32 v168, v168
v_exp_f32 v169, v169
v_exp_f32 v170, v170
v_exp_f32 v171, v171
v_exp_f32 v172, v172
v_exp_f32 v173, v173
v_exp_f32 v174, v174
v_exp_f32 v175, v175
v_exp_f32 v176, v176
v_exp_f32 v177, v177
v_exp_f32 v178, v178
buffer_load_dwordx4 v12, s[16:19], s62 offen offset:1024 lds
v_exp_f32 v179, v179
v_exp_f32 v180, v180
v_exp_f32 v181, v181
v_exp_f32 v182, v182
v_exp_f32 v183, v183
v_cvt_pk_bf16_f32 v128, v168, v169
v_cvt_pk_bf16_f32 v129, v170, v171
v_cvt_pk_bf16_f32 v130, v172, v173
v_cvt_pk_bf16_f32 v131, v174, v175
v_cvt_pk_bf16_f32 v132, v176, v177
v_cvt_pk_bf16_f32 v133, v178, v179
buffer_load_dwordx4 v13, s[16:19], s62 offen offset:2048 lds
v_cvt_pk_bf16_f32 v134, v180, v181
v_cvt_pk_bf16_f32 v135, v182, v183
v_bfi_b32 v168, v56, 0, v128
v_bfi_b32 v169, v57, 0, v129
v_bfi_b32 v170, v58, 0, v130
v_bfi_b32 v171, v59, 0, v131
v_bfi_b32 v172, v60, 0, v132
v_bfi_b32 v173, v61, 0, v133
v_bfi_b32 v174, v62, 0, v134
v_bfi_b32 v175, v63, 0, v135
v_and_b32 v176, v56, v128
buffer_load_dwordx4 v14, s[16:19], s62 offen offset:3072 lds
v_and_b32 v177, v57, v129
v_and_b32 v178, v58, v130
v_and_b32 v179, v59, v131
s_waitcnt vmcnt(24)
v_mfma_f32_32x32x16_bf16 v[200:215], a[128:131], v[168:171], v[200:215]
s_waitcnt vmcnt(23)
v_mfma_f32_32x32x16_bf16 v[200:215], a[132:135], v[172:175], v[200:215]
v_and_b32 v180, v60, v132
v_and_b32 v181, v61, v133
v_and_b32 v182, v62, v134
v_and_b32 v183, v63, v135
s_waitcnt vmcnt(22)
v_mfma_f32_32x32x16_bf16 v[200:215], a[192:195], v[176:179], v[200:215]
v_exp_f32 v152, v152
v_exp_f32 v153, v153
s_add_u32 m0, s56, 65536
s_add_u32 s62, s58, 0
buffer_load_dwordx4 v11, s[20:23], s62 offen offset:0 lds
s_waitcnt vmcnt(22)
v_mfma_f32_32x32x16_bf16 v[200:215], a[196:199], v[180:183], v[200:215]
v_exp_f32 v154, v154
v_exp_f32 v155, v155
v_exp_f32 v156, v156
v_exp_f32 v157, v157
v_exp_f32 v158, v158
v_exp_f32 v159, v159
v_cvt_pk_bf16_f32 v128, v152, v153
v_cvt_pk_bf16_f32 v129, v154, v155
v_cvt_pk_bf16_f32 v130, v156, v157
v_cvt_pk_bf16_f32 v131, v158, v159
buffer_load_dwordx4 v12, s[20:23], s62 offen offset:1024 lds
v_exp_f32 v160, v160
v_exp_f32 v161, v161
v_mfma_f32_32x32x16_bf16 v[216:231], a[144:147], v[128:131], 0
v_exp_f32 v162, v162
v_exp_f32 v163, v163
v_exp_f32 v164, v164
v_exp_f32 v165, v165
v_exp_f32 v166, v166
v_exp_f32 v167, v167
v_cvt_pk_bf16_f32 v132, v160, v161
v_cvt_pk_bf16_f32 v133, v162, v163
buffer_load_dwordx4 v13, s[20:23], s62 offen offset:2048 lds
v_cvt_pk_bf16_f32 v134, v164, v165
v_cvt_pk_bf16_f32 v135, v166, v167
v_mfma_f32_32x32x16_bf16 v[152:167], v[88:91], v[116:119], v[184:199]
v_exp_f32 v136, v136
v_exp_f32 v137, v137
v_mfma_f32_32x32x16_bf16 v[216:231], a[148:151], v[132:135], v[216:231]
v_exp_f32 v138, v138
v_exp_f32 v139, v139
v_exp_f32 v140, v140
v_exp_f32 v141, v141
v_exp_f32 v142, v142
buffer_load_dwordx4 v14, s[20:23], s62 offen offset:3072 lds
v_exp_f32 v143, v143
v_cvt_pk_bf16_f32 v128, v136, v137
v_cvt_pk_bf16_f32 v129, v138, v139
v_cvt_pk_bf16_f32 v130, v140, v141
v_cvt_pk_bf16_f32 v131, v142, v143
v_exp_f32 v144, v144
v_exp_f32 v145, v145
v_mfma_f32_32x32x16_bf16 v[216:231], a[152:155], v[128:131], v[216:231]
v_exp_f32 v146, v146
v_exp_f32 v147, v147
v_exp_f32 v148, v148
s_add_u32 m0, s56, 69632
s_add_u32 s62, s58, 32768
buffer_load_dwordx4 v11, s[20:23], s62 offen offset:0 lds
v_exp_f32 v149, v149
v_exp_f32 v150, v150
v_exp_f32 v151, v151
v_cvt_pk_bf16_f32 v132, v144, v145
v_cvt_pk_bf16_f32 v133, v146, v147
v_cvt_pk_bf16_f32 v134, v148, v149
v_cvt_pk_bf16_f32 v135, v150, v151
v_mfma_f32_32x32x16_bf16 v[136:151], v[92:95], v[116:119], v[184:199]
L_sp2:
s_waitcnt vmcnt(23)
v_cmp_gt_u32 vcc, 32, v124
s_cbranch_vccnz L_sp1
v_xor_b32 v124, s3, v124
v_and_b32 v124, 15, v124
v_cmp_ne_u32 vcc, 0, v124
s_cmp_eq_u64 vcc, 0
s_cselect_b32 s54, 1, 0
v_rcp_f32 v208, v208
s_add_u32 s66, s50, s71
buffer_load_dwordx4 v12, s[20:23], s62 offen offset:1024 lds
s_add_u32 s66, s66, 6291456
v_mul_f32 v200, v200, v208
v_mul_f32 v201, v201, v208
v_mul_f32 v202, v202, v208
v_mul_f32 v203, v203, v208
v_mul_f32 v204, v204, v208
v_mul_f32 v205, v205, v208
v_mul_f32 v206, v206, v208
v_mul_f32 v207, v207, v208
v_cvt_pk_bf16_f32 v252, v200, v201
v_cvt_pk_bf16_f32 v253, v202, v203
buffer_load_dwordx4 v13, s[20:23], s62 offen offset:2048 lds
v_cvt_pk_bf16_f32 v254, v204, v205
v_cvt_pk_bf16_f32 v255, v206, v207
v_and_b32 v252, -2, v252
s_cmp_eq_u32 s54, 0
s_cbranch_scc1 L_sc6
buffer_store_dwordx4 v[252:255], v1, s[32:35], s66 offen offset:0
L_sj7:
v_exp_f32 v152, v152
v_exp_f32 v153, v153
v_mfma_f32_32x32x16_bf16 v[216:231], a[156:159], v[132:135], v[216:231]
v_exp_f32 v154, v154
v_exp_f32 v155, v155
v_exp_f32 v156, v156
v_exp_f32 v157, v157
buffer_load_dwordx4 v14, s[20:23], s62 offen offset:3072 lds
v_exp_f32 v158, v158
v_exp_f32 v159, v159
v_cvt_pk_bf16_f32 v128, v152, v153
v_cvt_pk_bf16_f32 v129, v154, v155
v_cvt_pk_bf16_f32 v130, v156, v157
v_cvt_pk_bf16_f32 v131, v158, v159
v_exp_f32 v160, v160
v_exp_f32 v161, v161
v_mfma_f32_32x32x16_bf16 v[216:231], a[160:163], v[128:131], v[216:231]
v_exp_f32 v162, v162
v_exp_f32 v163, v163
s_add_u32 m0, s56, 73728
s_add_u32 s62, s58, 65536
buffer_load_dwordx4 v11, s[20:23], s62 offen offset:0 lds
v_exp_f32 v164, v164
v_exp_f32 v165, v165
v_exp_f32 v166, v166
v_exp_f32 v167, v167
v_cvt_pk_bf16_f32 v132, v160, v161
v_cvt_pk_bf16_f32 v133, v162, v163
s_mul_i32 s63, s97, 14
s_load_dwordx2 s[0:1], s[24:25], s63 offset:2492
s_load_dwordx2 s[0:1], s[24:25], s63 offset:4540
s_load_dwordx2 s[0:1], s[24:25], s63 offset:9660
s_load_dwordx2 s[0:1], s[24:25], s63 offset:11708
v_cvt_pk_bf16_f32 v134, v164, v165
v_cvt_pk_bf16_f32 v135, v166, v167
v_mfma_f32_32x32x16_bf16 v[152:167], v[96:99], v[116:119], v[184:199]
v_exp_f32 v136, v136
v_exp_f32 v137, v137
buffer_load_dwordx4 v12, s[20:23], s62 offen offset:1024 lds
v_mfma_f32_32x32x16_bf16 v[216:231], a[164:167], v[132:135], v[216:231]
v_exp_f32 v138, v138
v_exp_f32 v139, v139
v_exp_f32 v140, v140
v_exp_f32 v141, v141
v_exp_f32 v142, v142
v_exp_f32 v143, v143
v_cvt_pk_bf16_f32 v128, v136, v137
v_cvt_pk_bf16_f32 v129, v138, v139
v_cvt_pk_bf16_f32 v130, v140, v141
v_cvt_pk_bf16_f32 v131, v142, v143
buffer_load_dwordx4 v13, s[20:23], s62 offen offset:2048 lds
v_exp_f32 v144, v144
v_exp_f32 v145, v145
v_mfma_f32_32x32x16_bf16 v[216:231], a[168:171], v[128:131], v[216:231]
v_exp_f32 v146, v146
v_exp_f32 v147, v147
v_exp_f32 v148, v148
v_exp_f32 v149, v149
v_exp_f32 v150, v150
v_exp_f32 v151, v151
v_cvt_pk_bf16_f32 v132, v144, v145
v_cvt_pk_bf16_f32 v133, v146, v147
buffer_load_dwordx4 v14, s[20:23], s62 offen offset:3072 lds
v_cvt_pk_bf16_f32 v134, v148, v149
v_cvt_pk_bf16_f32 v135, v150, v151
v_mfma_f32_32x32x16_bf16 v[136:151], v[100:103], v[116:119], v[184:199]
v_exp_f32 v152, v152
v_exp_f32 v153, v153
v_mfma_f32_32x32x16_bf16 v[216:231], a[172:175], v[132:135], v[216:231]
v_exp_f32 v154, v154
v_exp_f32 v155, v155
v_exp_f32 v156, v156
v_exp_f32 v157, v157
v_exp_f32 v158, v158
s_add_u32 m0, s56, 77824
s_add_u32 s62, s58, 98304
buffer_load_dwordx4 v11, s[20:23], s62 offen offset:0 lds
v_exp_f32 v159, v159
v_cvt_pk_bf16_f32 v128, v152, v153
v_cvt_pk_bf16_f32 v129, v154, v155
v_cvt_pk_bf16_f32 v130, v156, v157
v_cvt_pk_bf16_f32 v131, v158, v159
v_exp_f32 v160, v160
v_exp_f32 v161, v161
v_mfma_f32_32x32x16_bf16 v[216:231], a[176:179], v[128:131], v[216:231]
v_exp_f32 v162, v162
v_exp_f32 v163, v163
v_exp_f32 v164, v164
buffer_load_dwordx4 v12, s[20:23], s62 offen offset:1024 lds
v_exp_f32 v165, v165
v_exp_f32 v166, v166
v_exp_f32 v167, v167
v_cvt_pk_bf16_f32 v132, v160, v161
v_cvt_pk_bf16_f32 v133, v162, v163
v_cvt_pk_bf16_f32 v134, v164, v165
v_cvt_pk_bf16_f32 v135, v166, v167
v_mfma_f32_32x32x16_bf16 v[152:167], v[104:107], v[116:119], v[184:199]
v_exp_f32 v136, v136
v_exp_f32 v137, v137
v_mfma_f32_32x32x16_bf16 v[216:231], a[180:183], v[132:135], v[216:231]
buffer_load_dwordx4 v13, s[20:23], s62 offen offset:2048 lds
v_exp_f32 v138, v138
v_exp_f32 v139, v139
v_exp_f32 v140, v140
v_exp_f32 v141, v141
v_exp_f32 v142, v142
v_exp_f32 v143, v143
v_cvt_pk_bf16_f32 v128, v136, v137
v_cvt_pk_bf16_f32 v129, v138, v139
v_cvt_pk_bf16_f32 v130, v140, v141
v_cvt_pk_bf16_f32 v131, v142, v143
v_exp_f32 v144, v144
buffer_load_dwordx4 v14, s[20:23], s62 offen offset:3072 lds
v_exp_f32 v145, v145
v_mfma_f32_32x32x16_bf16 v[216:231], a[184:187], v[128:131], v[216:231]
v_exp_f32 v146, v146
v_exp_f32 v147, v147
v_exp_f32 v148, v148
v_exp_f32 v149, v149
v_exp_f32 v150, v150
v_exp_f32 v151, v151
v_cvt_pk_bf16_f32 v132, v144, v145
v_cvt_pk_bf16_f32 v133, v146, v147
v_cvt_pk_bf16_f32 v134, v148, v149
v_cvt_pk_bf16_f32 v135, v150, v151
v_exp_f32 v152, v152
v_exp_f32 v153, v153
v_mfma_f32_32x32x16_bf16 v[216:231], a[188:191], v[132:135], v[216:231]
v_exp_f32 v154, v154
v_exp_f32 v155, v155
v_exp_f32 v156, v156
v_exp_f32 v157, v157
v_exp_f32 v158, v158
v_exp_f32 v159, v159
v_cvt_pk_bf16_f32 v128, v152, v153
v_cvt_pk_bf16_f32 v129, v154, v155
v_cvt_pk_bf16_f32 v130, v156, v157
v_cvt_pk_bf16_f32 v131, v158, v159
v_exp_f32 v160, v160
v_exp_f32 v161, v161
v_mfma_f32_32x32x16_bf16 v[216:231], a[192:195], v[128:131], v[216:231]
v_exp_f32 v162, v162
v_exp_f32 v163, v163
v_exp_f32 v164, v164
v_exp_f32 v165, v165
v_exp_f32 v166, v166
v_exp_f32 v167, v167
v_cvt_pk_bf16_f32 v132, v160, v161
v_cvt_pk_bf16_f32 v133, v162, v163
v_cvt_pk_bf16_f32 v134, v164, v165
v_cvt_pk_bf16_f32 v135, v166, v167
v_sub_f32 v232, v232, v250
v_sub_f32 v233, v233, v250
v_mfma_f32_32x32x16_bf16 v[216:231], a[196:199], v[132:135], v[216:231]
v_sub_f32 v234, v234, v250
v_sub_f32 v235, v235, v250
v_sub_f32 v236, v236, v250
v_sub_f32 v237, v237, v250
v_sub_f32 v238, v238, v250
v_sub_f32 v239, v239, v250
v_sub_f32 v240, v240, v250
v_sub_f32 v241, v241, v250
v_sub_f32 v242, v242, v250
v_sub_f32 v243, v243, v250
v_sub_f32 v244, v244, v250
v_sub_f32 v245, v245, v250
v_sub_f32 v246, v246, v250
v_sub_f32 v247, v247, v250
v_exp_f32 v232, v232
v_exp_f32 v233, v233
v_exp_f32 v234, v234
v_exp_f32 v235, v235
v_exp_f32 v236, v236
v_exp_f32 v237, v237
v_exp_f32 v238, v238
v_exp_f32 v239, v239
v_exp_f32 v240, v240
v_exp_f32 v241, v241
v_exp_f32 v242, v242
v_exp_f32 v243, v243
v_exp_f32 v244, v244
v_exp_f32 v245, v245
v_exp_f32 v246, v246
v_exp_f32 v247, v247
v_cvt_pk_bf16_f32 v128, v232, v233
v_cvt_pk_bf16_f32 v129, v234, v235
v_cvt_pk_bf16_f32 v130, v236, v237
v_cvt_pk_bf16_f32 v131, v238, v239
v_cvt_pk_bf16_f32 v132, v240, v241
v_cvt_pk_bf16_f32 v133, v242, v243
v_cvt_pk_bf16_f32 v134, v244, v245
v_cvt_pk_bf16_f32 v135, v246, v247
v_bfi_b32 v232, v56, 0, v128
v_bfi_b32 v233, v57, 0, v129
v_bfi_b32 v234, v58, 0, v130
v_bfi_b32 v235, v59, 0, v131
v_bfi_b32 v236, v60, 0, v132
v_bfi_b32 v237, v61, 0, v133
v_bfi_b32 v238, v62, 0, v134
s_waitcnt vmcnt(17)
s_mul_i32 s63, s7, 32
s_add_u32 s63, s3, s63
v_mov_b32 v37, s63
s_cmp_eq_u32 s54, 0
s_cbranch_scc1 L_sc8
buffer_store_dword v37, v27, s[32:35], s67 offen
L_sj9:
v_bfi_b32 v239, v63, 0, v135
v_and_b32 v240, v56, v128
v_and_b32 v241, v57, v129
v_and_b32 v242, v58, v130
v_and_b32 v243, v59, v131
v_mfma_f32_32x32x16_bf16 v[216:231], a[136:139], v[232:235], v[216:231]
v_mfma_f32_32x32x16_bf16 v[216:231], a[140:143], v[236:239], v[216:231]
v_and_b32 v244, v60, v132
v_and_b32 v245, v61, v133
v_and_b32 v246, v62, v134
v_and_b32 v247, v63, v135
v_mfma_f32_32x32x16_bf16 v[216:231], a[200:203], v[240:243], v[216:231]
s_nop 0
v_mfma_f32_32x32x16_bf16 v[216:231], a[204:207], v[244:247], v[216:231]
s_nop 11
v_rcp_f32 v224, v224
s_add_u32 s66, s50, s71
s_add_u32 s66, s66, 6324224
v_mul_f32 v216, v216, v224
v_mul_f32 v217, v217, v224
v_mul_f32 v218, v218, v224
v_mul_f32 v219, v219, v224
v_mul_f32 v220, v220, v224
v_mul_f32 v221, v221, v224
v_mul_f32 v222, v222, v224
v_mul_f32 v223, v223, v224
v_cvt_pk_bf16_f32 v252, v216, v217
v_cvt_pk_bf16_f32 v253, v218, v219
v_cvt_pk_bf16_f32 v254, v220, v221
v_cvt_pk_bf16_f32 v255, v222, v223
v_and_b32 v252, -2, v252
s_cmp_eq_u32 s54, 0
s_cbranch_scc1 L_sc10
buffer_store_dwordx4 v[252:255], v1, s[32:35], s66 offen offset:0
L_sj11:
s_waitcnt vmcnt(2)
s_cmp_eq_u32 s7, 0
s_cbranch_scc0 L_oa
s_waitcnt vmcnt(0)
L_oa:
s_add_u32 s63, s3, 32
v_mov_b32 v37, s63
s_cmp_eq_u32 s54, 0
s_cbranch_scc1 L_sc12
buffer_store_dword v37, v27, s[32:35], s67 offen
L_sj13:
s_mul_i32 s63, s97, 14
s_load_dwordx2 s[0:1], s[24:25], s63 offset:1468
s_load_dwordx2 s[0:1], s[24:25], s63 offset:6588
s_load_dwordx2 s[0:1], s[24:25], s63 offset:8636
s_load_dwordx2 s[0:1], s[24:25], s63 offset:13756
s_mul_i32 s63, s97, 14
s_load_dwordx2 s[0:1], s[24:25], s63 offset:3516
s_load_dwordx2 s[0:1], s[24:25], s63 offset:10684
s_barrier
s_add_u32 s63, s52, 32
L_pl14:
buffer_load_dword v37, v28, s[32:35], s51 offen sc1
s_waitcnt vmcnt(0)
v_cmp_gt_u32 vcc, s63, v37
s_cbranch_vccz L_pd15
s_sub_u32 s53, s53, 1
s_cbranch_scc0 L_pl14
s_endpgm
L_pd15:
s_add_u32 s64, s50, 6291456
buffer_load_dwordx4 v[72:75], v2, s[32:35], s64 offen offset:0 sc1
ds_read_b64_tr_b16 a[132:133], v7 offset:0
ds_read_b64_tr_b16 a[134:135], v7 offset:1024
ds_read_b64_tr_b16 a[128:129], v6 offset:0
ds_read_b64_tr_b16 a[130:131], v6 offset:1024
ds_read_b64_tr_b16 a[140:141], v7 offset:2048
buffer_load_dwordx4 v[76:79], v2, s[32:35], s64 offen offset:1024 sc1
ds_read_b64_tr_b16 a[142:143], v7 offset:3072
ds_read_b64_tr_b16 a[136:137], v6 offset:2048
ds_read_b64_tr_b16 a[138:139], v6 offset:3072
ds_read_b64_tr_b16 a[148:149], v7 offset:4096
ds_read_b64_tr_b16 a[150:151], v7 offset:5120
buffer_load_dwordx4 v[80:83], v2, s[32:35], s64 offen offset:2048 sc1
ds_read_b64_tr_b16 a[144:145], v6 offset:4096
ds_read_b64_tr_b16 a[146:147], v6 offset:5120
ds_read_b64_tr_b16 a[156:157], v7 offset:6144
ds_read_b64_tr_b16 a[158:159], v7 offset:7168
ds_read_b64_tr_b16 a[152:153], v6 offset:6144
buffer_load_dwordx4 v[84:87], v2, s[32:35], s64 offen offset:3072 sc1
ds_read_b64_tr_b16 a[154:155], v6 offset:7168
ds_read_b64_tr_b16 a[164:165], v7 offset:8192
ds_read_b64_tr_b16 a[166:167], v7 offset:9216
ds_read_b64_tr_b16 a[160:161], v6 offset:8192
ds_read_b64_tr_b16 a[162:163], v6 offset:9216
buffer_load_dwordx4 v[88:91], v3, s[32:35], s64 offen offset:0 sc1
ds_read_b64_tr_b16 a[172:173], v7 offset:10240
ds_read_b64_tr_b16 a[174:175], v7 offset:11264
ds_read_b64_tr_b16 a[168:169], v6 offset:10240
ds_read_b64_tr_b16 a[170:171], v6 offset:11264
ds_read_b64_tr_b16 a[180:181], v7 offset:12288
buffer_load_dwordx4 v[92:95], v3, s[32:35], s64 offen offset:1024 sc1
ds_read_b64_tr_b16 a[182:183], v7 offset:13312
ds_read_b64_tr_b16 a[176:177], v6 offset:12288
ds_read_b64_tr_b16 a[178:179], v6 offset:13312
ds_read_b64_tr_b16 a[188:189], v7 offset:14336
ds_read_b64_tr_b16 a[190:191], v7 offset:15360
buffer_load_dwordx4 v[96:99], v3, s[32:35], s64 offen offset:2048 sc1
ds_read_b64_tr_b16 a[184:185], v6 offset:14336
ds_read_b64_tr_b16 a[186:187], v6 offset:15360
ds_read_b64_tr_b16 a[196:197], v7 offset:16384
ds_read_b64_tr_b16 a[198:199], v7 offset:17408
ds_read_b64_tr_b16 a[192:193], v6 offset:16384
buffer_load_dwordx4 v[100:103], v3, s[32:35], s64 offen offset:3072 sc1
ds_read_b64_tr_b16 a[194:195], v6 offset:17408
ds_read_b64_tr_b16 a[204:205], v7 offset:18432
ds_read_b64_tr_b16 a[206:207], v7 offset:19456
ds_read_b64_tr_b16 a[200:201], v6 offset:18432
ds_read_b64_tr_b16 a[202:203], v6 offset:19456
s_waitcnt vmcnt(7)
v_mfma_f32_32x32x16_bf16 v[216:231], a[4:7], v[72:75], 0
ds_read_b64_tr_b16 a[212:213], v7 offset:20480
ds_read_b64_tr_b16 a[214:215], v7 offset:21504
v_mfma_f32_32x32x16_bf16 v[200:215], a[0:3], v[72:75], 0
ds_read_b64_tr_b16 a[208:209], v6 offset:20480
ds_read_b64_tr_b16 a[210:211], v6 offset:21504
buffer_load_dwordx4 v[104:107], v4, s[32:35], s64 offen offset:0 sc1
s_waitcnt vmcnt(7)
v_mfma_f32_32x32x16_bf16 v[216:231], a[12:15], v[76:79], v[216:231]
ds_read_b64_tr_b16 a[220:221], v7 offset:22528
ds_read_b64_tr_b16 a[222:223], v7 offset:23552
v_mfma_f32_32x32x16_bf16 v[200:215], a[8:11], v[76:79], v[200:215]
ds_read_b64_tr_b16 a[216:217], v6 offset:22528
ds_read_b64_tr_b16 a[218:219], v6 offset:23552
buffer_load_dwordx4 v[108:111], v4, s[32:35], s64 offen offset:1024 sc1
s_waitcnt vmcnt(7)
v_mfma_f32_32x32x16_bf16 v[216:231], a[20:23], v[80:83], v[216:231]
v_bitop3_b32 v248, v72, v76, v80 bitop3:0xfe
ds_read_b64_tr_b16 a[228:229], v7 offset:24576
ds_read_b64_tr_b16 a[230:231], v7 offset:25600
v_mfma_f32_32x32x16_bf16 v[200:215], a[16:19], v[80:83], v[200:215]
ds_read_b64_tr_b16 a[224:225], v6 offset:24576
ds_read_b64_tr_b16 a[226:227], v6 offset:25600
buffer_load_dwordx4 v[112:115], v4, s[32:35], s64 offen offset:2048 sc1
s_waitcnt vmcnt(7)
v_mfma_f32_32x32x16_bf16 v[216:231], a[28:31], v[84:87], v[216:231]
ds_read_b64_tr_b16 a[236:237], v7 offset:26624
ds_read_b64_tr_b16 a[238:239], v7 offset:27648
v_mfma_f32_32x32x16_bf16 v[200:215], a[24:27], v[84:87], v[200:215]
ds_read_b64_tr_b16 a[232:233], v6 offset:26624
ds_read_b64_tr_b16 a[234:235], v6 offset:27648
buffer_load_dwordx4 v[116:119], v4, s[32:35], s64 offen offset:3072 sc1
s_waitcnt vmcnt(7)
v_mfma_f32_32x32x16_bf16 v[216:231], a[36:39], v[88:91], v[216:231]
v_bitop3_b32 v248, v248, v84, v88 bitop3:0xfe
ds_read_b64_tr_b16 a[244:245], v7 offset:28672
ds_read_b64_tr_b16 a[246:247], v7 offset:29696
v_mfma_f32_32x32x16_bf16 v[200:215], a[32:35], v[88:91], v[200:215]
ds_read_b64_tr_b16 a[240:241], v6 offset:28672
ds_read_b64_tr_b16 a[242:243], v6 offset:29696
buffer_load_dwordx4 v[120:123], v5, s[32:35], s64 offen offset:0 sc1
s_waitcnt vmcnt(7)
v_mfma_f32_32x32x16_bf16 v[216:231], a[44:47], v[92:95], v[216:231]
ds_read_b64_tr_b16 a[252:253], v7 offset:30720
ds_read_b64_tr_b16 a[254:255], v7 offset:31744
v_mfma_f32_32x32x16_bf16 v[200:215], a[40:43], v[92:95], v[200:215]
ds_read_b64_tr_b16 a[248:249], v6 offset:30720
ds_read_b64_tr_b16 a[250:251], v6 offset:31744
buffer_load_dwordx4 v[124:127], v5, s[32:35], s64 offen offset:1024 sc1
s_waitcnt vmcnt(7)
v_mfma_f32_32x32x16_bf16 v[216:231], a[52:55], v[96:99], v[216:231]
v_bitop3_b32 v248, v248, v92, v96 bitop3:0xfe
v_mfma_f32_32x32x16_bf16 v[200:215], a[48:51], v[96:99], v[200:215]
buffer_load_dwordx4 v[128:131], v5, s[32:35], s64 offen offset:2048 sc1
s_waitcnt vmcnt(7)
v_mfma_f32_32x32x16_bf16 v[216:231], a[60:63], v[100:103], v[216:231]
s_waitcnt lgkmcnt(0)
s_barrier
v_mfma_f32_32x32x16_bf16 v[200:215], a[56:59], v[100:103], v[200:215]
buffer_load_dwordx4 v[132:135], v5, s[32:35], s64 offen offset:3072 sc1
s_waitcnt vmcnt(7)
v_mfma_f32_32x32x16_bf16 v[216:231], a[68:71], v[104:107], v[216:231]
v_bitop3_b32 v248, v248, v100, v104 bitop3:0xfe
v_mfma_f32_32x32x16_bf16 v[200:215], a[64:67], v[104:107], v[200:215]
s_add_u32 m0, s56, 0
s_add_u32 s62, s59, 0
buffer_load_dwordx4 v19, s[24:27], s62 offen offset:0 lds
s_waitcnt vmcnt(7)
v_mfma_f32_32x32x16_bf16 v[216:231], a[76:79], v[108:111], v[216:231]
buffer_load_dwordx4 v20, s[24:27], s62 offen offset:1024 lds
v_mfma_f32_32x32x16_bf16 v[200:215], a[72:75], v[108:111], v[200:215]
s_waitcnt vmcnt(7)
v_mfma_f32_32x32x16_bf16 v[216:231], a[84:87], v[112:115], v[216:231]
v_bitop3_b32 v248, v248, v108, v112 bitop3:0xfe
buffer_load_dwordx4 v21, s[24:27], s62 offen offset:2048 lds
v_mfma_f32_32x32x16_bf16 v[200:215], a[80:83], v[112:115], v[200:215]
s_waitcnt vmcnt(7)
v_mfma_f32_32x32x16_bf16 v[216:231], a[92:95], v[116:119], v[216:231]
buffer_load_dwordx4 v22, s[24:27], s62 offen offset:3072 lds
v_mfma_f32_32x32x16_bf16 v[200:215], a[88:91], v[116:119], v[200:215]
s_waitcnt vmcnt(7)
v_mfma_f32_32x32x16_bf16 v[216:231], a[100:103], v[120:123], v[216:231]
v_bitop3_b32 v248, v248, v116, v120 bitop3:0xfe
s_add_u32 m0, s56, 4096
s_add_u32 s62, s59, 114688
buffer_load_dwordx4 v19, s[24:27], s62 offen offset:0 lds
v_mfma_f32_32x32x16_bf16 v[200:215], a[96:99], v[120:123], v[200:215]
s_waitcnt vmcnt(7)
v_mfma_f32_32x32x16_bf16 v[216:231], a[108:111], v[124:127], v[216:231]
buffer_load_dwordx4 v20, s[24:27], s62 offen offset:1024 lds
v_mfma_f32_32x32x16_bf16 v[200:215], a[104:107], v[124:127], v[200:215]
s_waitcnt vmcnt(7)
v_mfma_f32_32x32x16_bf16 v[216:231], a[116:119], v[128:131], v[216:231]
v_bitop3_b32 v248, v248, v124, v128 bitop3:0xfe
buffer_load_dwordx4 v21, s[24:27], s62 offen offset:2048 lds
v_mfma_f32_32x32x16_bf16 v[200:215], a[112:115], v[128:131], v[200:215]
s_waitcnt vmcnt(7)
v_mfma_f32_32x32x16_bf16 v[216:231], a[124:127], v[132:135], v[216:231]
v_bitop3_b32 v248, v248, v132, v132 bitop3:0xfe
v_and_b32 v248, 1, v248
v_cmp_ne_u32 vcc, 0, v248
buffer_load_dwordx4 v22, s[24:27], s62 offen offset:3072 lds
v_mfma_f32_32x32x16_bf16 v[200:215], a[120:123], v[132:135], v[200:215]
s_cbranch_vccnz L_rt16
L_rb17:
s_nop 5
ds_write_b128 v23, v[216:219] offset:0
ds_write_b128 v23, v[220:223] offset:1024
ds_write_b128 v23, v[224:227] offset:2048
ds_write_b128 v23, v[228:231] offset:3072
s_add_u32 m0, s56, 8192
s_add_u32 s62, s59, 229376
buffer_load_dwordx4 v19, s[24:27], s62 offen offset:0 lds
buffer_load_dwordx4 v20, s[24:27], s62 offen offset:1024 lds
buffer_load_dwordx4 v21, s[24:27], s62 offen offset:2048 lds
buffer_load_dwordx4 v22, s[24:27], s62 offen offset:3072 lds
s_waitcnt lgkmcnt(0)
s_barrier
s_add_u32 m0, s56, 12288
s_add_u32 s62, s59, 344064
buffer_load_dwordx4 v19, s[24:27], s62 offen offset:0 lds
buffer_load_dwordx4 v20, s[24:27], s62 offen offset:1024 lds
ds_read_b128 v[168:171], v24 offset:0
ds_read_b128 v[172:175], v24 offset:1024
ds_read_b128 v[176:179], v24 offset:2048
ds_read_b128 v[180:183], v24 offset:3072
v_pk_add_f32 v[40:41], v[40:41], v[200:201]
v_pk_add_f32 v[42:43], v[42:43], v[202:203]
v_pk_add_f32 v[44:45], v[44:45], v[204:205]
buffer_load_dwordx4 v21, s[24:27], s62 offen offset:2048 lds
v_pk_add_f32 v[46:47], v[46:47], v[206:207]
v_pk_add_f32 v[48:49], v[48:49], v[208:209]
v_pk_add_f32 v[50:51], v[50:51], v[210:211]
buffer_load_dwordx4 v22, s[24:27], s62 offen offset:3072 lds
v_pk_add_f32 v[52:53], v[52:53], v[212:213]
v_pk_add_f32 v[54:55], v[54:55], v[214:215]
s_add_u32 s63, s3, 48
v_mov_b32 v37, s63
s_cmp_eq_u32 s54, 0
s_cbranch_scc1 L_sc18
buffer_store_dword v37, v27, s[32:35], s67 offen
L_sj19:
s_waitcnt lgkmcnt(3)
v_pk_add_f32 v[40:41], v[40:41], v[168:169]
v_pk_add_f32 v[42:43], v[42:43], v[170:171]
s_waitcnt lgkmcnt(2)
v_pk_add_f32 v[44:45], v[44:45], v[172:173]
v_pk_add_f32 v[46:47], v[46:47], v[174:175]
s_waitcnt lgkmcnt(1)
v_pk_add_f32 v[48:49], v[48:49], v[176:177]
v_pk_add_f32 v[50:51], v[50:51], v[178:179]
s_waitcnt lgkmcnt(0)
v_pk_add_f32 v[52:53], v[52:53], v[180:181]
v_pk_add_f32 v[54:55], v[54:55], v[182:183]
v_cvt_pk_bf16_f32 v248, v40, v41
v_cvt_pk_bf16_f32 v249, v42, v43
v_cvt_pk_bf16_f32 v250, v44, v45
v_cvt_pk_bf16_f32 v251, v46, v47
v_cvt_pk_bf16_f32 v252, v48, v49
v_cvt_pk_bf16_f32 v253, v50, v51
v_cvt_pk_bf16_f32 v254, v52, v53
v_cvt_pk_bf16_f32 v255, v54, v55
v_and_b32 v248, -2, v248
v_and_b32 v252, -2, v252
s_add_u32 s66, s50, s55
s_add_u32 s66, s66, 4194304
s_cmp_eq_u32 s54, 0
s_cbranch_scc1 L_sc20
buffer_store_dwordx4 v[248:251], v1, s[32:35], s66 offen offset:0
buffer_store_dwordx4 v[252:255], v1, s[32:35], s66 offen offset:1024
L_sj21:
v_pk_add_f32 v[232:233], v[40:41], v[42:43]
v_pk_mul_f32 v[234:235], v[40:41], v[40:41]
v_pk_fma_f32 v[234:235], v[42:43], v[42:43], v[234:235]
v_pk_add_f32 v[232:233], v[232:233], v[44:45]
v_pk_fma_f32 v[234:235], v[44:45], v[44:45], v[234:235]
v_pk_add_f32 v[232:233], v[232:233], v[46:47]
v_pk_fma_f32 v[234:235], v[46:47], v[46:47], v[234:235]
v_pk_add_f32 v[232:233], v[232:233], v[48:49]
v_pk_fma_f32 v[234:235], v[48:49], v[48:49], v[234:235]
v_pk_add_f32 v[232:233], v[232:233], v[50:51]
v_pk_fma_f32 v[234:235], v[50:51], v[50:51], v[234:235]
v_pk_add_f32 v[232:233], v[232:233], v[52:53]
v_pk_fma_f32 v[234:235], v[52:53], v[52:53], v[234:235]
v_pk_add_f32 v[232:233], v[232:233], v[54:55]
v_pk_fma_f32 v[234:235], v[54:55], v[54:55], v[234:235]
v_add_f32 v232, v232, v233
v_add_f32 v234, v234, v235
s_add_u32 s65, s50, s68
s_add_u32 s65, s65, 14680064
v_permlane32_swap_b32 v232, v234
v_add_f32 v232, v232, v234
v_and_or_b32 v232, v232, -2, s7
s_cmp_eq_u32 s54, 0
s_cbranch_scc1 L_sc22
buffer_store_dword v232, v1, s[32:35], s65 offen
L_sj23:
s_cmp_eq_u32 s7, 0
s_cbranch_scc0 L_cj24
v_lshrrev_b32 v168, 2, v0
v_lshrrev_b32 v169, 4, v0
v_xor_b32 v168, v168, v169
v_and_b32 v168, 1, v168
v_add_u32 v168, -1, v168
v_and_b32 v168, 0x3f803f80, v168
v_mov_b32 v169, v168
v_mov_b32 v170, v168
v_mov_b32 v171, v168
s_nop 2
s_cmp_eq_u32 s48, 0
s_cbranch_scc0 L_cb25
v_mfma_f32_16x16x32_bf16 v[172:175], v[168:171], a[128:131], 0
v_mfma_f32_16x16x32_bf16 v[176:179], v[168:171], a[136:139], 0
v_mfma_f32_16x16x32_bf16 v[172:175], v[168:171], a[144:147], v[172:175]
v_mfma_f32_16x16x32_bf16 v[176:179], v[168:171], a[152:155], v[176:179]
v_mfma_f32_16x16x32_bf16 v[172:175], v[168:171], a[160:163], v[172:175]
v_mfma_f32_16x16x32_bf16 v[176:179], v[168:171], a[168:171], v[176:179]
v_mfma_f32_16x16x32_bf16 v[172:175], v[168:171], a[176:179], v[172:175]
v_mfma_f32_16x16x32_bf16 v[176:179], v[168:171], a[184:187], v[176:179]
v_mfma_f32_16x16x32_bf16 v[172:175], v[168:171], a[192:195], v[172:175]
v_mfma_f32_16x16x32_bf16 v[176:179], v[168:171], a[200:203], v[176:179]
v_mfma_f32_16x16x32_bf16 v[172:175], v[168:171], a[208:211], v[172:175]
v_mfma_f32_16x16x32_bf16 v[176:179], v[168:171], a[216:219], v[176:179]
v_mfma_f32_16x16x32_bf16 v[172:175], v[168:171], a[224:227], v[172:175]
v_mfma_f32_16x16x32_bf16 v[176:179], v[168:171], a[232:235], v[176:179]
v_mfma_f32_16x16x32_bf16 v[172:175], v[168:171], a[240:243], v[172:175]
v_mfma_f32_16x16x32_bf16 v[176:179], v[168:171], a[248:251], v[176:179]
s_nop 11
s_branch L_ce26
L_cb25:
v_mfma_f32_16x16x32_bf16 v[172:175], v[168:171], a[132:135], 0
v_mfma_f32_16x16x32_bf16 v[176:179], v[168:171], a[140:143], 0
v_mfma_f32_16x16x32_bf16 v[172:175], v[168:171], a[148:151], v[172:175]
v_mfma_f32_16x16x32_bf16 v[176:179], v[168:171], a[156:159], v[176:179]
v_mfma_f32_16x16x32_bf16 v[172:175], v[168:171], a[164:167], v[172:175]
v_mfma_f32_16x16x32_bf16 v[176:179], v[168:171], a[172:175], v[176:179]
v_mfma_f32_16x16x32_bf16 v[172:175], v[168:171], a[180:183], v[172:175]
v_mfma_f32_16x16x32_bf16 v[176:179], v[168:171], a[188:191], v[176:179]
v_mfma_f32_16x16x32_bf16 v[172:175], v[168:171], a[196:199], v[172:175]
v_mfma_f32_16x16x32_bf16 v[176:179], v[168:171], a[204:207], v[176:179]
v_mfma_f32_16x16x32_bf16 v[172:175], v[168:171], a[212:215], v[172:175]
v_mfma_f32_16x16x32_bf16 v[176:179], v[168:171], a[220:223], v[176:179]
v_mfma_f32_16x16x32_bf16 v[172:175], v[168:171], a[228:231], v[172:175]
v_mfma_f32_16x16x32_bf16 v[176:179], v[168:171], a[236:239], v[176:179]
v_mfma_f32_16x16x32_bf16 v[172:175], v[168:171], a[244:247], v[172:175]
v_mfma_f32_16x16x32_bf16 v[176:179], v[168:171], a[252:255], v[176:179]
s_nop 11
L_ce26:
v_add_f32 v172, v172, v176
s_mov_b32 exec_hi, 0
ds_add_f32 v26, v172 offset:768
s_mov_b32 exec_hi, -1
L_cj24:
s_lshl1_add_u32 s63, s97, 1572864
s_load_dwordx2 s[0:1], s[28:29], s63 offset:444
s_load_dwordx2 s[0:1], s[28:29], s63 offset:1468
s_and_b32 s63, s97, 0x1c000
s_lshl1_add_u32 s63, s63, s97
s_lshl_b32 s63, s63, 2
s_load_dwordx2 s[0:1], s[28:29], s63 offset:444
s_load_dwordx2 s[0:1], s[28:29], s63 offset:1468
s_load_dwordx2 s[0:1], s[28:29], s63 offset:2492
s_load_dwordx2 s[0:1], s[28:29], s63 offset:3516
s_and_b32 s63, s97, 0x1c000
s_lshl1_add_u32 s63, s63, s97
s_lshl_b32 s63, s63, 2
s_load_dwordx2 s[0:1], s[28:29], s63 offset:65980
s_add_u32 s63, s52, 48
L_pl27:
buffer_load_dword v37, v28, s[32:35], s51 offen sc1
s_waitcnt vmcnt(0)
v_cmp_gt_u32 vcc, s63, v37
s_cbranch_vccz L_pd28
s_sub_u32 s53, s53, 1
s_cbranch_scc0 L_pl27
s_endpgm
L_pd28:
s_add_u32 s64, s50, 4194304
buffer_load_dwordx4 v[72:75], v2, s[32:35], s64 offen offset:0 sc1
s_lshl_b32 s66, s48, 14
s_xor_b32 s63, s66, 0x4000
v_xor_b32 v8, s63, v8
v_xor_b32 v9, s63, v9
ds_read_b64_tr_b16 a[4:5], v9 offset:0
ds_read_b64_tr_b16 a[6:7], v9 offset:1024
ds_read_b64_tr_b16 a[0:1], v8 offset:0
ds_read_b64_tr_b16 a[2:3], v8 offset:1024
ds_read_b64_tr_b16 a[12:13], v9 offset:2048
buffer_load_dwordx4 v[76:79], v2, s[32:35], s64 offen offset:1024 sc1
ds_read_b64_tr_b16 a[14:15], v9 offset:3072
ds_read_b64_tr_b16 a[8:9], v8 offset:2048
ds_read_b64_tr_b16 a[10:11], v8 offset:3072
ds_read_b64_tr_b16 a[20:21], v9 offset:4096
ds_read_b64_tr_b16 a[22:23], v9 offset:5120
buffer_load_dwordx4 v[80:83], v2, s[32:35], s64 offen offset:2048 sc1
ds_read_b64_tr_b16 a[16:17], v8 offset:4096
ds_read_b64_tr_b16 a[18:19], v8 offset:5120
ds_read_b64_tr_b16 a[28:29], v9 offset:6144
ds_read_b64_tr_b16 a[30:31], v9 offset:7168
ds_read_b64_tr_b16 a[24:25], v8 offset:6144
buffer_load_dwordx4 v[84:87], v2, s[32:35], s64 offen offset:3072 sc1
ds_read_b64_tr_b16 a[26:27], v8 offset:7168
ds_read_b64_tr_b16 a[36:37], v9 offset:8192
ds_read_b64_tr_b16 a[38:39], v9 offset:9216
ds_read_b64_tr_b16 a[32:33], v8 offset:8192
ds_read_b64_tr_b16 a[34:35], v8 offset:9216
buffer_load_dwordx4 v[88:91], v3, s[32:35], s64 offen offset:0 sc1
ds_read_b64_tr_b16 a[44:45], v9 offset:10240
ds_read_b64_tr_b16 a[46:47], v9 offset:11264
ds_read_b64_tr_b16 a[40:41], v8 offset:10240
ds_read_b64_tr_b16 a[42:43], v8 offset:11264
ds_read_b64_tr_b16 a[52:53], v9 offset:12288
buffer_load_dwordx4 v[92:95], v3, s[32:35], s64 offen offset:1024 sc1
ds_read_b64_tr_b16 a[54:55], v9 offset:13312
ds_read_b64_tr_b16 a[48:49], v8 offset:12288
ds_read_b64_tr_b16 a[50:51], v8 offset:13312
ds_read_b64_tr_b16 a[60:61], v9 offset:14336
ds_read_b64_tr_b16 a[62:63], v9 offset:15360
buffer_load_dwordx4 v[96:99], v3, s[32:35], s64 offen offset:2048 sc1
ds_read_b64_tr_b16 a[56:57], v8 offset:14336
ds_read_b64_tr_b16 a[58:59], v8 offset:15360
v_xor_b32 v8, 0x4000, v8
v_xor_b32 v9, 0x4000, v9
ds_read_b64_tr_b16 a[68:69], v9 offset:0
ds_read_b64_tr_b16 a[70:71], v9 offset:1024
ds_read_b64_tr_b16 a[64:65], v8 offset:0
buffer_load_dwordx4 v[100:103], v3, s[32:35], s64 offen offset:3072 sc1
ds_read_b64_tr_b16 a[66:67], v8 offset:1024
ds_read_b64_tr_b16 a[76:77], v9 offset:2048
ds_read_b64_tr_b16 a[78:79], v9 offset:3072
ds_read_b64_tr_b16 a[72:73], v8 offset:2048
ds_read_b64_tr_b16 a[74:75], v8 offset:3072
s_waitcnt vmcnt(7)
v_mfma_f32_32x32x16_bf16 v[216:231], a[132:135], v[72:75], 0
ds_read_b64_tr_b16 a[84:85], v9 offset:4096
ds_read_b64_tr_b16 a[86:87], v9 offset:5120
v_mfma_f32_32x32x16_bf16 v[200:215], a[128:131], v[72:75], 0
ds_read_b64_tr_b16 a[80:81], v8 offset:4096
ds_read_b64_tr_b16 a[82:83], v8 offset:5120
buffer_load_dwordx4 v[104:107], v4, s[32:35], s64 offen offset:0 sc1
s_waitcnt vmcnt(7)
v_mfma_f32_32x32x16_bf16 v[216:231], a[140:143], v[76:79], v[216:231]
ds_read_b64_tr_b16 a[92:93], v9 offset:6144
ds_read_b64_tr_b16 a[94:95], v9 offset:7168
v_mfma_f32_32x32x16_bf16 v[200:215], a[136:139], v[76:79], v[200:215]
ds_read_b64_tr_b16 a[88:89], v8 offset:6144
ds_read_b64_tr_b16 a[90:91], v8 offset:7168
buffer_load_dwordx4 v[108:111], v4, s[32:35], s64 offen offset:1024 sc1
s_waitcnt vmcnt(7)
v_mfma_f32_32x32x16_bf16 v[216:231], a[148:151], v[80:83], v[216:231]
v_bitop3_b32 v248, v72, v76, v80 bitop3:0xfe
ds_read_b64_tr_b16 a[100:101], v9 offset:8192
ds_read_b64_tr_b16 a[102:103], v9 offset:9216
v_mfma_f32_32x32x16_bf16 v[200:215], a[144:147], v[80:83], v[200:215]
ds_read_b64_tr_b16 a[96:97], v8 offset:8192
ds_read_b64_tr_b16 a[98:99], v8 offset:9216
buffer_load_dwordx4 v[112:115], v4, s[32:35], s64 offen offset:2048 sc1
s_waitcnt vmcnt(7)
v_mfma_f32_32x32x16_bf16 v[216:231], a[156:159], v[84:87], v[216:231]
ds_read_b64_tr_b16 a[108:109], v9 offset:10240
ds_read_b64_tr_b16 a[110:111], v9 offset:11264
v_mfma_f32_32x32x16_bf16 v[200:215], a[152:155], v[84:87], v[200:215]
ds_read_b64_tr_b16 a[104:105], v8 offset:10240
ds_read_b64_tr_b16 a[106:107], v8 offset:11264
buffer_load_dwordx4 v[116:119], v4, s[32:35], s64 offen offset:3072 sc1
s_waitcnt vmcnt(7)
v_mfma_f32_32x32x16_bf16 v[216:231], a[164:167], v[88:91], v[216:231]
v_bitop3_b32 v248, v248, v84, v88 bitop3:0xfe
ds_read_b64_tr_b16 a[116:117], v9 offset:12288
ds_read_b64_tr_b16 a[118:119], v9 offset:13312
v_mfma_f32_32x32x16_bf16 v[200:215], a[160:163], v[88:91], v[200:215]
ds_read_b64_tr_b16 a[112:113], v8 offset:12288
ds_read_b64_tr_b16 a[114:115], v8 offset:13312
buffer_load_dwordx4 v[120:123], v5, s[32:35], s64 offen offset:0 sc1
s_waitcnt vmcnt(7)
v_mfma_f32_32x32x16_bf16 v[216:231], a[172:175], v[92:95], v[216:231]
ds_read_b64_tr_b16 a[124:125], v9 offset:14336
ds_read_b64_tr_b16 a[126:127], v9 offset:15360
v_mfma_f32_32x32x16_bf16 v[200:215], a[168:171], v[92:95], v[200:215]
ds_read_b64_tr_b16 a[120:121], v8 offset:14336
buffer_load_dwordx4 v[124:127], v5, s[32:35], s64 offen offset:1024 sc1
ds_read_b64_tr_b16 a[122:123], v8 offset:15360
v_xor_b32 v8, s66, v8
v_xor_b32 v9, s66, v9
s_waitcnt vmcnt(7)
v_mfma_f32_32x32x16_bf16 v[216:231], a[180:183], v[96:99], v[216:231]
v_bitop3_b32 v248, v248, v92, v96 bitop3:0xfe
v_mfma_f32_32x32x16_bf16 v[200:215], a[176:179], v[96:99], v[200:215]
buffer_load_dwordx4 v[128:131], v5, s[32:35], s64 offen offset:2048 sc1
s_waitcnt vmcnt(7)
v_mfma_f32_32x32x16_bf16 v[216:231], a[188:191], v[100:103], v[216:231]
s_waitcnt lgkmcnt(0)
s_barrier
v_mfma_f32_32x32x16_bf16 v[200:215], a[184:187], v[100:103], v[200:215]
buffer_load_dwordx4 v[132:135], v5, s[32:35], s64 offen offset:3072 sc1
s_waitcnt vmcnt(7)
v_mfma_f32_32x32x16_bf16 v[216:231], a[196:199], v[104:107], v[216:231]
v_bitop3_b32 v248, v248, v100, v104 bitop3:0xfe
ds_read_b128 v[184:187], v25 offset:768
v_mfma_f32_32x32x16_bf16 v[200:215], a[192:195], v[104:107], v[200:215]
ds_read_b128 v[188:191], v25 offset:800
s_lshl_b32 s65, s48, 12
s_add_u32 s65, s65, s50
s_add_u32 s65, s65, 14680064
buffer_load_dwordx4 v[232:235], v1, s[32:35], s65 offen offset:0 sc1
s_waitcnt vmcnt(7)
v_mfma_f32_32x32x16_bf16 v[216:231], a[204:207], v[108:111], v[216:231]
ds_read_b128 v[192:195], v25 offset:832
v_mfma_f32_32x32x16_bf16 v[200:215], a[200:203], v[108:111], v[200:215]
ds_read_b128 v[196:199], v25 offset:864
buffer_load_dwordx4 v[236:239], v1, s[32:35], s65 offen offset:1024 sc1
s_waitcnt vmcnt(7)
v_mfma_f32_32x32x16_bf16 v[216:231], a[212:215], v[112:115], v[216:231]
v_bitop3_b32 v248, v248, v108, v112 bitop3:0xfe
v_mfma_f32_32x32x16_bf16 v[200:215], a[208:211], v[112:115], v[200:215]
buffer_load_dwordx4 v[240:243], v1, s[32:35], s65 offen offset:2048 sc1
s_waitcnt vmcnt(7)
v_mfma_f32_32x32x16_bf16 v[216:231], a[220:223], v[116:119], v[216:231]
v_mfma_f32_32x32x16_bf16 v[200:215], a[216:219], v[116:119], v[200:215]
buffer_load_dwordx4 v[244:247], v1, s[32:35], s65 offen offset:3072 sc1
s_waitcnt vmcnt(7)
v_mfma_f32_32x32x16_bf16 v[216:231], a[228:231], v[120:123], v[216:231]
v_bitop3_b32 v248, v248, v116, v120 bitop3:0xfe
v_mfma_f32_32x32x16_bf16 v[200:215], a[224:227], v[120:123], v[200:215]
s_add_u32 m0, s56, 65536
s_add_u32 s62, s59, 128
buffer_load_dwordx4 v19, s[24:27], s62 offen offset:0 lds
s_waitcnt vmcnt(7)
v_mfma_f32_32x32x16_bf16 v[216:231], a[236:239], v[124:127], v[216:231]
v_mfma_f32_32x32x16_bf16 v[200:215], a[232:235], v[124:127], v[200:215]
buffer_load_dwordx4 v20, s[24:27], s62 offen offset:1024 lds
s_waitcnt vmcnt(7)
v_mfma_f32_32x32x16_bf16 v[216:231], a[244:247], v[128:131], v[216:231]
v_bitop3_b32 v248, v248, v124, v128 bitop3:0xfe
v_mfma_f32_32x32x16_bf16 v[200:215], a[240:243], v[128:131], v[200:215]
buffer_load_dwordx4 v21, s[24:27], s62 offen offset:2048 lds
s_waitcnt vmcnt(7)
v_mfma_f32_32x32x16_bf16 v[216:231], a[252:255], v[132:135], v[216:231]
v_bitop3_b32 v248, v248, v132, v132 bitop3:0xfe
v_and_b32 v248, 1, v248
v_cmp_ne_u32 vcc, 0, v248
v_mfma_f32_32x32x16_bf16 v[200:215], a[248:251], v[132:135], v[200:215]
s_cbranch_vccnz L_rt29
L_rb30:
s_nop 6
ds_write_b128 v23, v[216:219] offset:0
ds_write_b128 v23, v[220:223] offset:1024
ds_write_b128 v23, v[224:227] offset:2048
ds_write_b128 v23, v[228:231] offset:3072
s_waitcnt vmcnt(6)
v_bitop3_b32 v248, v232, v233, s7 bitop3:0x7e
buffer_load_dwordx4 v22, s[24:27], s62 offen offset:3072 lds
v_bitop3_b32 v248, v248, v234, s7 bitop3:0xf6
v_bitop3_b32 v248, v248, v235, s7 bitop3:0xf6
s_waitcnt vmcnt(6)
v_bitop3_b32 v248, v248, v236, s7 bitop3:0xf6
v_bitop3_b32 v248, v248, v237, s7 bitop3:0xf6
v_bitop3_b32 v248, v248, v238, s7 bitop3:0xf6
v_bitop3_b32 v248, v248, v239, s7 bitop3:0xf6
s_waitcnt vmcnt(5)
v_bitop3_b32 v248, v248, v240, s7 bitop3:0xf6
s_add_u32 m0, s56, 69632
s_add_u32 s62, s59, 114816
buffer_load_dwordx4 v19, s[24:27], s62 offen offset:0 lds
v_bitop3_b32 v248, v248, v241, s7 bitop3:0xf6
v_bitop3_b32 v248, v248, v242, s7 bitop3:0xf6
v_bitop3_b32 v248, v248, v243, s7 bitop3:0xf6
s_waitcnt vmcnt(5)
v_bitop3_b32 v248, v248, v244, s7 bitop3:0xf6
v_bitop3_b32 v248, v248, v245, s7 bitop3:0xf6
v_bitop3_b32 v248, v248, v246, s7 bitop3:0xf6
v_bitop3_b32 v248, v248, v247, s7 bitop3:0xf6
v_and_b32 v248, 1, v248
v_cmp_ne_u32 vcc, 0, v248
s_cbranch_vccnz L_rt31
L_rb32:
s_waitcnt lgkmcnt(0)
s_barrier
buffer_load_dwordx4 v20, s[24:27], s62 offen offset:1024 lds
ds_read_b128 v[168:171], v24 offset:0
ds_read_b128 v[172:175], v24 offset:1024
ds_read_b128 v[176:179], v24 offset:2048
ds_read_b128 v[180:183], v24 offset:3072
v_add_f32 v232, v232, v240
v_add_f32 v233, v233, v241
v_add_f32 v234, v234, v242
v_add_f32 v235, v235, v243
v_add_f32 v236, v236, v244
v_add_f32 v237, v237, v245
v_add_f32 v238, v238, v246
buffer_load_dwordx4 v21, s[24:27], s62 offen offset:2048 lds
v_add_f32 v239, v239, v247
v_add_f32 v232, v232, v236
v_add_f32 v233, v233, v237
v_add_f32 v234, v234, v238
v_add_f32 v235, v235, v239
v_add_f32 v232, v232, v234
v_add_f32 v233, v233, v235
v_add_f32 v232, v232, v233
v_mul_f32 v232, 0x3b000000, v232
v_mov_b32 v233, v232
s_nop 1
v_permlane32_swap_b32 v232, v233
buffer_load_dwordx4 v22, s[24:27], s62 offen offset:3072 lds
v_mul_f32 v34, -1.0, v232
v_fmac_f32 v233, v34, v232
v_max_f32 v233, 0, v233
v_add_f32 v232, 0x3727c5ac, v233
v_rsq_f32 v35, v232
s_nop 0
v_mul_f32 v233, v233, v35
v_fmaak_f32 v233, v233, v35, 0x3727c5ac
v_rsq_f32 v233, v233
s_nop 0
v_mul_f32 v36, v233, v35
v_mul_f32 v244, v36, v36
v_mul_f32 v242, 0xc0135761, v36
s_add_u32 m0, s56, 73728
s_add_u32 s62, s59, 229504
buffer_load_dwordx4 v19, s[24:27], s62 offen offset:0 lds
v_rcp_f32 v246, v36
v_mul_f32 v244, 0x3d372713, v244
v_mul_f32 v244, v244, v242
v_pk_fma_f32 v[200:201], v[184:185], v[34:35], v[200:201] op_sel_hi:[1,0,1]
v_pk_fma_f32 v[202:203], v[186:187], v[34:35], v[202:203] op_sel_hi:[1,0,1]
v_pk_fma_f32 v[204:205], v[188:189], v[34:35], v[204:205] op_sel_hi:[1,0,1]
v_pk_fma_f32 v[206:207], v[190:191], v[34:35], v[206:207] op_sel_hi:[1,0,1]
v_pk_fma_f32 v[208:209], v[192:193], v[34:35], v[208:209] op_sel_hi:[1,0,1]
v_pk_fma_f32 v[210:211], v[194:195], v[34:35], v[210:211] op_sel_hi:[1,0,1]
v_pk_fma_f32 v[212:213], v[196:197], v[34:35], v[212:213] op_sel_hi:[1,0,1]
v_pk_fma_f32 v[214:215], v[198:199], v[34:35], v[214:215] op_sel_hi:[1,0,1]
s_waitcnt lgkmcnt(3)
v_pk_add_f32 v[200:201], v[200:201], v[168:169]
buffer_load_dwordx4 v20, s[24:27], s62 offen offset:1024 lds
v_pk_add_f32 v[202:203], v[202:203], v[170:171]
v_pk_mul_f32 v[184:185], v[200:201], v[200:201]
v_pk_mul_f32 v[186:187], v[202:203], v[202:203]
v_pk_fma_f32 v[184:185], v[184:185], v[244:245], v[242:243] op_sel_hi:[1,0,0]
v_pk_fma_f32 v[186:187], v[186:187], v[244:245], v[242:243] op_sel_hi:[1,0,0]
v_pk_mul_f32 v[184:185], v[184:185], v[200:201]
v_pk_mul_f32 v[186:187], v[186:187], v[202:203]
buffer_load_dwordx4 v21, s[24:27], s62 offen offset:2048 lds
v_exp_f32 v184, v184
v_exp_f32 v185, v185
v_exp_f32 v186, v186
v_exp_f32 v187, v187
v_pk_fma_f32 v[184:185], v[184:185], v[246:247], v[246:247] op_sel_hi:[1,0,0]
v_pk_fma_f32 v[186:187], v[186:187], v[246:247], v[246:247] op_sel_hi:[1,0,0]
v_rcp_f32 v184, v184
buffer_load_dwordx4 v22, s[24:27], s62 offen offset:3072 lds
v_rcp_f32 v185, v185
v_rcp_f32 v186, v186
v_rcp_f32 v187, v187
v_pk_mul_f32 v[200:201], v[200:201], v[184:185]
v_pk_mul_f32 v[202:203], v[202:203], v[186:187]
s_waitcnt lgkmcnt(2)
v_pk_add_f32 v[204:205], v[204:205], v[172:173]
v_pk_add_f32 v[206:207], v[206:207], v[174:175]
s_add_u32 m0, s56, 77824
s_add_u32 s62, s59, 344192
buffer_load_dwordx4 v19, s[24:27], s62 offen offset:0 lds
v_pk_mul_f32 v[188:189], v[204:205], v[204:205]
v_pk_mul_f32 v[190:191], v[206:207], v[206:207]
v_pk_fma_f32 v[188:189], v[188:189], v[244:245], v[242:243] op_sel_hi:[1,0,0]
v_pk_fma_f32 v[190:191], v[190:191], v[244:245], v[242:243] op_sel_hi:[1,0,0]
v_pk_mul_f32 v[188:189], v[188:189], v[204:205]
v_pk_mul_f32 v[190:191], v[190:191], v[206:207]
v_exp_f32 v188, v188
v_exp_f32 v189, v189
buffer_load_dwordx4 v20, s[24:27], s62 offen offset:1024 lds
v_exp_f32 v190, v190
v_exp_f32 v191, v191
v_pk_fma_f32 v[188:189], v[188:189], v[246:247], v[246:247] op_sel_hi:[1,0,0]
v_pk_fma_f32 v[190:191], v[190:191], v[246:247], v[246:247] op_sel_hi:[1,0,0]
v_rcp_f32 v188, v188
v_rcp_f32 v189, v189
v_rcp_f32 v190, v190
buffer_load_dwordx4 v21, s[24:27], s62 offen offset:2048 lds
v_rcp_f32 v191, v191
v_pk_mul_f32 v[204:205], v[204:205], v[188:189]
v_pk_mul_f32 v[206:207], v[206:207], v[190:191]
s_waitcnt lgkmcnt(1)
v_pk_add_f32 v[208:209], v[208:209], v[176:177]
v_pk_add_f32 v[210:211], v[210:211], v[178:179]
v_pk_mul_f32 v[192:193], v[208:209], v[208:209]
v_pk_mul_f32 v[194:195], v[210:211], v[210:211]
buffer_load_dwordx4 v22, s[24:27], s62 offen offset:3072 lds
v_pk_fma_f32 v[192:193], v[192:193], v[244:245], v[242:243] op_sel_hi:[1,0,0]
v_pk_fma_f32 v[194:195], v[194:195], v[244:245], v[242:243] op_sel_hi:[1,0,0]
v_pk_mul_f32 v[192:193], v[192:193], v[208:209]
v_pk_mul_f32 v[194:195], v[194:195], v[210:211]
v_exp_f32 v192, v192
v_exp_f32 v193, v193
v_exp_f32 v194, v194
v_exp_f32 v195, v195
v_pk_fma_f32 v[192:193], v[192:193], v[246:247], v[246:247] op_sel_hi:[1,0,0]
v_pk_fma_f32 v[194:195], v[194:195], v[246:247], v[246:247] op_sel_hi:[1,0,0]
v_rcp_f32 v192, v192
v_rcp_f32 v193, v193
v_rcp_f32 v194, v194
v_rcp_f32 v195, v195
v_pk_mul_f32 v[208:209], v[208:209], v[192:193]
v_pk_mul_f32 v[210:211], v[210:211], v[194:195]
s_waitcnt lgkmcnt(0)
v_pk_add_f32 v[212:213], v[212:213], v[180:181]
v_pk_add_f32 v[214:215], v[214:215], v[182:183]
v_pk_mul_f32 v[196:197], v[212:213], v[212:213]
v_pk_mul_f32 v[198:199], v[214:215], v[214:215]
v_pk_fma_f32 v[196:197], v[196:197], v[244:245], v[242:243] op_sel_hi:[1,0,0]
v_pk_fma_f32 v[198:199], v[198:199], v[244:245], v[242:243] op_sel_hi:[1,0,0]
v_pk_mul_f32 v[196:197], v[196:197], v[212:213]
v_pk_mul_f32 v[198:199], v[198:199], v[214:215]
v_exp_f32 v196, v196
v_exp_f32 v197, v197
v_exp_f32 v198, v198
v_exp_f32 v199, v199
v_pk_fma_f32 v[196:197], v[196:197], v[246:247], v[246:247] op_sel_hi:[1,0,0]
v_pk_fma_f32 v[198:199], v[198:199], v[246:247], v[246:247] op_sel_hi:[1,0,0]
v_rcp_f32 v196, v196
v_rcp_f32 v197, v197
v_rcp_f32 v198, v198
v_rcp_f32 v199, v199
v_pk_mul_f32 v[212:213], v[212:213], v[196:197]
v_pk_mul_f32 v[214:215], v[214:215], v[198:199]
s_add_u32 s63, s3, 64
v_mov_b32 v37, s63
s_cmp_eq_u32 s54, 0
s_cbranch_scc1 L_sc33
buffer_store_dword v37, v27, s[32:35], s67 offen
L_sj34:
buffer_store_dword v37, v27, s[32:35], s75 offen sc1
v_cvt_pk_bf16_f32 v248, v200, v201
v_cvt_pk_bf16_f32 v249, v202, v203
v_cvt_pk_bf16_f32 v250, v204, v205
v_cvt_pk_bf16_f32 v251, v206, v207
v_cvt_pk_bf16_f32 v252, v208, v209
v_cvt_pk_bf16_f32 v253, v210, v211
v_cvt_pk_bf16_f32 v254, v212, v213
v_cvt_pk_bf16_f32 v255, v214, v215
v_or_b32 v248, 1, v248
v_or_b32 v252, 1, v252
s_add_u32 s66, s50, s55
s_add_u32 s66, s66, 6291456
s_cmp_eq_u32 s54, 0
s_cbranch_scc1 L_sc35
buffer_store_dwordx4 v[248:251], v1, s[32:35], s66 offen offset:0
buffer_store_dwordx4 v[252:255], v1, s[32:35], s66 offen offset:1024
L_sj36:
s_add_u32 s66, s66, 10485760
buffer_store_dwordx4 v[248:251], v38, s[32:35], s66 offen offset:0 sc1
buffer_store_dwordx4 v[252:255], v38, s[32:35], s66 offen offset:1024 sc1
v_pk_add_f32 v[56:57], v[40:41], v[34:35] op_sel_hi:[1,0]
v_pk_add_f32 v[58:59], v[42:43], v[34:35] op_sel_hi:[1,0]
v_pk_add_f32 v[60:61], v[44:45], v[34:35] op_sel_hi:[1,0]
v_pk_add_f32 v[62:63], v[46:47], v[34:35] op_sel_hi:[1,0]
v_pk_add_f32 v[64:65], v[48:49], v[34:35] op_sel_hi:[1,0]
v_pk_add_f32 v[66:67], v[50:51], v[34:35] op_sel_hi:[1,0]
v_pk_add_f32 v[68:69], v[52:53], v[34:35] op_sel_hi:[1,0]
v_pk_add_f32 v[70:71], v[54:55], v[34:35] op_sel_hi:[1,0]
v_pk_mul_f32 v[56:57], v[56:57], v[34:35] op_sel:[0,1] op_sel_hi:[1,1]
v_pk_mul_f32 v[58:59], v[58:59], v[34:35] op_sel:[0,1] op_sel_hi:[1,1]
v_pk_mul_f32 v[60:61], v[60:61], v[34:35] op_sel:[0,1] op_sel_hi:[1,1]
v_pk_mul_f32 v[62:63], v[62:63], v[34:35] op_sel:[0,1] op_sel_hi:[1,1]
v_pk_mul_f32 v[64:65], v[64:65], v[34:35] op_sel:[0,1] op_sel_hi:[1,1]
v_pk_mul_f32 v[66:67], v[66:67], v[34:35] op_sel:[0,1] op_sel_hi:[1,1]
v_pk_mul_f32 v[68:69], v[68:69], v[34:35] op_sel:[0,1] op_sel_hi:[1,1]
v_pk_mul_f32 v[70:71], v[70:71], v[34:35] op_sel:[0,1] op_sel_hi:[1,1]
s_and_b32 s63, s97, 0x1c000
s_lshl1_add_u32 s63, s63, s97
s_lshl_b32 s63, s63, 2
s_load_dwordx2 s[0:1], s[28:29], s63 offset:67004
s_load_dwordx2 s[0:1], s[28:29], s63 offset:68028
s_load_dwordx2 s[0:1], s[28:29], s63 offset:69052
s_and_b32 s63, s97, 0x1c000
s_lshl1_add_u32 s63, s63, s97
s_lshl_b32 s63, s63, 2
s_load_dwordx2 s[0:1], s[28:29], s63 offset:131516
s_load_dwordx2 s[0:1], s[28:29], s63 offset:132540
s_load_dwordx2 s[0:1], s[28:29], s63 offset:133564
s_load_dwordx2 s[0:1], s[28:29], s63 offset:134588
s_and_b32 s98, s5, 4
s_lshl1_add_u32 s98, s49, s98
s_lshl_b32 s99, s5, 7
s_mul_i32 s93, s98, 196608
s_add_u32 s93, s93, s99
s_xor_b32 s92, s93, 512
s_add_u32 s98, s98, 48
s_lshl_b32 s95, s98, 15
s_add_u32 s95, s95, s99
s_xor_b32 s94, s95, 512
s_mul_i32 s98, s48, 65536
s_cmp_eq_u32 s48, 0
s_cselect_b32 s76, s93, s92
s_add_u32 s76, s76, s98
s_add_u32 s76, s76, 0
s_mul_i32 s98, s48, 65536
s_cmp_eq_u32 s48, 0
s_cselect_b32 s77, s93, s92
s_add_u32 s77, s77, s98
s_add_u32 s77, s77, 32768
s_mul_i32 s98, s48, 65536
s_cmp_eq_u32 s48, 0
s_cselect_b32 s78, s93, s92
s_add_u32 s78, s78, s98
s_add_u32 s78, s78, 196608
s_mul_i32 s98, s48, 65536
s_cmp_eq_u32 s48, 0
s_cselect_b32 s79, s93, s92
s_add_u32 s79, s79, s98
s_add_u32 s79, s79, 229376
s_mul_i32 s98, s48, -131072
s_cmp_eq_u32 s48, 0
s_cselect_b32 s80, s92, s94
s_add_u32 s80, s80, s98
s_add_u32 s80, s80, 131072
s_mul_i32 s98, s48, -131072
s_cmp_eq_u32 s48, 0
s_cselect_b32 s81, s92, s94
s_add_u32 s81, s81, s98
s_add_u32 s81, s81, 163840
s_mul_i32 s98, s48, -262144
s_cmp_eq_u32 s48, 0
s_cselect_b32 s82, s92, s93
s_add_u32 s82, s82, s98
s_add_u32 s82, s82, 327680
s_mul_i32 s98, s48, -262144
s_cmp_eq_u32 s48, 0
s_cselect_b32 s83, s92, s93
s_add_u32 s83, s83, s98
s_add_u32 s83, s83, 360448
s_mul_i32 s98, s48, 65536
s_cmp_eq_u32 s48, 0
s_cselect_b32 s84, s93, s93
s_add_u32 s84, s84, s98
s_add_u32 s84, s84, 262144
s_mul_i32 s98, s48, 65536
s_cmp_eq_u32 s48, 0
s_cselect_b32 s85, s93, s93
s_add_u32 s85, s85, s98
s_add_u32 s85, s85, 294912
s_mul_i32 s98, s48, -131072
s_cmp_eq_u32 s48, 0
s_cselect_b32 s86, s93, s95
s_add_u32 s86, s86, s98
s_add_u32 s86, s86, 131072
s_mul_i32 s98, s48, -131072
s_cmp_eq_u32 s48, 0
s_cselect_b32 s87, s93, s95
s_add_u32 s87, s87, s98
s_add_u32 s87, s87, 163840
s_mul_i32 s98, s48, 196608
s_cmp_eq_u32 s48, 0
s_cselect_b32 s88, s92, s92
s_add_u32 s88, s88, s98
s_add_u32 s88, s88, 0
s_mul_i32 s98, s48, 196608
s_cmp_eq_u32 s48, 0
s_cselect_b32 s89, s92, s92
s_add_u32 s89, s89, s98
s_add_u32 s89, s89, 32768
s_lshr_b32 s98, s5, 2
s_lshl_b32 s98, s98, 14
s_add_u32 s98, s98, s50
s_lshl_b32 s99, s49, 13
s_sub_u32 s90, s98, s99
s_lshr_b32 s99, s99, 1
s_sub_u32 s91, s90, s99
s_add_u32 s63, s52, 64
L_pl37:
buffer_load_dword v37, v28, s[32:35], s51 offen sc1
s_waitcnt vmcnt(0)
v_cmp_gt_u32 vcc, s63, v37
s_cbranch_vccz L_pd38
s_sub_u32 s53, s53, 1
s_cbranch_scc0 L_pl37
s_endpgm
L_pd38:
s_mov_b32 s64, 4096
buffer_load_dwordx4 v[72:75], v31, s[32:35], 0 offen offset:0 sc1
ds_read_b64_tr_b16 a[132:133], v7 offset:0
ds_read_b64_tr_b16 a[134:135], v7 offset:1024
ds_read_b64_tr_b16 a[128:129], v6 offset:0
ds_read_b64_tr_b16 a[130:131], v6 offset:1024
ds_read_b64_tr_b16 a[140:141], v7 offset:2048
buffer_load_dwordx4 v[76:79], v31, s[32:35], 0 offen offset:1024 sc1
ds_read_b64_tr_b16 a[142:143], v7 offset:3072
ds_read_b64_tr_b16 a[136:137], v6 offset:2048
ds_read_b64_tr_b16 a[138:139], v6 offset:3072
ds_read_b64_tr_b16 a[148:149], v7 offset:4096
ds_read_b64_tr_b16 a[150:151], v7 offset:5120
buffer_load_dwordx4 v[80:83], v31, s[32:35], 0 offen offset:2048 sc1
ds_read_b64_tr_b16 a[144:145], v6 offset:4096
ds_read_b64_tr_b16 a[146:147], v6 offset:5120
ds_read_b64_tr_b16 a[156:157], v7 offset:6144
ds_read_b64_tr_b16 a[158:159], v7 offset:7168
ds_read_b64_tr_b16 a[152:153], v6 offset:6144
buffer_load_dwordx4 v[84:87], v31, s[32:35], 0 offen offset:3072 sc1
ds_read_b64_tr_b16 a[154:155], v6 offset:7168
ds_read_b64_tr_b16 a[164:165], v7 offset:8192
ds_read_b64_tr_b16 a[166:167], v7 offset:9216
ds_read_b64_tr_b16 a[160:161], v6 offset:8192
ds_read_b64_tr_b16 a[162:163], v6 offset:9216
buffer_load_dwordx4 v[88:91], v31, s[32:35], s64 offen offset:0 sc1
ds_read_b64_tr_b16 a[172:173], v7 offset:10240
ds_read_b64_tr_b16 a[174:175], v7 offset:11264
ds_read_b64_tr_b16 a[168:169], v6 offset:10240
ds_read_b64_tr_b16 a[170:171], v6 offset:11264
ds_read_b64_tr_b16 a[180:181], v7 offset:12288
buffer_load_dwordx4 v[92:95], v31, s[32:35], s64 offen offset:1024 sc1
ds_read_b64_tr_b16 a[182:183], v7 offset:13312
ds_read_b64_tr_b16 a[176:177], v6 offset:12288
ds_read_b64_tr_b16 a[178:179], v6 offset:13312
ds_read_b64_tr_b16 a[188:189], v7 offset:14336
ds_read_b64_tr_b16 a[190:191], v7 offset:15360
buffer_load_dwordx4 v[96:99], v31, s[32:35], s64 offen offset:2048 sc1
ds_read_b64_tr_b16 a[184:185], v6 offset:14336
ds_read_b64_tr_b16 a[186:187], v6 offset:15360
ds_read_b64_tr_b16 a[196:197], v7 offset:16384
ds_read_b64_tr_b16 a[198:199], v7 offset:17408
ds_read_b64_tr_b16 a[192:193], v6 offset:16384
buffer_load_dwordx4 v[100:103], v31, s[32:35], s64 offen offset:3072 sc1
ds_read_b64_tr_b16 a[194:195], v6 offset:17408
ds_read_b64_tr_b16 a[204:205], v7 offset:18432
ds_read_b64_tr_b16 a[206:207], v7 offset:19456
ds_read_b64_tr_b16 a[200:201], v6 offset:18432
ds_read_b64_tr_b16 a[202:203], v6 offset:19456
s_waitcnt vmcnt(7)
v_mfma_f32_32x32x16_bf16 v[216:231], a[4:7], v[72:75], 0
ds_read_b64_tr_b16 a[212:213], v7 offset:20480
ds_read_b64_tr_b16 a[214:215], v7 offset:21504
v_mfma_f32_32x32x16_bf16 v[200:215], a[0:3], v[72:75], 0
ds_read_b64_tr_b16 a[208:209], v6 offset:20480
ds_read_b64_tr_b16 a[210:211], v6 offset:21504
buffer_load_dwordx4 v[104:107], v32, s[32:35], 0 offen offset:0 sc1
s_waitcnt vmcnt(7)
v_mfma_f32_32x32x16_bf16 v[216:231], a[12:15], v[76:79], v[216:231]
ds_read_b64_tr_b16 a[220:221], v7 offset:22528
ds_read_b64_tr_b16 a[222:223], v7 offset:23552
v_mfma_f32_32x32x16_bf16 v[200:215], a[8:11], v[76:79], v[200:215]
ds_read_b64_tr_b16 a[216:217], v6 offset:22528
ds_read_b64_tr_b16 a[218:219], v6 offset:23552
buffer_load_dwordx4 v[108:111], v32, s[32:35], 0 offen offset:1024 sc1
s_waitcnt vmcnt(7)
v_mfma_f32_32x32x16_bf16 v[216:231], a[20:23], v[80:83], v[216:231]
v_bitop3_b32 v248, v72, v76, v80 bitop3:0x7f
ds_read_b64_tr_b16 a[228:229], v7 offset:24576
ds_read_b64_tr_b16 a[230:231], v7 offset:25600
v_mfma_f32_32x32x16_bf16 v[200:215], a[16:19], v[80:83], v[200:215]
ds_read_b64_tr_b16 a[224:225], v6 offset:24576
ds_read_b64_tr_b16 a[226:227], v6 offset:25600
buffer_load_dwordx4 v[112:115], v32, s[32:35], 0 offen offset:2048 sc1
s_waitcnt vmcnt(7)
v_mfma_f32_32x32x16_bf16 v[216:231], a[28:31], v[84:87], v[216:231]
ds_read_b64_tr_b16 a[236:237], v7 offset:26624
ds_read_b64_tr_b16 a[238:239], v7 offset:27648
v_mfma_f32_32x32x16_bf16 v[200:215], a[24:27], v[84:87], v[200:215]
ds_read_b64_tr_b16 a[232:233], v6 offset:26624
ds_read_b64_tr_b16 a[234:235], v6 offset:27648
buffer_load_dwordx4 v[116:119], v32, s[32:35], 0 offen offset:3072 sc1
s_waitcnt vmcnt(7)
v_mfma_f32_32x32x16_bf16 v[216:231], a[36:39], v[88:91], v[216:231]
v_bitop3_b32 v248, v248, v84, v88 bitop3:0xf7
ds_read_b64_tr_b16 a[244:245], v7 offset:28672
ds_read_b64_tr_b16 a[246:247], v7 offset:29696
v_mfma_f32_32x32x16_bf16 v[200:215], a[32:35], v[88:91], v[200:215]
ds_read_b64_tr_b16 a[240:241], v6 offset:28672
ds_read_b64_tr_b16 a[242:243], v6 offset:29696
buffer_load_dwordx4 v[120:123], v32, s[32:35], s64 offen offset:0 sc1
s_waitcnt vmcnt(7)
v_mfma_f32_32x32x16_bf16 v[216:231], a[44:47], v[92:95], v[216:231]
ds_read_b64_tr_b16 a[252:253], v7 offset:30720
ds_read_b64_tr_b16 a[254:255], v7 offset:31744
v_mfma_f32_32x32x16_bf16 v[200:215], a[40:43], v[92:95], v[200:215]
ds_read_b64_tr_b16 a[248:249], v6 offset:30720
ds_read_b64_tr_b16 a[250:251], v6 offset:31744
buffer_load_dwordx4 v[124:127], v32, s[32:35], s64 offen offset:1024 sc1
s_waitcnt vmcnt(7)
v_mfma_f32_32x32x16_bf16 v[216:231], a[52:55], v[96:99], v[216:231]
v_bitop3_b32 v248, v248, v92, v96 bitop3:0xf7
v_mfma_f32_32x32x16_bf16 v[200:215], a[48:51], v[96:99], v[200:215]
buffer_load_dwordx4 v[128:131], v32, s[32:35], s64 offen offset:2048 sc1
s_waitcnt vmcnt(7)
v_mfma_f32_32x32x16_bf16 v[216:231], a[60:63], v[100:103], v[216:231]
v_bitop3_b32 v248, v248, v100, v100 bitop3:0xf7
s_waitcnt lgkmcnt(0)
s_barrier
v_mfma_f32_32x32x16_bf16 v[200:215], a[56:59], v[100:103], v[200:215]
buffer_load_dwordx4 v[132:135], v32, s[32:35], s64 offen offset:3072 sc1
s_waitcnt vmcnt(7)
v_mfma_f32_32x32x16_bf16 v[216:231], a[68:71], v[104:107], v[216:231]
v_lshrrev_b32 v250, 30, v31
v_bitop3_b32 v248, v248, v250, 1 bitop3:0x20
v_lshrrev_b32 v250, 30, v32
v_mfma_f32_32x32x16_bf16 v[200:215], a[64:67], v[104:107], v[200:215]
s_add_u32 m0, s56, 0
s_add_u32 s62, s59, 256
buffer_load_dwordx4 v19, s[24:27], s62 offen offset:0 lds
s_waitcnt vmcnt(7)
v_mfma_f32_32x32x16_bf16 v[216:231], a[76:79], v[108:111], v[216:231]
buffer_load_dwordx4 v20, s[24:27], s62 offen offset:1024 lds
v_mfma_f32_32x32x16_bf16 v[200:215], a[72:75], v[108:111], v[200:215]
s_waitcnt vmcnt(7)
v_mfma_f32_32x32x16_bf16 v[216:231], a[84:87], v[112:115], v[216:231]
v_bitop3_b32 v249, v104, v108, v112 bitop3:0x7f
buffer_load_dwordx4 v21, s[24:27], s62 offen offset:2048 lds
v_mfma_f32_32x32x16_bf16 v[200:215], a[80:83], v[112:115], v[200:215]
s_waitcnt vmcnt(7)
v_mfma_f32_32x32x16_bf16 v[216:231], a[92:95], v[116:119], v[216:231]
buffer_load_dwordx4 v22, s[24:27], s62 offen offset:3072 lds
v_mfma_f32_32x32x16_bf16 v[200:215], a[88:91], v[116:119], v[200:215]
s_waitcnt vmcnt(7)
v_mfma_f32_32x32x16_bf16 v[216:231], a[100:103], v[120:123], v[216:231]
v_bitop3_b32 v249, v249, v116, v120 bitop3:0xf7
s_add_u32 m0, s56, 4096
s_add_u32 s62, s59, 114944
buffer_load_dwordx4 v19, s[24:27], s62 offen offset:0 lds
v_mfma_f32_32x32x16_bf16 v[200:215], a[96:99], v[120:123], v[200:215]
s_waitcnt vmcnt(7)
v_mfma_f32_32x32x16_bf16 v[216:231], a[108:111], v[124:127], v[216:231]
buffer_load_dwordx4 v20, s[24:27], s62 offen offset:1024 lds
v_mfma_f32_32x32x16_bf16 v[200:215], a[104:107], v[124:127], v[200:215]
s_waitcnt vmcnt(7)
v_mfma_f32_32x32x16_bf16 v[216:231], a[116:119], v[128:131], v[216:231]
v_bitop3_b32 v249, v249, v124, v128 bitop3:0xf7
buffer_load_dwordx4 v21, s[24:27], s62 offen offset:2048 lds
v_mfma_f32_32x32x16_bf16 v[200:215], a[112:115], v[128:131], v[200:215]
s_waitcnt vmcnt(7)
v_mfma_f32_32x32x16_bf16 v[216:231], a[124:127], v[132:135], v[216:231]
v_bitop3_b32 v249, v249, v132, v132 bitop3:0xf7
v_bitop3_b32 v249, v249, v250, 1 bitop3:0x20
v_or_b32 v248, v248, v249
v_cmp_ne_u32 vcc, 0, v248
buffer_load_dwordx4 v22, s[24:27], s62 offen offset:3072 lds
v_mfma_f32_32x32x16_bf16 v[200:215], a[120:123], v[132:135], v[200:215]
s_cbranch_vccnz L_rt39
L_rb40:
s_nop 4
ds_write_b128 v23, v[216:219] offset:0
ds_write_b128 v23, v[220:223] offset:1024
ds_write_b128 v23, v[224:227] offset:2048
ds_write_b128 v23, v[228:231] offset:3072
s_add_u32 m0, s56, 8192
s_add_u32 s62, s59, 229632
buffer_load_dwordx4 v19, s[24:27], s62 offen offset:0 lds
buffer_load_dwordx4 v20, s[24:27], s62 offen offset:1024 lds
buffer_load_dwordx4 v21, s[24:27], s62 offen offset:2048 lds
buffer_load_dwordx4 v22, s[24:27], s62 offen offset:3072 lds
s_waitcnt lgkmcnt(0)
s_barrier
s_add_u32 m0, s56, 12288
s_add_u32 s62, s59, 344320
buffer_load_dwordx4 v19, s[24:27], s62 offen offset:0 lds
buffer_load_dwordx4 v20, s[24:27], s62 offen offset:1024 lds
ds_read_b128 v[168:171], v24 offset:0
ds_read_b128 v[172:175], v24 offset:1024
ds_read_b128 v[176:179], v24 offset:2048
ds_read_b128 v[180:183], v24 offset:3072
v_pk_add_f32 v[56:57], v[56:57], v[200:201]
v_pk_add_f32 v[58:59], v[58:59], v[202:203]
v_pk_add_f32 v[60:61], v[60:61], v[204:205]
buffer_load_dwordx4 v21, s[24:27], s62 offen offset:2048 lds
v_pk_add_f32 v[62:63], v[62:63], v[206:207]
v_pk_add_f32 v[64:65], v[64:65], v[208:209]
v_pk_add_f32 v[66:67], v[66:67], v[210:211]
buffer_load_dwordx4 v22, s[24:27], s62 offen offset:3072 lds
v_pk_add_f32 v[68:69], v[68:69], v[212:213]
v_pk_add_f32 v[70:71], v[70:71], v[214:215]
s_add_u32 s63, s3, 80
v_mov_b32 v37, s63
s_cmp_eq_u32 s54, 0
s_cbranch_scc1 L_sc43
buffer_store_dword v37, v27, s[32:35], s67 offen
L_sj44:
s_waitcnt lgkmcnt(3)
v_pk_add_f32 v[56:57], v[56:57], v[168:169]
v_pk_add_f32 v[58:59], v[58:59], v[170:171]
s_waitcnt lgkmcnt(2)
v_pk_add_f32 v[60:61], v[60:61], v[172:173]
v_pk_add_f32 v[62:63], v[62:63], v[174:175]
s_waitcnt lgkmcnt(1)
v_pk_add_f32 v[64:65], v[64:65], v[176:177]
v_pk_add_f32 v[66:67], v[66:67], v[178:179]
s_waitcnt lgkmcnt(0)
v_pk_add_f32 v[68:69], v[68:69], v[180:181]
v_pk_add_f32 v[70:71], v[70:71], v[182:183]
v_cvt_pk_bf16_f32 v248, v56, v57
v_cvt_pk_bf16_f32 v249, v58, v59
v_cvt_pk_bf16_f32 v250, v60, v61
v_cvt_pk_bf16_f32 v251, v62, v63
v_cvt_pk_bf16_f32 v252, v64, v65
v_cvt_pk_bf16_f32 v253, v66, v67
v_cvt_pk_bf16_f32 v254, v68, v69
v_cvt_pk_bf16_f32 v255, v70, v71
v_or_b32 v248, 1, v248
v_or_b32 v252, 1, v252
s_add_u32 s66, s50, s55
s_add_u32 s66, s66, 4194304
s_cmp_eq_u32 s54, 0
s_cbranch_scc1 L_sc45
buffer_store_dwordx4 v[248:251], v1, s[32:35], s66 offen offset:0
buffer_store_dwordx4 v[252:255], v1, s[32:35], s66 offen offset:1024
L_sj46:
v_pk_add_f32 v[232:233], v[56:57], v[58:59]
v_pk_mul_f32 v[234:235], v[56:57], v[56:57]
v_pk_fma_f32 v[234:235], v[58:59], v[58:59], v[234:235]
v_pk_add_f32 v[232:233], v[232:233], v[60:61]
v_pk_fma_f32 v[234:235], v[60:61], v[60:61], v[234:235]
v_pk_add_f32 v[232:233], v[232:233], v[62:63]
v_pk_fma_f32 v[234:235], v[62:63], v[62:63], v[234:235]
v_pk_add_f32 v[232:233], v[232:233], v[64:65]
v_pk_fma_f32 v[234:235], v[64:65], v[64:65], v[234:235]
v_pk_add_f32 v[232:233], v[232:233], v[66:67]
v_pk_fma_f32 v[234:235], v[66:67], v[66:67], v[234:235]
v_pk_add_f32 v[232:233], v[232:233], v[68:69]
v_pk_fma_f32 v[234:235], v[68:69], v[68:69], v[234:235]
v_pk_add_f32 v[232:233], v[232:233], v[70:71]
v_pk_fma_f32 v[234:235], v[70:71], v[70:71], v[234:235]
v_add_f32 v232, v232, v233
v_add_f32 v234, v234, v235
s_add_u32 s65, s50, s68
s_add_u32 s65, s65, 14680064
v_permlane32_swap_b32 v232, v234
v_add_f32 v232, v232, v234
v_bitop3_b32 v232, v232, 1, s7 bitop3:0x74
s_cmp_eq_u32 s54, 0
s_cbranch_scc1 L_sc47
buffer_store_dword v232, v1, s[32:35], s65 offen
L_sj48:
v_pk_add_f32 v[40:41], v[40:41], v[56:57]
v_pk_add_f32 v[42:43], v[42:43], v[58:59]
v_pk_add_f32 v[44:45], v[44:45], v[60:61]
v_pk_add_f32 v[46:47], v[46:47], v[62:63]
v_pk_add_f32 v[48:49], v[48:49], v[64:65]
v_pk_add_f32 v[50:51], v[50:51], v[66:67]
v_pk_add_f32 v[52:53], v[52:53], v[68:69]
v_pk_add_f32 v[54:55], v[54:55], v[70:71]
v_lshrrev_b32 v56, 2, v0
v_mul_u32_u24 v56, 3584, v56
v_and_b32 v57, 48, v1
v_add_u32 v56, v56, v57
v_add_u32 v57, 56320, v56
v_add_u32 v58, 112640, v56
v_add_u32 v59, 168960, v56
s_cmp_eq_u32 s7, 0
s_cbranch_scc0 L_cj50
v_lshrrev_b32 v68, 2, v0
v_lshrrev_b32 v69, 4, v0
v_xor_b32 v68, v68, v69
v_and_b32 v68, 1, v68
v_add_u32 v68, -1, v68
v_and_b32 v68, 0x3f803f80, v68
v_mov_b32 v69, v68
v_mov_b32 v70, v68
v_mov_b32 v71, v68
s_cmp_eq_u32 s48, 0
s_cbranch_scc0 L_cb49
v_mfma_f32_16x16x32_bf16 v[64:67], v[68:71], a[128:131], 0
v_mfma_f32_16x16x32_bf16 v[64:67], v[68:71], a[136:139], v[64:67]
v_mfma_f32_16x16x32_bf16 v[64:67], v[68:71], a[144:147], v[64:67]
v_mfma_f32_16x16x32_bf16 v[64:67], v[68:71], a[152:155], v[64:67]
v_mfma_f32_16x16x32_bf16 v[64:67], v[68:71], a[160:163], v[64:67]
v_mfma_f32_16x16x32_bf16 v[64:67], v[68:71], a[168:171], v[64:67]
v_mfma_f32_16x16x32_bf16 v[64:67], v[68:71], a[176:179], v[64:67]
v_mfma_f32_16x16x32_bf16 v[64:67], v[68:71], a[184:187], v[64:67]
v_mfma_f32_16x16x32_bf16 v[64:67], v[68:71], a[192:195], v[64:67]
v_mfma_f32_16x16x32_bf16 v[64:67], v[68:71], a[200:203], v[64:67]
v_mfma_f32_16x16x32_bf16 v[64:67], v[68:71], a[208:211], v[64:67]
v_mfma_f32_16x16x32_bf16 v[64:67], v[68:71], a[216:219], v[64:67]
v_mfma_f32_16x16x32_bf16 v[64:67], v[68:71], a[224:227], v[64:67]
v_mfma_f32_16x16x32_bf16 v[64:67], v[68:71], a[232:235], v[64:67]
v_mfma_f32_16x16x32_bf16 v[64:67], v[68:71], a[240:243], v[64:67]
v_mfma_f32_16x16x32_bf16 v[64:67], v[68:71], a[248:251], v[64:67]
s_branch L_cj50
L_cb49:
v_mfma_f32_16x16x32_bf16 v[64:67], v[68:71], a[132:135], 0
v_mfma_f32_16x16x32_bf16 v[64:67], v[68:71], a[140:143], v[64:67]
v_mfma_f32_16x16x32_bf16 v[64:67], v[68:71], a[148:151], v[64:67]
v_mfma_f32_16x16x32_bf16 v[64:67], v[68:71], a[156:159], v[64:67]
v_mfma_f32_16x16x32_bf16 v[64:67], v[68:71], a[164:167], v[64:67]
v_mfma_f32_16x16x32_bf16 v[64:67], v[68:71], a[172:175], v[64:67]
v_mfma_f32_16x16x32_bf16 v[64:67], v[68:71], a[180:183], v[64:67]
v_mfma_f32_16x16x32_bf16 v[64:67], v[68:71], a[188:191], v[64:67]
v_mfma_f32_16x16x32_bf16 v[64:67], v[68:71], a[196:199], v[64:67]
v_mfma_f32_16x16x32_bf16 v[64:67], v[68:71], a[204:207], v[64:67]
v_mfma_f32_16x16x32_bf16 v[64:67], v[68:71], a[212:215], v[64:67]
v_mfma_f32_16x16x32_bf16 v[64:67], v[68:71], a[220:223], v[64:67]
v_mfma_f32_16x16x32_bf16 v[64:67], v[68:71], a[228:231], v[64:67]
v_mfma_f32_16x16x32_bf16 v[64:67], v[68:71], a[236:239], v[64:67]
v_mfma_f32_16x16x32_bf16 v[64:67], v[68:71], a[244:247], v[64:67]
v_mfma_f32_16x16x32_bf16 v[64:67], v[68:71], a[252:255], v[64:67]
L_cj50:
s_mul_i32 s63, s97, 12
s_load_dwordx2 s[0:1], s[8:9], s63 offset:1468
s_load_dwordx2 s[0:1], s[8:9], s63 offset:4540
s_load_dwordx2 s[0:1], s[8:9], s63 offset:7612
s_load_dwordx2 s[0:1], s[8:9], s63 offset:10684
s_mul_i32 s63, s97, 12
s_load_dwordx2 s[0:1], s[8:9], s63 offset:2492
s_load_dwordx2 s[0:1], s[8:9], s63 offset:5564
s_load_dwordx2 s[0:1], s[8:9], s63 offset:8636
s_add_u32 s63, s52, 80
L_pl51:
buffer_load_dword v37, v28, s[32:35], s51 offen sc1
s_waitcnt vmcnt(0)
v_cmp_gt_u32 vcc, s63, v37
s_cbranch_vccz L_pd52
s_sub_u32 s53, s53, 1
s_cbranch_scc0 L_pl51
s_endpgm
L_pd52:
s_add_u32 s64, s50, 4194304
buffer_load_dwordx4 v[72:75], v2, s[32:35], s64 offen offset:0 sc1
ds_read_b64_tr_b16 a[4:5], v9 offset:0
ds_read_b64_tr_b16 a[6:7], v9 offset:1024
ds_read_b64_tr_b16 a[0:1], v8 offset:0
ds_read_b64_tr_b16 a[2:3], v8 offset:1024
ds_read_b64_tr_b16 a[12:13], v9 offset:2048
buffer_load_dwordx4 v[76:79], v2, s[32:35], s64 offen offset:1024 sc1
ds_read_b64_tr_b16 a[14:15], v9 offset:3072
ds_read_b64_tr_b16 a[8:9], v8 offset:2048
ds_read_b64_tr_b16 a[10:11], v8 offset:3072
ds_read_b64_tr_b16 a[20:21], v9 offset:4096
ds_read_b64_tr_b16 a[22:23], v9 offset:5120
buffer_load_dwordx4 v[80:83], v2, s[32:35], s64 offen offset:2048 sc1
ds_read_b64_tr_b16 a[16:17], v8 offset:4096
ds_read_b64_tr_b16 a[18:19], v8 offset:5120
ds_read_b64_tr_b16 a[28:29], v9 offset:6144
ds_read_b64_tr_b16 a[30:31], v9 offset:7168
ds_read_b64_tr_b16 a[24:25], v8 offset:6144
buffer_load_dwordx4 v[84:87], v2, s[32:35], s64 offen offset:3072 sc1
ds_read_b64_tr_b16 a[26:27], v8 offset:7168
ds_read_b64_tr_b16 a[36:37], v9 offset:8192
ds_read_b64_tr_b16 a[38:39], v9 offset:9216
ds_read_b64_tr_b16 a[32:33], v8 offset:8192
ds_read_b64_tr_b16 a[34:35], v8 offset:9216
buffer_load_dwordx4 v[88:91], v3, s[32:35], s64 offen offset:0 sc1
ds_read_b64_tr_b16 a[44:45], v9 offset:10240
ds_read_b64_tr_b16 a[46:47], v9 offset:11264
ds_read_b64_tr_b16 a[40:41], v8 offset:10240
ds_read_b64_tr_b16 a[42:43], v8 offset:11264
ds_read_b64_tr_b16 a[52:53], v9 offset:12288
buffer_load_dwordx4 v[92:95], v3, s[32:35], s64 offen offset:1024 sc1
ds_read_b64_tr_b16 a[54:55], v9 offset:13312
ds_read_b64_tr_b16 a[48:49], v8 offset:12288
ds_read_b64_tr_b16 a[50:51], v8 offset:13312
ds_read_b64_tr_b16 a[60:61], v9 offset:14336
ds_read_b64_tr_b16 a[62:63], v9 offset:15360
buffer_load_dwordx4 v[96:99], v3, s[32:35], s64 offen offset:2048 sc1
ds_read_b64_tr_b16 a[56:57], v8 offset:14336
ds_read_b64_tr_b16 a[58:59], v8 offset:15360
ds_read_b64_tr_b16 a[68:69], v9 offset:16384
ds_read_b64_tr_b16 a[70:71], v9 offset:17408
ds_read_b64_tr_b16 a[64:65], v8 offset:16384
buffer_load_dwordx4 v[100:103], v3, s[32:35], s64 offen offset:3072 sc1
ds_read_b64_tr_b16 a[66:67], v8 offset:17408
ds_read_b64_tr_b16 a[76:77], v9 offset:18432
ds_read_b64_tr_b16 a[78:79], v9 offset:19456
ds_read_b64_tr_b16 a[72:73], v8 offset:18432
ds_read_b64_tr_b16 a[74:75], v8 offset:19456
s_waitcnt vmcnt(7)
v_mfma_f32_32x32x16_bf16 v[216:231], a[132:135], v[72:75], 0
ds_read_b64_tr_b16 a[84:85], v9 offset:20480
ds_read_b64_tr_b16 a[86:87], v9 offset:21504
v_lshlrev_b32 v60, 2, v0
v_mfma_f32_32x32x16_bf16 v[200:215], a[128:131], v[72:75], 0
ds_read_b64_tr_b16 a[80:81], v8 offset:20480
ds_read_b64_tr_b16 a[82:83], v8 offset:21504
buffer_load_dwordx4 v[104:107], v4, s[32:35], s64 offen offset:0 sc1
v_add_u32 v60, 151040, v60
s_waitcnt vmcnt(7)
v_mfma_f32_32x32x16_bf16 v[216:231], a[140:143], v[76:79], v[216:231]
ds_read_b64_tr_b16 a[92:93], v9 offset:22528
ds_read_b64_tr_b16 a[94:95], v9 offset:23552
v_mov_b32 v61, v60
v_mfma_f32_32x32x16_bf16 v[200:215], a[136:139], v[76:79], v[200:215]
ds_read_b64_tr_b16 a[88:89], v8 offset:22528
ds_read_b64_tr_b16 a[90:91], v8 offset:23552
buffer_load_dwordx4 v[108:111], v4, s[32:35], s64 offen offset:1024 sc1
v_mov_b32 v62, v60
s_waitcnt vmcnt(7)
v_mfma_f32_32x32x16_bf16 v[216:231], a[148:151], v[80:83], v[216:231]
v_bitop3_b32 v248, v72, v76, v80 bitop3:0x7f
ds_read_b64_tr_b16 a[100:101], v9 offset:24576
ds_read_b64_tr_b16 a[102:103], v9 offset:25600
v_xor_b32 v63, 64, v60
v_mfma_f32_32x32x16_bf16 v[200:215], a[144:147], v[80:83], v[200:215]
ds_read_b64_tr_b16 a[96:97], v8 offset:24576
ds_read_b64_tr_b16 a[98:99], v8 offset:25600
buffer_load_dwordx4 v[112:115], v4, s[32:35], s64 offen offset:2048 sc1
s_or_b32 exec_hi, s7, s49
s_cselect_b32 exec_lo, 0, -1
s_mov_b32 exec_hi, 0
v_mov_b32 v60, v26
v_subrev_u32 v62, 3584, v62
s_mov_b64 exec, -1
s_waitcnt vmcnt(7)
v_mfma_f32_32x32x16_bf16 v[216:231], a[156:159], v[84:87], v[216:231]
ds_read_b64_tr_b16 a[108:109], v9 offset:26624
ds_read_b64_tr_b16 a[110:111], v9 offset:27648
s_cmp_gt_u32 s49, s7
s_cselect_b32 exec_lo, -1, 0
s_mov_b32 exec_hi, 0
v_mov_b32 v61, v26
v_subrev_u32 v63, 3584, v63
s_mov_b64 exec, -1
v_mfma_f32_32x32x16_bf16 v[200:215], a[152:155], v[84:87], v[200:215]
ds_read_b64_tr_b16 a[104:105], v8 offset:26624
ds_read_b64_tr_b16 a[106:107], v8 offset:27648
buffer_load_dwordx4 v[116:119], v4, s[32:35], s64 offen offset:3072 sc1
s_waitcnt vmcnt(7)
v_mfma_f32_32x32x16_bf16 v[216:231], a[164:167], v[88:91], v[216:231]
v_bitop3_b32 v248, v248, v84, v88 bitop3:0xf7
ds_read_b64_tr_b16 a[116:117], v9 offset:28672
ds_read_b64_tr_b16 a[118:119], v9 offset:29696
ds_write_b32 v60, v64 offset:3072
v_mfma_f32_32x32x16_bf16 v[200:215], a[160:163], v[88:91], v[200:215]
ds_read_b64_tr_b16 a[112:113], v8 offset:28672
ds_read_b64_tr_b16 a[114:115], v8 offset:29696
buffer_load_dwordx4 v[120:123], v5, s[32:35], s64 offen offset:0 sc1
s_waitcnt vmcnt(7)
v_mfma_f32_32x32x16_bf16 v[216:231], a[172:175], v[92:95], v[216:231]
ds_read_b64_tr_b16 a[124:125], v9 offset:30720
ds_read_b64_tr_b16 a[126:127], v9 offset:31744
v_mfma_f32_32x32x16_bf16 v[200:215], a[168:171], v[92:95], v[200:215]
ds_read_b64_tr_b16 a[120:121], v8 offset:30720
ds_read_b64_tr_b16 a[122:123], v8 offset:31744
buffer_load_dwordx4 v[124:127], v5, s[32:35], s64 offen offset:1024 sc1
s_waitcnt vmcnt(7)
v_mfma_f32_32x32x16_bf16 v[216:231], a[180:183], v[96:99], v[216:231]
v_bitop3_b32 v248, v248, v92, v96 bitop3:0xf7
v_mfma_f32_32x32x16_bf16 v[200:215], a[176:179], v[96:99], v[200:215]
buffer_load_dwordx4 v[128:131], v5, s[32:35], s64 offen offset:2048 sc1
s_waitcnt vmcnt(7)
v_mfma_f32_32x32x16_bf16 v[216:231], a[188:191], v[100:103], v[216:231]
s_waitcnt lgkmcnt(0)
s_barrier
v_mfma_f32_32x32x16_bf16 v[200:215], a[184:187], v[100:103], v[200:215]
ds_read_b32 v65, v61 offset:3072
buffer_load_dwordx4 v[132:135], v5, s[32:35], s64 offen offset:3072 sc1
s_waitcnt vmcnt(7)
v_mfma_f32_32x32x16_bf16 v[216:231], a[196:199], v[104:107], v[216:231]
v_bitop3_b32 v248, v248, v100, v104 bitop3:0xf7
v_mfma_f32_32x32x16_bf16 v[200:215], a[192:195], v[104:107], v[200:215]
s_lshl_b32 s65, s48, 12
s_add_u32 s65, s65, s50
s_add_u32 s65, s65, 14680064
buffer_load_dwordx4 v[232:235], v1, s[32:35], s65 offen offset:0 sc1
s_waitcnt vmcnt(7)
v_mfma_f32_32x32x16_bf16 v[216:231], a[204:207], v[108:111], v[216:231]
v_mfma_f32_32x32x16_bf16 v[200:215], a[200:203], v[108:111], v[200:215]
buffer_load_dwordx4 v[236:239], v1, s[32:35], s65 offen offset:1024 sc1
s_waitcnt lgkmcnt(0)
v_add_f32 v64, v64, v65
ds_write_b32 v61, v64 offset:1024
s_waitcnt vmcnt(7)
v_mfma_f32_32x32x16_bf16 v[216:231], a[212:215], v[112:115], v[216:231]
v_bitop3_b32 v248, v248, v108, v112 bitop3:0xf7
v_mfma_f32_32x32x16_bf16 v[200:215], a[208:211], v[112:115], v[200:215]
buffer_load_dwordx4 v[240:243], v1, s[32:35], s65 offen offset:2048 sc1
s_waitcnt vmcnt(7)
v_mfma_f32_32x32x16_bf16 v[216:231], a[220:223], v[116:119], v[216:231]
v_mfma_f32_32x32x16_bf16 v[200:215], a[216:219], v[116:119], v[200:215]
buffer_load_dwordx4 v[244:247], v1, s[32:35], s65 offen offset:3072 sc1
s_waitcnt vmcnt(7)
v_mfma_f32_32x32x16_bf16 v[216:231], a[228:231], v[120:123], v[216:231]
v_bitop3_b32 v248, v248, v116, v120 bitop3:0xf7
v_mfma_f32_32x32x16_bf16 v[200:215], a[224:227], v[120:123], v[200:215]
s_add_u32 m0, s74, 81920
s_add_u32 s62, s73, 0
buffer_load_dwordx4 v56, s[24:27], s62 offen offset:0 lds
s_waitcnt vmcnt(7)
v_mfma_f32_32x32x16_bf16 v[216:231], a[236:239], v[124:127], v[216:231]
v_mfma_f32_32x32x16_bf16 v[200:215], a[232:235], v[124:127], v[200:215]
buffer_load_dwordx4 v57, s[24:27], s62 offen offset:1024 lds
s_waitcnt vmcnt(7)
v_mfma_f32_32x32x16_bf16 v[216:231], a[244:247], v[128:131], v[216:231]
v_bitop3_b32 v248, v248, v124, v128 bitop3:0xf7
v_mfma_f32_32x32x16_bf16 v[200:215], a[240:243], v[128:131], v[200:215]
buffer_load_dwordx4 v58, s[24:27], s62 offen offset:2048 lds
s_waitcnt vmcnt(7)
v_mfma_f32_32x32x16_bf16 v[216:231], a[252:255], v[132:135], v[216:231]
v_bitop3_b32 v248, v248, v132, v132 bitop3:0xf7
v_and_b32 v248, 1, v248
v_cmp_ne_u32 vcc, 0, v248
v_mfma_f32_32x32x16_bf16 v[200:215], a[248:251], v[132:135], v[200:215]
s_cbranch_vccnz L_rt53
L_rb54:
s_nop 6
ds_write_b128 v23, v[216:219] offset:0
ds_write_b128 v23, v[220:223] offset:1024
ds_write_b128 v23, v[224:227] offset:2048
ds_write_b128 v23, v[228:231] offset:3072
buffer_load_dwordx4 v59, s[24:27], s62 offen offset:3072 lds
s_waitcnt vmcnt(7)
v_bitop3_b32 v248, v232, v233, s7 bitop3:0xbd
v_bitop3_b32 v248, v248, v234, s7 bitop3:0xf9
v_bitop3_b32 v248, v248, v235, s7 bitop3:0xf9
s_waitcnt vmcnt(6)
v_bitop3_b32 v248, v248, v236, s7 bitop3:0xf9
v_bitop3_b32 v248, v248, v237, s7 bitop3:0xf9
v_bitop3_b32 v248, v248, v238, s7 bitop3:0xf9
v_bitop3_b32 v248, v248, v239, s7 bitop3:0xf9
s_waitcnt vmcnt(5)
v_bitop3_b32 v248, v248, v240, s7 bitop3:0xf9
v_bitop3_b32 v248, v248, v241, s7 bitop3:0xf9
v_bitop3_b32 v248, v248, v242, s7 bitop3:0xf9
v_bitop3_b32 v248, v248, v243, s7 bitop3:0xf9
s_waitcnt vmcnt(4)
v_bitop3_b32 v248, v248, v244, s7 bitop3:0xf9
v_bitop3_b32 v248, v248, v245, s7 bitop3:0xf9
v_bitop3_b32 v248, v248, v246, s7 bitop3:0xf9
v_bitop3_b32 v248, v248, v247, s7 bitop3:0xf9
v_and_b32 v248, 1, v248
v_cmp_ne_u32 vcc, 0, v248
s_cbranch_vccnz L_rt55
L_rb56:
v_add_f32 v232, v232, v240
v_add_f32 v233, v233, v241
v_add_f32 v234, v234, v242
v_add_f32 v235, v235, v243
v_add_f32 v236, v236, v244
v_add_f32 v237, v237, v245
v_add_f32 v238, v238, v246
v_add_f32 v239, v239, v247
v_add_f32 v232, v232, v236
v_add_f32 v233, v233, v237
v_add_f32 v234, v234, v238
v_add_f32 v235, v235, v239
v_add_f32 v232, v232, v234
v_add_f32 v233, v233, v235
v_add_f32 v232, v232, v233
v_mul_f32 v232, 0x3b000000, v232
v_mov_b32 v233, v232
s_nop 1
v_permlane32_swap_b32 v232, v233
v_mul_f32 v34, -1.0, v232
v_fmac_f32 v233, v34, v232
v_max_f32 v233, 0, v233
v_add_f32 v232, 0x3727c5ac, v233
v_rsq_f32 v35, v232
s_nop 0
v_mul_f32 v244, v35, v35
v_mul_f32 v242, 0xc0135761, v35
v_rcp_f32 v246, v35
v_mul_f32 v244, 0x3d372713, v244
v_mul_f32 v244, v244, v242
s_add_u32 m0, s74, 86016
s_add_u32 s62, s73, 229376
buffer_load_dwordx4 v56, s[24:27], s62 offen offset:0 lds
s_cmp_eq_u32 s7, 0
s_cbranch_scc0 L_cj58
s_cmp_eq_u32 s48, 0
s_cbranch_scc0 L_cb57
v_mfma_f32_16x16x32_bf16 v[64:67], v[68:71], a[0:3], 0
v_mfma_f32_16x16x32_bf16 v[64:67], v[68:71], a[8:11], v[64:67]
v_mfma_f32_16x16x32_bf16 v[64:67], v[68:71], a[16:19], v[64:67]
v_mfma_f32_16x16x32_bf16 v[64:67], v[68:71], a[24:27], v[64:67]
v_mfma_f32_16x16x32_bf16 v[64:67], v[68:71], a[32:35], v[64:67]
v_mfma_f32_16x16x32_bf16 v[64:67], v[68:71], a[40:43], v[64:67]
v_mfma_f32_16x16x32_bf16 v[64:67], v[68:71], a[48:51], v[64:67]
v_mfma_f32_16x16x32_bf16 v[64:67], v[68:71], a[56:59], v[64:67]
v_mfma_f32_16x16x32_bf16 v[64:67], v[68:71], a[64:67], v[64:67]
v_mfma_f32_16x16x32_bf16 v[64:67], v[68:71], a[72:75], v[64:67]
v_mfma_f32_16x16x32_bf16 v[64:67], v[68:71], a[80:83], v[64:67]
v_mfma_f32_16x16x32_bf16 v[64:67], v[68:71], a[88:91], v[64:67]
v_mfma_f32_16x16x32_bf16 v[64:67], v[68:71], a[96:99], v[64:67]
v_mfma_f32_16x16x32_bf16 v[64:67], v[68:71], a[104:107], v[64:67]
v_mfma_f32_16x16x32_bf16 v[64:67], v[68:71], a[112:115], v[64:67]
v_mfma_f32_16x16x32_bf16 v[64:67], v[68:71], a[120:123], v[64:67]
s_branch L_cj58
L_cb57:
v_mfma_f32_16x16x32_bf16 v[64:67], v[68:71], a[4:7], 0
v_mfma_f32_16x16x32_bf16 v[64:67], v[68:71], a[12:15], v[64:67]
v_mfma_f32_16x16x32_bf16 v[64:67], v[68:71], a[20:23], v[64:67]
v_mfma_f32_16x16x32_bf16 v[64:67], v[68:71], a[28:31], v[64:67]
v_mfma_f32_16x16x32_bf16 v[64:67], v[68:71], a[36:39], v[64:67]
v_mfma_f32_16x16x32_bf16 v[64:67], v[68:71], a[44:47], v[64:67]
v_mfma_f32_16x16x32_bf16 v[64:67], v[68:71], a[52:55], v[64:67]
v_mfma_f32_16x16x32_bf16 v[64:67], v[68:71], a[60:63], v[64:67]
v_mfma_f32_16x16x32_bf16 v[64:67], v[68:71], a[68:71], v[64:67]
v_mfma_f32_16x16x32_bf16 v[64:67], v[68:71], a[76:79], v[64:67]
v_mfma_f32_16x16x32_bf16 v[64:67], v[68:71], a[84:87], v[64:67]
v_mfma_f32_16x16x32_bf16 v[64:67], v[68:71], a[92:95], v[64:67]
v_mfma_f32_16x16x32_bf16 v[64:67], v[68:71], a[100:103], v[64:67]
v_mfma_f32_16x16x32_bf16 v[64:67], v[68:71], a[108:111], v[64:67]
v_mfma_f32_16x16x32_bf16 v[64:67], v[68:71], a[116:119], v[64:67]
v_mfma_f32_16x16x32_bf16 v[64:67], v[68:71], a[124:127], v[64:67]
L_cj58:
s_waitcnt lgkmcnt(0)
s_barrier
v_mfma_f32_32x32x16_bf16 v[152:167], a[4:7], v[72:75], 0
ds_read_b128 v[184:187], v25 offset:1024
ds_read_b128 v[188:191], v25 offset:1056
ds_read_b128 v[192:195], v25 offset:1088
ds_read_b128 v[196:199], v25 offset:1120
ds_read_b128 v[168:171], v24 offset:0
ds_read_b128 v[172:175], v24 offset:1024
ds_read_b64_tr_b16 a[132:133], v7 offset:0
ds_read_b64_tr_b16 a[134:135], v7 offset:1024
ds_read_b64_tr_b16 a[128:129], v6 offset:0
ds_read_b64_tr_b16 a[130:131], v6 offset:1024
buffer_load_dwordx4 v57, s[24:27], s62 offen offset:1024 lds
v_mfma_f32_32x32x16_bf16 v[136:151], a[0:3], v[72:75], 0
ds_read_b128 v[176:179], v24 offset:2048
ds_read_b128 v[180:183], v24 offset:3072
ds_read_b64_tr_b16 a[140:141], v7 offset:2048
ds_read_b64_tr_b16 a[142:143], v7 offset:3072
ds_read_b64_tr_b16 a[136:137], v6 offset:2048
ds_write_b32 v60, v64 offset:3072
buffer_load_dwordx4 v58, s[24:27], s62 offen offset:2048 lds
s_waitcnt lgkmcnt(15)
v_fmac_f32 v200, v184, v34
v_fmac_f32 v201, v185, v34
v_fmac_f32 v202, v186, v34
v_mfma_f32_32x32x16_bf16 v[152:167], a[12:15], v[76:79], v[152:167]
ds_read_b64_tr_b16 a[138:139], v6 offset:3072
ds_read_b64_tr_b16 a[148:149], v7 offset:4096
ds_read_b64_tr_b16 a[150:151], v7 offset:5120
v_fmac_f32 v203, v187, v34
s_waitcnt lgkmcnt(15)
v_fmac_f32 v204, v188, v34
v_fmac_f32 v205, v189, v34
v_fmac_f32 v206, v190, v34
v_fmac_f32 v207, v191, v34
v_mfma_f32_32x32x16_bf16 v[136:151], a[8:11], v[76:79], v[136:151]
ds_read_b64_tr_b16 a[144:145], v6 offset:4096
ds_read_b64_tr_b16 a[146:147], v6 offset:5120
ds_read_b64_tr_b16 a[156:157], v7 offset:6144
buffer_load_dwordx4 v59, s[24:27], s62 offen offset:3072 lds
v_fmac_f32 v208, v192, v34
v_fmac_f32 v209, v193, v34
v_fmac_f32 v210, v194, v34
v_fmac_f32 v211, v195, v34
v_fmac_f32 v212, v196, v34
v_mfma_f32_32x32x16_bf16 v[152:167], a[20:23], v[80:83], v[152:167]
ds_read_b64_tr_b16 a[158:159], v7 offset:7168
ds_read_b64_tr_b16 a[152:153], v6 offset:6144
ds_read_b64_tr_b16 a[154:155], v6 offset:7168
v_fmac_f32 v213, v197, v34
v_fmac_f32 v214, v198, v34
v_fmac_f32 v215, v199, v34
s_waitcnt lgkmcnt(15)
v_add_f32 v200, v200, v168
v_add_f32 v201, v201, v169
v_mfma_f32_32x32x16_bf16 v[136:151], a[16:19], v[80:83], v[136:151]
ds_read_b64_tr_b16 a[164:165], v7 offset:8192
ds_read_b64_tr_b16 a[166:167], v7 offset:9216
ds_read_b64_tr_b16 a[160:161], v6 offset:8192
ds_read_b64_tr_b16 a[162:163], v6 offset:9216
s_add_u32 m0, s74, 65536
s_nop 0
buffer_load_dwordx4 v11, s[28:31], s88 offen offset:0 lds
v_add_f32 v202, v202, v170
v_add_f32 v203, v203, v171
v_mul_f32 v184, v200, v200
v_mul_f32 v185, v201, v201
v_mul_f32 v186, v202, v202
v_mfma_f32_32x32x16_bf16 v[152:167], a[28:31], v[84:87], v[152:167]
ds_read_b64_tr_b16 a[172:173], v7 offset:10240
ds_read_b64_tr_b16 a[174:175], v7 offset:11264
ds_read_b64_tr_b16 a[168:169], v6 offset:10240
v_mul_f32 v187, v203, v203
v_fma_f32 v184, v184, v244, v242
v_fma_f32 v185, v185, v244, v242
v_fma_f32 v186, v186, v244, v242
v_fma_f32 v187, v187, v244, v242
v_mul_f32 v184, v184, v200
v_mfma_f32_32x32x16_bf16 v[136:151], a[24:27], v[84:87], v[136:151]
ds_read_b64_tr_b16 a[170:171], v6 offset:11264
ds_read_b64_tr_b16 a[180:181], v7 offset:12288
ds_read_b64_tr_b16 a[182:183], v7 offset:13312
buffer_load_dwordx4 v12, s[28:31], s88 offen offset:1024 lds
v_mul_f32 v185, v185, v201
v_mul_f32 v186, v186, v202
v_mul_f32 v187, v187, v203
v_exp_f32 v184, v184
v_exp_f32 v185, v185
v_mfma_f32_32x32x16_bf16 v[152:167], a[36:39], v[88:91], v[152:167]
ds_read_b64_tr_b16 a[176:177], v6 offset:12288
ds_read_b64_tr_b16 a[178:179], v6 offset:13312
ds_read_b64_tr_b16 a[188:189], v7 offset:14336
v_exp_f32 v186, v186
v_exp_f32 v187, v187
v_fma_f32 v184, v184, v246, v246
v_fma_f32 v185, v185, v246, v246
v_fma_f32 v186, v186, v246, v246
v_mfma_f32_32x32x16_bf16 v[136:151], a[32:35], v[88:91], v[136:151]
ds_read_b64_tr_b16 a[190:191], v7 offset:15360
ds_read_b64_tr_b16 a[184:185], v6 offset:14336
ds_read_b64_tr_b16 a[186:187], v6 offset:15360
buffer_load_dwordx4 v13, s[28:31], s88 offen offset:2048 lds
v_fma_f32 v187, v187, v246, v246
v_rcp_f32 v184, v184
v_rcp_f32 v185, v185
v_rcp_f32 v186, v186
v_rcp_f32 v187, v187
v_mfma_f32_32x32x16_bf16 v[152:167], a[44:47], v[92:95], v[152:167]
ds_read_b64_tr_b16 a[196:197], v7 offset:16384
ds_read_b64_tr_b16 a[198:199], v7 offset:17408
ds_read_b64_tr_b16 a[192:193], v6 offset:16384
ds_read_b64_tr_b16 a[194:195], v6 offset:17408
v_mul_f32 v200, v200, v184
v_mul_f32 v201, v201, v185
v_mul_f32 v202, v202, v186
v_mul_f32 v203, v203, v187
v_add_f32 v204, v204, v172
v_mfma_f32_32x32x16_bf16 v[136:151], a[40:43], v[92:95], v[136:151]
ds_read_b64_tr_b16 a[204:205], v7 offset:18432
ds_read_b64_tr_b16 a[206:207], v7 offset:19456
ds_read_b64_tr_b16 a[200:201], v6 offset:18432
buffer_load_dwordx4 v14, s[28:31], s88 offen offset:3072 lds
v_add_f32 v205, v205, v173
v_add_f32 v206, v206, v174
v_add_f32 v207, v207, v175
v_mul_f32 v188, v204, v204
v_mul_f32 v189, v205, v205
v_mfma_f32_32x32x16_bf16 v[152:167], a[52:55], v[96:99], v[152:167]
ds_read_b64_tr_b16 a[202:203], v6 offset:19456
ds_read_b64_tr_b16 a[212:213], v7 offset:20480
ds_read_b64_tr_b16 a[214:215], v7 offset:21504
v_mul_f32 v190, v206, v206
v_mul_f32 v191, v207, v207
v_fma_f32 v188, v188, v244, v242
v_fma_f32 v189, v189, v244, v242
v_fma_f32 v190, v190, v244, v242
v_fma_f32 v191, v191, v244, v242
v_mfma_f32_32x32x16_bf16 v[136:151], a[48:51], v[96:99], v[136:151]
ds_read_b64_tr_b16 a[208:209], v6 offset:20480
ds_read_b64_tr_b16 a[210:211], v6 offset:21504
ds_read_b64_tr_b16 a[220:221], v7 offset:22528
s_add_u32 m0, s74, 69632
s_nop 0
buffer_load_dwordx4 v11, s[28:31], s89 offen offset:0 lds
v_mul_f32 v188, v188, v204
v_mul_f32 v189, v189, v205
v_mul_f32 v190, v190, v206
v_mul_f32 v191, v191, v207
v_exp_f32 v188, v188
v_mfma_f32_32x32x16_bf16 v[152:167], a[60:63], v[100:103], v[152:167]
ds_read_b64_tr_b16 a[222:223], v7 offset:23552
ds_read_b64_tr_b16 a[216:217], v6 offset:22528
ds_read_b64_tr_b16 a[218:219], v6 offset:23552
v_exp_f32 v189, v189
v_exp_f32 v190, v190
v_exp_f32 v191, v191
v_fma_f32 v188, v188, v246, v246
v_fma_f32 v189, v189, v246, v246
v_mfma_f32_32x32x16_bf16 v[136:151], a[56:59], v[100:103], v[136:151]
ds_read_b64_tr_b16 a[228:229], v7 offset:24576
ds_read_b64_tr_b16 a[230:231], v7 offset:25600
ds_read_b64_tr_b16 a[224:225], v6 offset:24576
ds_read_b64_tr_b16 a[226:227], v6 offset:25600
buffer_load_dwordx4 v12, s[28:31], s89 offen offset:1024 lds
v_fma_f32 v190, v190, v246, v246
v_fma_f32 v191, v191, v246, v246
v_rcp_f32 v188, v188
v_rcp_f32 v189, v189
v_rcp_f32 v190, v190
v_mfma_f32_32x32x16_bf16 v[152:167], a[68:71], v[104:107], v[152:167]
ds_read_b64_tr_b16 a[236:237], v7 offset:26624
ds_read_b64_tr_b16 a[238:239], v7 offset:27648
ds_read_b64_tr_b16 a[232:233], v6 offset:26624
v_rcp_f32 v191, v191
v_mul_f32 v204, v204, v188
v_mul_f32 v205, v205, v189
v_mul_f32 v206, v206, v190
v_mul_f32 v207, v207, v191
v_mfma_f32_32x32x16_bf16 v[136:151], a[64:67], v[104:107], v[136:151]
ds_read_b64_tr_b16 a[234:235], v6 offset:27648
ds_read_b64_tr_b16 a[244:245], v7 offset:28672
ds_read_b64_tr_b16 a[246:247], v7 offset:29696
buffer_load_dwordx4 v13, s[28:31], s89 offen offset:2048 lds
s_waitcnt lgkmcnt(15)
v_add_f32 v208, v208, v176
v_add_f32 v209, v209, v177
v_add_f32 v210, v210, v178
v_add_f32 v211, v211, v179
v_mul_f32 v192, v208, v208
v_mfma_f32_32x32x16_bf16 v[152:167], a[76:79], v[108:111], v[152:167]
ds_read_b64_tr_b16 a[240:241], v6 offset:28672
ds_read_b64_tr_b16 a[242:243], v6 offset:29696
ds_read_b64_tr_b16 a[252:253], v7 offset:30720
v_mul_f32 v193, v209, v209
v_mul_f32 v194, v210, v210
v_mul_f32 v195, v211, v211
v_fma_f32 v192, v192, v244, v242
v_fma_f32 v193, v193, v244, v242
v_mfma_f32_32x32x16_bf16 v[136:151], a[72:75], v[108:111], v[136:151]
ds_read_b64_tr_b16 a[254:255], v7 offset:31744
ds_read_b64_tr_b16 a[248:249], v6 offset:30720
ds_read_b64_tr_b16 a[250:251], v6 offset:31744
buffer_load_dwordx4 v14, s[28:31], s89 offen offset:3072 lds
v_fma_f32 v194, v194, v244, v242
v_fma_f32 v195, v195, v244, v242
v_mul_f32 v192, v192, v208
v_mul_f32 v193, v193, v209
v_mul_f32 v194, v194, v210
v_mul_f32 v195, v195, v211
v_mfma_f32_32x32x16_bf16 v[152:167], a[84:87], v[112:115], v[152:167]
v_exp_f32 v192, v192
v_exp_f32 v193, v193
v_exp_f32 v194, v194
v_exp_f32 v195, v195
v_fma_f32 v192, v192, v246, v246
v_mfma_f32_32x32x16_bf16 v[136:151], a[80:83], v[112:115], v[136:151]
s_waitcnt lgkmcnt(0)
s_barrier
v_fma_f32 v193, v193, v246, v246
v_fma_f32 v194, v194, v246, v246
v_fma_f32 v195, v195, v246, v246
v_rcp_f32 v192, v192
v_rcp_f32 v193, v193
v_mfma_f32_32x32x16_bf16 v[152:167], a[92:95], v[116:119], v[152:167]
ds_read_b32 v65, v61 offset:3072
s_add_u32 m0, s56, 0
s_nop 0
buffer_load_dwordx4 v11, s[28:31], s76 offen offset:0 lds
v_rcp_f32 v194, v194
v_rcp_f32 v195, v195
v_mul_f32 v208, v208, v192
v_mul_f32 v209, v209, v193
v_mul_f32 v210, v210, v194
v_mfma_f32_32x32x16_bf16 v[136:151], a[88:91], v[116:119], v[136:151]
v_mul_f32 v211, v211, v195
v_add_f32 v212, v212, v180
v_add_f32 v213, v213, v181
v_add_f32 v214, v214, v182
v_add_f32 v215, v215, v183
v_mfma_f32_32x32x16_bf16 v[152:167], a[100:103], v[120:123], v[152:167]
buffer_load_dwordx4 v12, s[28:31], s76 offen offset:1024 lds
v_mul_f32 v196, v212, v212
v_mul_f32 v197, v213, v213
v_mul_f32 v198, v214, v214
v_mul_f32 v199, v215, v215
v_fma_f32 v196, v196, v244, v242
v_mfma_f32_32x32x16_bf16 v[136:151], a[96:99], v[120:123], v[136:151]
v_fma_f32 v197, v197, v244, v242
v_fma_f32 v198, v198, v244, v242
v_fma_f32 v199, v199, v244, v242
v_mul_f32 v196, v196, v212
v_mul_f32 v197, v197, v213
v_mul_f32 v198, v198, v214
s_waitcnt lgkmcnt(0)
v_add_f32 v64, v64, v65
ds_write_b32 v61, v64 offset:1280
v_mfma_f32_32x32x16_bf16 v[152:167], a[108:111], v[124:127], v[152:167]
buffer_load_dwordx4 v13, s[28:31], s76 offen offset:2048 lds
v_mul_f32 v199, v199, v215
v_exp_f32 v196, v196
v_exp_f32 v197, v197
v_exp_f32 v198, v198
v_exp_f32 v199, v199
v_mfma_f32_32x32x16_bf16 v[136:151], a[104:107], v[124:127], v[136:151]
v_fma_f32 v196, v196, v246, v246
v_fma_f32 v197, v197, v246, v246
v_fma_f32 v198, v198, v246, v246
v_fma_f32 v199, v199, v246, v246
v_rcp_f32 v196, v196
v_mfma_f32_32x32x16_bf16 v[152:167], a[116:119], v[128:131], v[152:167]
buffer_load_dwordx4 v14, s[28:31], s76 offen offset:3072 lds
v_rcp_f32 v197, v197
v_rcp_f32 v198, v198
v_rcp_f32 v199, v199
v_mul_f32 v212, v212, v196
v_mul_f32 v213, v213, v197
v_mfma_f32_32x32x16_bf16 v[136:151], a[112:115], v[128:131], v[136:151]
v_mul_f32 v214, v214, v198
v_mul_f32 v215, v215, v199
v_cvt_pk_bf16_f32 v248, v200, v201
v_cvt_pk_bf16_f32 v249, v202, v203
v_cvt_pk_bf16_f32 v250, v204, v205
v_mfma_f32_32x32x16_bf16 v[152:167], a[124:127], v[132:135], v[152:167]
s_add_u32 m0, s56, 4096
s_nop 0
buffer_load_dwordx4 v11, s[28:31], s77 offen offset:0 lds
v_cvt_pk_bf16_f32 v251, v206, v207
v_cvt_pk_bf16_f32 v252, v208, v209
v_cvt_pk_bf16_f32 v253, v210, v211
v_cvt_pk_bf16_f32 v254, v212, v213
v_cvt_pk_bf16_f32 v255, v214, v215
v_mfma_f32_32x32x16_bf16 v[136:151], a[120:123], v[132:135], v[136:151]
v_or_b32 v248, 1, v248
v_or_b32 v252, 1, v252
s_add_u32 s66, s50, s55
s_add_u32 s66, s66, 6291456
s_cmp_eq_u32 s54, 0
s_cbranch_scc1 L_sc59
buffer_store_dwordx4 v[248:251], v1, s[32:35], s66 offen offset:0
buffer_store_dwordx4 v[252:255], v1, s[32:35], s66 offen offset:1024
L_sj60:
ds_write_b128 v23, v[152:155] offset:0
ds_write_b128 v23, v[156:159] offset:1024
ds_write_b128 v23, v[160:163] offset:2048
ds_write_b128 v23, v[164:167] offset:3072
s_cmp_eq_u32 s7, 0
s_cbranch_scc0 L_cj62
s_cmp_eq_u32 s48, 0
s_cbranch_scc0 L_cb61
v_mfma_f32_16x16x32_bf16 v[64:67], v[68:71], a[128:131], 0
v_mfma_f32_16x16x32_bf16 v[64:67], v[68:71], a[136:139], v[64:67]
v_mfma_f32_16x16x32_bf16 v[64:67], v[68:71], a[144:147], v[64:67]
v_mfma_f32_16x16x32_bf16 v[64:67], v[68:71], a[152:155], v[64:67]
v_mfma_f32_16x16x32_bf16 v[64:67], v[68:71], a[160:163], v[64:67]
v_mfma_f32_16x16x32_bf16 v[64:67], v[68:71], a[168:171], v[64:67]
v_mfma_f32_16x16x32_bf16 v[64:67], v[68:71], a[176:179], v[64:67]
v_mfma_f32_16x16x32_bf16 v[64:67], v[68:71], a[184:187], v[64:67]
v_mfma_f32_16x16x32_bf16 v[64:67], v[68:71], a[192:195], v[64:67]
v_mfma_f32_16x16x32_bf16 v[64:67], v[68:71], a[200:203], v[64:67]
v_mfma_f32_16x16x32_bf16 v[64:67], v[68:71], a[208:211], v[64:67]
v_mfma_f32_16x16x32_bf16 v[64:67], v[68:71], a[216:219], v[64:67]
v_mfma_f32_16x16x32_bf16 v[64:67], v[68:71], a[224:227], v[64:67]
v_mfma_f32_16x16x32_bf16 v[64:67], v[68:71], a[232:235], v[64:67]
v_mfma_f32_16x16x32_bf16 v[64:67], v[68:71], a[240:243], v[64:67]
v_mfma_f32_16x16x32_bf16 v[64:67], v[68:71], a[248:251], v[64:67]
s_branch L_cj62
L_cb61:
v_mfma_f32_16x16x32_bf16 v[64:67], v[68:71], a[132:135], 0
v_mfma_f32_16x16x32_bf16 v[64:67], v[68:71], a[140:143], v[64:67]
v_mfma_f32_16x16x32_bf16 v[64:67], v[68:71], a[148:151], v[64:67]
v_mfma_f32_16x16x32_bf16 v[64:67], v[68:71], a[156:159], v[64:67]
v_mfma_f32_16x16x32_bf16 v[64:67], v[68:71], a[164:167], v[64:67]
v_mfma_f32_16x16x32_bf16 v[64:67], v[68:71], a[172:175], v[64:67]
v_mfma_f32_16x16x32_bf16 v[64:67], v[68:71], a[180:183], v[64:67]
v_mfma_f32_16x16x32_bf16 v[64:67], v[68:71], a[188:191], v[64:67]
v_mfma_f32_16x16x32_bf16 v[64:67], v[68:71], a[196:199], v[64:67]
v_mfma_f32_16x16x32_bf16 v[64:67], v[68:71], a[204:207], v[64:67]
v_mfma_f32_16x16x32_bf16 v[64:67], v[68:71], a[212:215], v[64:67]
v_mfma_f32_16x16x32_bf16 v[64:67], v[68:71], a[220:223], v[64:67]
v_mfma_f32_16x16x32_bf16 v[64:67], v[68:71], a[228:231], v[64:67]
v_mfma_f32_16x16x32_bf16 v[64:67], v[68:71], a[236:239], v[64:67]
v_mfma_f32_16x16x32_bf16 v[64:67], v[68:71], a[244:247], v[64:67]
v_mfma_f32_16x16x32_bf16 v[64:67], v[68:71], a[252:255], v[64:67]
L_cj62:
s_waitcnt vmcnt(7)
s_waitcnt lgkmcnt(0)
s_barrier
v_mfma_f32_32x32x16_bf16 v[216:231], a[132:135], v[72:75], 0
ds_read_b128 v[184:187], v25 offset:1280
ds_read_b128 v[188:191], v25 offset:1312
ds_read_b128 v[192:195], v25 offset:1344
ds_read_b128 v[196:199], v25 offset:1376
ds_read_b128 v[168:171], v24 offset:0
ds_read_b128 v[172:175], v24 offset:1024
ds_read_b64_tr_b16 a[0:1], v10 offset:0
ds_read_b64_tr_b16 a[2:3], v10 offset:512
ds_read_b64_tr_b16 a[4:5], v10 offset:1024
ds_read_b64_tr_b16 a[6:7], v10 offset:1536
buffer_load_dwordx4 v12, s[28:31], s77 offen offset:1024 lds
v_mfma_f32_32x32x16_bf16 v[200:215], a[128:131], v[72:75], 0
ds_read_b128 v[176:179], v24 offset:2048
ds_read_b128 v[180:183], v24 offset:3072
ds_read_b64_tr_b16 a[8:9], v10 offset:2048
ds_read_b64_tr_b16 a[10:11], v10 offset:2560
ds_read_b64_tr_b16 a[12:13], v10 offset:3072
ds_write_b32 v60, v64 offset:3072
buffer_load_dwordx4 v13, s[28:31], s77 offen offset:2048 lds
s_waitcnt lgkmcnt(15)
v_fmac_f32 v136, v184, v34
v_fmac_f32 v137, v185, v34
v_fmac_f32 v138, v186, v34
v_mfma_f32_32x32x16_bf16 v[216:231], a[140:143], v[76:79], v[216:231]
ds_read_b64_tr_b16 a[14:15], v10 offset:3584
ds_read_b64_tr_b16 a[16:17], v10 offset:4096
ds_read_b64_tr_b16 a[18:19], v10 offset:4608
v_fmac_f32 v139, v187, v34
s_waitcnt lgkmcnt(15)
v_fmac_f32 v140, v188, v34
v_fmac_f32 v141, v189, v34
v_fmac_f32 v142, v190, v34
v_fmac_f32 v143, v191, v34
v_mfma_f32_32x32x16_bf16 v[200:215], a[136:139], v[76:79], v[200:215]
ds_read_b64_tr_b16 a[20:21], v10 offset:5120
ds_read_b64_tr_b16 a[22:23], v10 offset:5632
ds_read_b64_tr_b16 a[24:25], v10 offset:6144
buffer_load_dwordx4 v14, s[28:31], s77 offen offset:3072 lds
v_fmac_f32 v144, v192, v34
v_fmac_f32 v145, v193, v34
v_fmac_f32 v146, v194, v34
v_fmac_f32 v147, v195, v34
v_fmac_f32 v148, v196, v34
v_mfma_f32_32x32x16_bf16 v[216:231], a[148:151], v[80:83], v[216:231]
ds_read_b64_tr_b16 a[26:27], v10 offset:6656
ds_read_b64_tr_b16 a[28:29], v10 offset:7168
ds_read_b64_tr_b16 a[30:31], v10 offset:7680
v_fmac_f32 v149, v197, v34
v_fmac_f32 v150, v198, v34
v_fmac_f32 v151, v199, v34
s_waitcnt lgkmcnt(15)
v_add_f32 v136, v136, v168
v_add_f32 v137, v137, v169
v_mfma_f32_32x32x16_bf16 v[200:215], a[144:147], v[80:83], v[200:215]
ds_read_b64_tr_b16 a[32:33], v10 offset:8192
ds_read_b64_tr_b16 a[34:35], v10 offset:8704
ds_read_b64_tr_b16 a[36:37], v10 offset:9216
ds_read_b64_tr_b16 a[38:39], v10 offset:9728
s_add_u32 m0, s56, 8192
s_nop 0
buffer_load_dwordx4 v11, s[28:31], s78 offen offset:0 lds
v_add_f32 v138, v138, v170
v_add_f32 v139, v139, v171
v_mul_f32 v184, v136, v136
v_mul_f32 v185, v137, v137
v_mul_f32 v186, v138, v138
v_mfma_f32_32x32x16_bf16 v[216:231], a[156:159], v[84:87], v[216:231]
ds_read_b64_tr_b16 a[40:41], v10 offset:10240
ds_read_b64_tr_b16 a[42:43], v10 offset:10752
ds_read_b64_tr_b16 a[44:45], v10 offset:11264
v_mul_f32 v187, v139, v139
v_fma_f32 v184, v184, v244, v242
v_fma_f32 v185, v185, v244, v242
v_fma_f32 v186, v186, v244, v242
v_fma_f32 v187, v187, v244, v242
v_mfma_f32_32x32x16_bf16 v[200:215], a[152:155], v[84:87], v[200:215]
ds_read_b64_tr_b16 a[46:47], v10 offset:11776
ds_read_b64_tr_b16 a[48:49], v10 offset:12288
ds_read_b64_tr_b16 a[50:51], v10 offset:12800
buffer_load_dwordx4 v12, s[28:31], s78 offen offset:1024 lds
v_mul_f32 v184, v184, v136
v_mul_f32 v185, v185, v137
v_mul_f32 v186, v186, v138
v_mul_f32 v187, v187, v139
v_exp_f32 v184, v184
v_mfma_f32_32x32x16_bf16 v[216:231], a[164:167], v[88:91], v[216:231]
ds_read_b64_tr_b16 a[52:53], v10 offset:13312
ds_read_b64_tr_b16 a[54:55], v10 offset:13824
ds_read_b64_tr_b16 a[56:57], v10 offset:14336
v_exp_f32 v185, v185
v_exp_f32 v186, v186
v_exp_f32 v187, v187
v_fma_f32 v184, v184, v246, v246
v_fma_f32 v185, v185, v246, v246
v_mfma_f32_32x32x16_bf16 v[200:215], a[160:163], v[88:91], v[200:215]
ds_read_b64_tr_b16 a[58:59], v10 offset:14848
ds_read_b64_tr_b16 a[60:61], v10 offset:15360
ds_read_b64_tr_b16 a[62:63], v10 offset:15872
buffer_load_dwordx4 v13, s[28:31], s78 offen offset:2048 lds
v_fma_f32 v186, v186, v246, v246
v_fma_f32 v187, v187, v246, v246
v_rcp_f32 v184, v184
v_rcp_f32 v185, v185
v_rcp_f32 v186, v186
v_mfma_f32_32x32x16_bf16 v[216:231], a[172:175], v[92:95], v[216:231]
ds_read_b64_tr_b16 a[68:69], v9 offset:0
ds_read_b64_tr_b16 a[70:71], v9 offset:1024
ds_read_b64_tr_b16 a[64:65], v8 offset:0
ds_read_b64_tr_b16 a[66:67], v8 offset:1024
v_rcp_f32 v187, v187
v_mul_f32 v136, v136, v184
v_mul_f32 v137, v137, v185
v_mul_f32 v138, v138, v186
v_mul_f32 v139, v139, v187
v_add_f32 v140, v140, v172
v_mfma_f32_32x32x16_bf16 v[200:215], a[168:171], v[92:95], v[200:215]
ds_read_b64_tr_b16 a[76:77], v9 offset:2048
ds_read_b64_tr_b16 a[78:79], v9 offset:3072
ds_read_b64_tr_b16 a[72:73], v8 offset:2048
buffer_load_dwordx4 v14, s[28:31], s78 offen offset:3072 lds
v_add_f32 v141, v141, v173
v_add_f32 v142, v142, v174
v_add_f32 v143, v143, v175
v_mul_f32 v188, v140, v140
v_mul_f32 v189, v141, v141
v_mfma_f32_32x32x16_bf16 v[216:231], a[180:183], v[96:99], v[216:231]
ds_read_b64_tr_b16 a[74:75], v8 offset:3072
ds_read_b64_tr_b16 a[84:85], v9 offset:4096
ds_read_b64_tr_b16 a[86:87], v9 offset:5120
v_mul_f32 v190, v142, v142
v_mul_f32 v191, v143, v143
v_fma_f32 v188, v188, v244, v242
v_fma_f32 v189, v189, v244, v242
v_fma_f32 v190, v190, v244, v242
v_mfma_f32_32x32x16_bf16 v[200:215], a[176:179], v[96:99], v[200:215]
ds_read_b64_tr_b16 a[80:81], v8 offset:4096
ds_read_b64_tr_b16 a[82:83], v8 offset:5120
ds_read_b64_tr_b16 a[92:93], v9 offset:6144
s_add_u32 m0, s56, 12288
s_nop 0
buffer_load_dwordx4 v11, s[28:31], s79 offen offset:0 lds
v_fma_f32 v191, v191, v244, v242
v_mul_f32 v188, v188, v140
v_mul_f32 v189, v189, v141
v_mul_f32 v190, v190, v142
v_mul_f32 v191, v191, v143
v_mfma_f32_32x32x16_bf16 v[216:231], a[188:191], v[100:103], v[216:231]
ds_read_b64_tr_b16 a[94:95], v9 offset:7168
ds_read_b64_tr_b16 a[88:89], v8 offset:6144
ds_read_b64_tr_b16 a[90:91], v8 offset:7168
v_exp_f32 v188, v188
v_exp_f32 v189, v189
v_exp_f32 v190, v190
v_exp_f32 v191, v191
v_fma_f32 v188, v188, v246, v246
v_mfma_f32_32x32x16_bf16 v[200:215], a[184:187], v[100:103], v[200:215]
ds_read_b64_tr_b16 a[100:101], v9 offset:8192
ds_read_b64_tr_b16 a[102:103], v9 offset:9216
ds_read_b64_tr_b16 a[96:97], v8 offset:8192
ds_read_b64_tr_b16 a[98:99], v8 offset:9216
buffer_load_dwordx4 v12, s[28:31], s79 offen offset:1024 lds
v_fma_f32 v189, v189, v246, v246
v_fma_f32 v190, v190, v246, v246
v_fma_f32 v191, v191, v246, v246
v_rcp_f32 v188, v188
v_rcp_f32 v189, v189
v_mfma_f32_32x32x16_bf16 v[216:231], a[196:199], v[104:107], v[216:231]
ds_read_b64_tr_b16 a[108:109], v9 offset:10240
ds_read_b64_tr_b16 a[110:111], v9 offset:11264
ds_read_b64_tr_b16 a[104:105], v8 offset:10240
v_rcp_f32 v190, v190
v_rcp_f32 v191, v191
v_mul_f32 v140, v140, v188
v_mul_f32 v141, v141, v189
v_mul_f32 v142, v142, v190
v_mfma_f32_32x32x16_bf16 v[200:215], a[192:195], v[104:107], v[200:215]
ds_read_b64_tr_b16 a[106:107], v8 offset:11264
ds_read_b64_tr_b16 a[116:117], v9 offset:12288
ds_read_b64_tr_b16 a[118:119], v9 offset:13312
buffer_load_dwordx4 v13, s[28:31], s79 offen offset:2048 lds
v_mul_f32 v143, v143, v191
s_waitcnt lgkmcnt(15)
v_add_f32 v144, v144, v176
v_add_f32 v145, v145, v177
v_add_f32 v146, v146, v178
v_add_f32 v147, v147, v179
v_mfma_f32_32x32x16_bf16 v[216:231], a[204:207], v[108:111], v[216:231]
ds_read_b64_tr_b16 a[112:113], v8 offset:12288
ds_read_b64_tr_b16 a[114:115], v8 offset:13312
ds_read_b64_tr_b16 a[124:125], v9 offset:14336
v_mul_f32 v192, v144, v144
v_mul_f32 v193, v145, v145
v_mul_f32 v194, v146, v146
v_mul_f32 v195, v147, v147
v_fma_f32 v192, v192, v244, v242
v_mfma_f32_32x32x16_bf16 v[200:215], a[200:203], v[108:111], v[200:215]
ds_read_b64_tr_b16 a[126:127], v9 offset:15360
ds_read_b64_tr_b16 a[120:121], v8 offset:14336
ds_read_b64_tr_b16 a[122:123], v8 offset:15360
buffer_load_dwordx4 v14, s[28:31], s79 offen offset:3072 lds
v_fma_f32 v193, v193, v244, v242
v_fma_f32 v194, v194, v244, v242
v_fma_f32 v195, v195, v244, v242
v_mul_f32 v192, v192, v144
v_mul_f32 v193, v193, v145
v_mfma_f32_32x32x16_bf16 v[216:231], a[212:215], v[112:115], v[216:231]
v_mul_f32 v194, v194, v146
v_mul_f32 v195, v195, v147
v_exp_f32 v192, v192
v_exp_f32 v193, v193
v_exp_f32 v194, v194
v_mfma_f32_32x32x16_bf16 v[200:215], a[208:211], v[112:115], v[200:215]
s_waitcnt lgkmcnt(0)
s_barrier
v_exp_f32 v195, v195
v_fma_f32 v192, v192, v246, v246
v_fma_f32 v193, v193, v246, v246
v_fma_f32 v194, v194, v246, v246
v_fma_f32 v195, v195, v246, v246
v_rcp_f32 v192, v192
v_mfma_f32_32x32x16_bf16 v[216:231], a[220:223], v[116:119], v[216:231]
ds_read_b32 v65, v61 offset:3072
s_add_u32 m0, s56, 65536
s_nop 0
buffer_load_dwordx4 v11, s[28:31], s80 offen offset:0 lds
v_rcp_f32 v193, v193
v_rcp_f32 v194, v194
v_rcp_f32 v195, v195
v_mul_f32 v144, v144, v192
v_mul_f32 v145, v145, v193
v_mfma_f32_32x32x16_bf16 v[200:215], a[216:219], v[116:119], v[200:215]
v_mul_f32 v146, v146, v194
v_mul_f32 v147, v147, v195
v_add_f32 v148, v148, v180
v_add_f32 v149, v149, v181
v_add_f32 v150, v150, v182
v_mfma_f32_32x32x16_bf16 v[216:231], a[228:231], v[120:123], v[216:231]
buffer_load_dwordx4 v12, s[28:31], s80 offen offset:1024 lds
v_add_f32 v151, v151, v183
v_mul_f32 v196, v148, v148
v_mul_f32 v197, v149, v149
v_mul_f32 v198, v150, v150
v_mul_f32 v199, v151, v151
v_mfma_f32_32x32x16_bf16 v[200:215], a[224:227], v[120:123], v[200:215]
buffer_load_dwordx4 v13, s[28:31], s80 offen offset:2048 lds
v_fma_f32 v196, v196, v244, v242
v_fma_f32 v197, v197, v244, v242
v_fma_f32 v198, v198, v244, v242
v_fma_f32 v199, v199, v244, v242
v_mul_f32 v196, v196, v148
s_waitcnt lgkmcnt(0)
v_add_f32 v64, v64, v65
ds_write_b32 v61, v64 offset:1536
v_mfma_f32_32x32x16_bf16 v[216:231], a[236:239], v[124:127], v[216:231]
v_mul_f32 v197, v197, v149
v_mul_f32 v198, v198, v150
v_mul_f32 v199, v199, v151
v_exp_f32 v196, v196
v_exp_f32 v197, v197
v_mfma_f32_32x32x16_bf16 v[200:215], a[232:235], v[124:127], v[200:215]
buffer_load_dwordx4 v14, s[28:31], s80 offen offset:3072 lds
v_exp_f32 v198, v198
v_exp_f32 v199, v199
v_fma_f32 v196, v196, v246, v246
v_fma_f32 v197, v197, v246, v246
v_fma_f32 v198, v198, v246, v246
v_mfma_f32_32x32x16_bf16 v[216:231], a[244:247], v[128:131], v[216:231]
s_add_u32 m0, s56, 69632
s_nop 0
buffer_load_dwordx4 v11, s[28:31], s81 offen offset:0 lds
v_fma_f32 v199, v199, v246, v246
v_rcp_f32 v196, v196
v_rcp_f32 v197, v197
v_rcp_f32 v198, v198
v_rcp_f32 v199, v199
v_mfma_f32_32x32x16_bf16 v[200:215], a[240:243], v[128:131], v[200:215]
v_mul_f32 v148, v148, v196
v_mul_f32 v149, v149, v197
v_mul_f32 v150, v150, v198
v_mul_f32 v151, v151, v199
v_cvt_pk_bf16_f32 v248, v136, v137
v_mfma_f32_32x32x16_bf16 v[216:231], a[252:255], v[132:135], v[216:231]
buffer_load_dwordx4 v12, s[28:31], s81 offen offset:1024 lds
v_cvt_pk_bf16_f32 v249, v138, v139
v_cvt_pk_bf16_f32 v250, v140, v141
v_cvt_pk_bf16_f32 v251, v142, v143
v_cvt_pk_bf16_f32 v252, v144, v145
v_cvt_pk_bf16_f32 v253, v146, v147
v_mfma_f32_32x32x16_bf16 v[200:215], a[248:251], v[132:135], v[200:215]
v_cvt_pk_bf16_f32 v254, v148, v149
v_cvt_pk_bf16_f32 v255, v150, v151
s_add_u32 s66, s50, s55
s_add_u32 s66, s66, 8388608
s_cmp_eq_u32 s54, 0
s_cbranch_scc1 L_sc63
buffer_store_dwordx4 v[248:251], v1, s[32:35], s66 offen offset:0
buffer_store_dwordx4 v[252:255], v1, s[32:35], s66 offen offset:1024
L_sj64:
ds_write_b128 v23, v[216:219] offset:0
ds_write_b128 v23, v[220:223] offset:1024
ds_write_b128 v23, v[224:227] offset:2048
ds_write_b128 v23, v[228:231] offset:3072
s_cmp_eq_u32 s7, 0
s_cbranch_scc0 L_cj66
L_cb65:
v_mfma_f32_16x16x32_bf16 v[64:67], v[68:71], a[0:3], 0
v_mfma_f32_16x16x32_bf16 v[64:67], v[68:71], a[4:7], v[64:67]
v_mfma_f32_16x16x32_bf16 v[64:67], v[68:71], a[8:11], v[64:67]
v_mfma_f32_16x16x32_bf16 v[64:67], v[68:71], a[12:15], v[64:67]
v_mfma_f32_16x16x32_bf16 v[64:67], v[68:71], a[16:19], v[64:67]
v_mfma_f32_16x16x32_bf16 v[64:67], v[68:71], a[20:23], v[64:67]
v_mfma_f32_16x16x32_bf16 v[64:67], v[68:71], a[24:27], v[64:67]
v_mfma_f32_16x16x32_bf16 v[64:67], v[68:71], a[28:31], v[64:67]
v_mfma_f32_16x16x32_bf16 v[64:67], v[68:71], a[32:35], v[64:67]
v_mfma_f32_16x16x32_bf16 v[64:67], v[68:71], a[36:39], v[64:67]
v_mfma_f32_16x16x32_bf16 v[64:67], v[68:71], a[40:43], v[64:67]
v_mfma_f32_16x16x32_bf16 v[64:67], v[68:71], a[44:47], v[64:67]
v_mfma_f32_16x16x32_bf16 v[64:67], v[68:71], a[48:51], v[64:67]
v_mfma_f32_16x16x32_bf16 v[64:67], v[68:71], a[52:55], v[64:67]
v_mfma_f32_16x16x32_bf16 v[64:67], v[68:71], a[56:59], v[64:67]
v_mfma_f32_16x16x32_bf16 v[64:67], v[68:71], a[60:63], v[64:67]
L_cj66:
s_waitcnt vmcnt(8)
s_waitcnt lgkmcnt(0)
s_barrier
v_mfma_f32_32x32x16_bf16 v[136:151], a[0:3], v[72:75], 0
ds_read_b128 v[184:187], v25 offset:1536
ds_read_b128 v[188:191], v25 offset:1568
ds_read_b128 v[192:195], v25 offset:1600
ds_read_b128 v[196:199], v25 offset:1632
ds_read_b128 v[168:171], v24 offset:0
ds_read_b128 v[172:175], v24 offset:1024
ds_read_b128 v[176:179], v24 offset:2048
ds_read_b128 v[180:183], v24 offset:3072
ds_read_b64_tr_b16 a[132:133], v7 offset:0
ds_read_b64_tr_b16 a[134:135], v7 offset:1024
ds_read_b64_tr_b16 a[128:129], v6 offset:0
ds_read_b64_tr_b16 a[130:131], v6 offset:1024
ds_read_b64_tr_b16 a[140:141], v7 offset:2048
ds_read_b64_tr_b16 a[142:143], v7 offset:3072
ds_read_b64_tr_b16 a[136:137], v6 offset:2048
ds_read_b64_tr_b16 a[138:139], v6 offset:3072
ds_read_b64_tr_b16 a[148:149], v7 offset:4096
ds_read_b64_tr_b16 a[150:151], v7 offset:5120
buffer_load_dwordx4 v13, s[28:31], s81 offen offset:2048 lds
buffer_load_dwordx4 v14, s[28:31], s81 offen offset:3072 lds
s_waitcnt lgkmcnt(15)
v_fmac_f32 v200, v184, v34
v_fmac_f32 v201, v185, v34
v_fmac_f32 v202, v186, v34
v_mfma_f32_32x32x16_bf16 v[136:151], a[4:7], v[76:79], v[136:151]
ds_read_b64_tr_b16 a[144:145], v6 offset:4096
ds_read_b64_tr_b16 a[146:147], v6 offset:5120
ds_read_b64_tr_b16 a[156:157], v7 offset:6144
ds_read_b64_tr_b16 a[158:159], v7 offset:7168
ds_read_b64_tr_b16 a[152:153], v6 offset:6144
ds_read_b64_tr_b16 a[154:155], v6 offset:7168
ds_read_b64_tr_b16 a[164:165], v7 offset:8192
ds_read_b64_tr_b16 a[166:167], v7 offset:9216
ds_read_b64_tr_b16 a[160:161], v6 offset:8192
ds_write_b32 v62, v64 offset:3072
s_add_u32 m0, s56, 73728
s_nop 0
buffer_load_dwordx4 v11, s[28:31], s82 offen offset:0 lds
v_fmac_f32 v203, v187, v34
v_fmac_f32 v204, v188, v34
v_fmac_f32 v205, v189, v34
v_fmac_f32 v206, v190, v34
v_fmac_f32 v207, v191, v34
v_fmac_f32 v208, v192, v34
v_fmac_f32 v209, v193, v34
v_fmac_f32 v210, v194, v34
v_fmac_f32 v211, v195, v34
s_waitcnt lgkmcnt(15)
v_fmac_f32 v212, v196, v34
v_mfma_f32_32x32x16_bf16 v[136:151], a[8:11], v[80:83], v[136:151]
ds_read_b64_tr_b16 a[162:163], v6 offset:9216
ds_read_b64_tr_b16 a[172:173], v7 offset:10240
ds_read_b64_tr_b16 a[174:175], v7 offset:11264
ds_read_b64_tr_b16 a[168:169], v6 offset:10240
ds_read_b64_tr_b16 a[170:171], v6 offset:11264
ds_read_b64_tr_b16 a[180:181], v7 offset:12288
ds_read_b64_tr_b16 a[182:183], v7 offset:13312
ds_read_b64_tr_b16 a[176:177], v6 offset:12288
ds_read_b64_tr_b16 a[178:179], v6 offset:13312
buffer_load_dwordx4 v12, s[28:31], s82 offen offset:1024 lds
v_fmac_f32 v213, v197, v34
v_fmac_f32 v214, v198, v34
v_fmac_f32 v215, v199, v34
v_add_f32 v200, v200, v168
v_add_f32 v201, v201, v169
v_add_f32 v202, v202, v170
v_add_f32 v203, v203, v171
v_mul_f32 v184, v200, v200
v_mul_f32 v185, v201, v201
v_mul_f32 v186, v202, v202
v_mfma_f32_32x32x16_bf16 v[136:151], a[12:15], v[84:87], v[136:151]
ds_read_b64_tr_b16 a[188:189], v7 offset:14336
ds_read_b64_tr_b16 a[190:191], v7 offset:15360
ds_read_b64_tr_b16 a[184:185], v6 offset:14336
ds_read_b64_tr_b16 a[186:187], v6 offset:15360
ds_read_b64_tr_b16 a[196:197], v7 offset:16384
ds_read_b64_tr_b16 a[198:199], v7 offset:17408
ds_read_b64_tr_b16 a[192:193], v6 offset:16384
ds_read_b64_tr_b16 a[194:195], v6 offset:17408
ds_read_b64_tr_b16 a[204:205], v7 offset:18432
buffer_load_dwordx4 v13, s[28:31], s82 offen offset:2048 lds
v_mul_f32 v187, v203, v203
v_fma_f32 v184, v184, v244, v242
v_fma_f32 v185, v185, v244, v242
v_fma_f32 v186, v186, v244, v242
v_fma_f32 v187, v187, v244, v242
v_mul_f32 v184, v184, v200
v_mul_f32 v185, v185, v201
v_mul_f32 v186, v186, v202
v_mul_f32 v187, v187, v203
v_exp_f32 v184, v184
v_mfma_f32_32x32x16_bf16 v[136:151], a[16:19], v[88:91], v[136:151]
ds_read_b64_tr_b16 a[206:207], v7 offset:19456
ds_read_b64_tr_b16 a[200:201], v6 offset:18432
ds_read_b64_tr_b16 a[202:203], v6 offset:19456
ds_read_b64_tr_b16 a[212:213], v7 offset:20480
ds_read_b64_tr_b16 a[214:215], v7 offset:21504
ds_read_b64_tr_b16 a[208:209], v6 offset:20480
ds_read_b64_tr_b16 a[210:211], v6 offset:21504
ds_read_b64_tr_b16 a[220:221], v7 offset:22528
ds_read_b64_tr_b16 a[222:223], v7 offset:23552
buffer_load_dwordx4 v14, s[28:31], s82 offen offset:3072 lds
s_add_u32 m0, s56, 77824
s_nop 0
buffer_load_dwordx4 v11, s[28:31], s83 offen offset:0 lds
v_exp_f32 v185, v185
v_exp_f32 v186, v186
v_exp_f32 v187, v187
v_fma_f32 v184, v184, v246, v246
v_fma_f32 v185, v185, v246, v246
v_fma_f32 v186, v186, v246, v246
v_fma_f32 v187, v187, v246, v246
v_rcp_f32 v184, v184
v_rcp_f32 v185, v185
v_rcp_f32 v186, v186
v_mfma_f32_32x32x16_bf16 v[136:151], a[20:23], v[92:95], v[136:151]
ds_read_b64_tr_b16 a[216:217], v6 offset:22528
ds_read_b64_tr_b16 a[218:219], v6 offset:23552
ds_read_b64_tr_b16 a[228:229], v7 offset:24576
ds_read_b64_tr_b16 a[230:231], v7 offset:25600
ds_read_b64_tr_b16 a[224:225], v6 offset:24576
ds_read_b64_tr_b16 a[226:227], v6 offset:25600
ds_read_b64_tr_b16 a[236:237], v7 offset:26624
ds_read_b64_tr_b16 a[238:239], v7 offset:27648
ds_read_b64_tr_b16 a[232:233], v6 offset:26624
buffer_load_dwordx4 v12, s[28:31], s83 offen offset:1024 lds
s_add_u32 s63, s3, 96
v_mov_b32 v37, s63
s_waitcnt vmcnt(8)
s_cmp_eq_u32 s54, 0
s_cbranch_scc1 L_sc67
buffer_store_dword v37, v27, s[32:35], s67 offen
L_sj68:
v_rcp_f32 v187, v187
v_mul_f32 v200, v200, v184
v_mul_f32 v201, v201, v185
v_mul_f32 v202, v202, v186
v_mul_f32 v203, v203, v187
v_add_f32 v204, v204, v172
v_add_f32 v205, v205, v173
v_add_f32 v206, v206, v174
v_add_f32 v207, v207, v175
v_mul_f32 v188, v204, v204
v_mul_f32 v189, v205, v205
v_mfma_f32_32x32x16_bf16 v[136:151], a[24:27], v[96:99], v[136:151]
ds_read_b64_tr_b16 a[234:235], v6 offset:27648
ds_read_b64_tr_b16 a[244:245], v7 offset:28672
ds_read_b64_tr_b16 a[246:247], v7 offset:29696
ds_read_b64_tr_b16 a[240:241], v6 offset:28672
ds_read_b64_tr_b16 a[242:243], v6 offset:29696
ds_read_b64_tr_b16 a[252:253], v7 offset:30720
ds_read_b64_tr_b16 a[254:255], v7 offset:31744
ds_read_b64_tr_b16 a[248:249], v6 offset:30720
ds_read_b64_tr_b16 a[250:251], v6 offset:31744
buffer_load_dwordx4 v13, s[28:31], s83 offen offset:2048 lds
v_mul_f32 v190, v206, v206
v_mul_f32 v191, v207, v207
v_fma_f32 v188, v188, v244, v242
v_fma_f32 v189, v189, v244, v242
v_fma_f32 v190, v190, v244, v242
v_fma_f32 v191, v191, v244, v242
v_mul_f32 v188, v188, v204
v_mul_f32 v189, v189, v205
v_mul_f32 v190, v190, v206
v_mul_f32 v191, v191, v207
v_mfma_f32_32x32x16_bf16 v[136:151], a[28:31], v[100:103], v[136:151]
buffer_load_dwordx4 v14, s[28:31], s83 offen offset:3072 lds
v_exp_f32 v188, v188
v_exp_f32 v189, v189
v_exp_f32 v190, v190
v_exp_f32 v191, v191
v_fma_f32 v188, v188, v246, v246
v_fma_f32 v189, v189, v246, v246
v_fma_f32 v190, v190, v246, v246
v_fma_f32 v191, v191, v246, v246
v_rcp_f32 v188, v188
v_rcp_f32 v189, v189
v_mfma_f32_32x32x16_bf16 v[136:151], a[32:35], v[104:107], v[136:151]
s_waitcnt lgkmcnt(0)
s_barrier
s_add_u32 m0, s56, 0
s_nop 0
buffer_load_dwordx4 v11, s[28:31], s84 offen offset:0 lds
v_rcp_f32 v190, v190
v_rcp_f32 v191, v191
v_mul_f32 v204, v204, v188
v_mul_f32 v205, v205, v189
v_mul_f32 v206, v206, v190
v_mul_f32 v207, v207, v191
v_add_f32 v208, v208, v176
v_add_f32 v209, v209, v177
v_add_f32 v210, v210, v178
v_add_f32 v211, v211, v179
v_mfma_f32_32x32x16_bf16 v[136:151], a[36:39], v[108:111], v[136:151]
ds_read_b32 v65, v63 offset:3072
buffer_load_dwordx4 v12, s[28:31], s84 offen offset:1024 lds
v_mul_f32 v192, v208, v208
v_mul_f32 v193, v209, v209
v_mul_f32 v194, v210, v210
v_mul_f32 v195, v211, v211
v_fma_f32 v192, v192, v244, v242
v_fma_f32 v193, v193, v244, v242
v_fma_f32 v194, v194, v244, v242
v_fma_f32 v195, v195, v244, v242
v_mul_f32 v192, v192, v208
v_mul_f32 v193, v193, v209
v_mfma_f32_32x32x16_bf16 v[136:151], a[40:43], v[112:115], v[136:151]
buffer_load_dwordx4 v13, s[28:31], s84 offen offset:2048 lds
v_mul_f32 v194, v194, v210
v_mul_f32 v195, v195, v211
v_exp_f32 v192, v192
v_exp_f32 v193, v193
v_exp_f32 v194, v194
v_exp_f32 v195, v195
v_fma_f32 v192, v192, v246, v246
v_fma_f32 v193, v193, v246, v246
v_fma_f32 v194, v194, v246, v246
v_fma_f32 v195, v195, v246, v246
v_rcp_f32 v192, v192
v_mfma_f32_32x32x16_bf16 v[136:151], a[44:47], v[116:119], v[136:151]
buffer_load_dwordx4 v14, s[28:31], s84 offen offset:3072 lds
v_rcp_f32 v193, v193
v_rcp_f32 v194, v194
v_rcp_f32 v195, v195
v_mul_f32 v208, v208, v192
v_mul_f32 v209, v209, v193
v_mul_f32 v210, v210, v194
v_mul_f32 v211, v211, v195
v_add_f32 v212, v212, v180
v_add_f32 v213, v213, v181
v_add_f32 v214, v214, v182
s_waitcnt lgkmcnt(0)
v_add_f32 v64, v64, v65
ds_write_b32 v63, v64 offset:1792
v_mfma_f32_32x32x16_bf16 v[136:151], a[48:51], v[120:123], v[136:151]
s_add_u32 m0, s56, 4096
s_nop 0
buffer_load_dwordx4 v11, s[28:31], s85 offen offset:0 lds
v_add_f32 v215, v215, v183
v_mul_f32 v196, v212, v212
v_mul_f32 v197, v213, v213
v_mul_f32 v198, v214, v214
v_mul_f32 v199, v215, v215
v_fma_f32 v196, v196, v244, v242
v_fma_f32 v197, v197, v244, v242
v_fma_f32 v198, v198, v244, v242
v_fma_f32 v199, v199, v244, v242
v_mul_f32 v196, v196, v212
v_mfma_f32_32x32x16_bf16 v[136:151], a[52:55], v[124:127], v[136:151]
buffer_load_dwordx4 v12, s[28:31], s85 offen offset:1024 lds
v_mul_f32 v197, v197, v213
v_mul_f32 v198, v198, v214
v_mul_f32 v199, v199, v215
v_exp_f32 v196, v196
v_exp_f32 v197, v197
v_exp_f32 v198, v198
v_exp_f32 v199, v199
v_fma_f32 v196, v196, v246, v246
v_fma_f32 v197, v197, v246, v246
v_fma_f32 v198, v198, v246, v246
v_mfma_f32_32x32x16_bf16 v[136:151], a[56:59], v[128:131], v[136:151]
buffer_load_dwordx4 v13, s[28:31], s85 offen offset:2048 lds
v_fma_f32 v199, v199, v246, v246
v_rcp_f32 v196, v196
v_rcp_f32 v197, v197
v_rcp_f32 v198, v198
v_rcp_f32 v199, v199
v_mul_f32 v212, v212, v196
v_mul_f32 v213, v213, v197
v_mul_f32 v214, v214, v198
v_mul_f32 v215, v215, v199
v_cvt_pk_bf16_f32 v248, v200, v201
v_mfma_f32_32x32x16_bf16 v[136:151], a[60:63], v[132:135], v[136:151]
buffer_load_dwordx4 v14, s[28:31], s85 offen offset:3072 lds
buffer_load_dword v37, v28, s[32:35], s51 offen sc1
v_cvt_pk_bf16_f32 v249, v202, v203
v_cvt_pk_bf16_f32 v250, v204, v205
v_cvt_pk_bf16_f32 v251, v206, v207
v_cvt_pk_bf16_f32 v252, v208, v209
v_cvt_pk_bf16_f32 v253, v210, v211
v_cvt_pk_bf16_f32 v254, v212, v213
v_cvt_pk_bf16_f32 v255, v214, v215
s_add_u32 s66, s50, s55
s_add_u32 s66, s66, 10485760
s_cmp_eq_u32 s54, 0
s_cbranch_scc1 L_sc69
buffer_store_dwordx4 v[248:251], v1, s[32:35], s66 offen offset:0
buffer_store_dwordx4 v[252:255], v1, s[32:35], s66 offen offset:1024
L_sj70:
s_lshl_b32 s63, s49, 6
v_subrev_u32 v232, s63, v25
ds_write_b128 v23, v[144:147] offset:0
ds_write_b128 v23, v[148:151] offset:1024
s_add_u32 m0, s56, 8192
s_nop 0
buffer_load_dwordx4 v11, s[28:31], s86 offen offset:0 lds
s_waitcnt lgkmcnt(0)
s_barrier
ds_read_b128 v[184:187], v232 offset:1792
ds_read_b128 v[188:191], v232 offset:1824
buffer_load_dwordx4 v12, s[28:31], s86 offen offset:1024 lds
ds_read_b128 v[168:171], v24 offset:0
ds_read_b128 v[172:175], v24 offset:1024
s_waitcnt lgkmcnt(3)
v_pk_fma_f32 v[136:137], v[184:185], v[34:35], v[136:137] op_sel_hi:[1,0,1]
v_pk_fma_f32 v[138:139], v[186:187], v[34:35], v[138:139] op_sel_hi:[1,0,1]
s_waitcnt lgkmcnt(2)
v_pk_fma_f32 v[140:141], v[188:189], v[34:35], v[140:141] op_sel_hi:[1,0,1]
v_pk_fma_f32 v[142:143], v[190:191], v[34:35], v[142:143] op_sel_hi:[1,0,1]
s_waitcnt lgkmcnt(1)
v_pk_add_f32 v[136:137], v[136:137], v[168:169]
s_add_u32 s63, s52, 96
s_waitcnt vmcnt(4)
v_cmp_gt_u32 vcc, s63, v37
s_cbranch_vccnz L_pl71
L_pd72:
s_add_u32 s64, s90, 6291456
buffer_load_dwordx4 v[72:75], v2, s[32:35], s64 offen offset:0 sc1
v_pk_add_f32 v[138:139], v[138:139], v[170:171]
v_pk_mul_f32 v[184:185], v[136:137], v[136:137]
v_pk_mul_f32 v[186:187], v[138:139], v[138:139]
buffer_load_dwordx4 v[76:79], v2, s[32:35], s64 offen offset:1024 sc1
v_pk_fma_f32 v[184:185], v[184:185], v[244:245], v[242:243] op_sel_hi:[1,0,0]
v_pk_fma_f32 v[186:187], v[186:187], v[244:245], v[242:243] op_sel_hi:[1,0,0]
v_pk_mul_f32 v[184:185], v[184:185], v[136:137]
v_pk_mul_f32 v[186:187], v[186:187], v[138:139]
buffer_load_dwordx4 v[80:83], v2, s[32:35], s64 offen offset:2048 sc1
v_exp_f32 v184, v184
v_exp_f32 v185, v185
v_exp_f32 v186, v186
v_exp_f32 v187, v187
buffer_load_dwordx4 v[84:87], v2, s[32:35], s64 offen offset:3072 sc1
v_pk_fma_f32 v[184:185], v[184:185], v[246:247], v[246:247] op_sel_hi:[1,0,0]
v_pk_fma_f32 v[186:187], v[186:187], v[246:247], v[246:247] op_sel_hi:[1,0,0]
v_rcp_f32 v184, v184
v_rcp_f32 v185, v185
buffer_load_dwordx4 v[88:91], v3, s[32:35], s64 offen offset:0 sc1
v_rcp_f32 v186, v186
v_rcp_f32 v187, v187
v_pk_mul_f32 v[136:137], v[136:137], v[184:185]
v_pk_mul_f32 v[138:139], v[138:139], v[186:187]
buffer_load_dwordx4 v[92:95], v3, s[32:35], s64 offen offset:1024 sc1
s_waitcnt lgkmcnt(0)
v_pk_add_f32 v[140:141], v[140:141], v[172:173]
v_pk_add_f32 v[142:143], v[142:143], v[174:175]
v_pk_mul_f32 v[188:189], v[140:141], v[140:141]
v_pk_mul_f32 v[190:191], v[142:143], v[142:143]
buffer_load_dwordx4 v[96:99], v3, s[32:35], s64 offen offset:2048 sc1
v_pk_fma_f32 v[188:189], v[188:189], v[244:245], v[242:243] op_sel_hi:[1,0,0]
v_pk_fma_f32 v[190:191], v[190:191], v[244:245], v[242:243] op_sel_hi:[1,0,0]
v_pk_mul_f32 v[188:189], v[188:189], v[140:141]
v_pk_mul_f32 v[190:191], v[190:191], v[142:143]
buffer_load_dwordx4 v[100:103], v3, s[32:35], s64 offen offset:3072 sc1
v_exp_f32 v188, v188
v_exp_f32 v189, v189
v_exp_f32 v190, v190
v_exp_f32 v191, v191
v_pk_fma_f32 v[188:189], v[188:189], v[246:247], v[246:247] op_sel_hi:[1,0,0]
v_pk_fma_f32 v[190:191], v[190:191], v[246:247], v[246:247] op_sel_hi:[1,0,0]
v_rcp_f32 v188, v188
v_rcp_f32 v189, v189
v_rcp_f32 v190, v190
v_rcp_f32 v191, v191
v_pk_mul_f32 v[140:141], v[140:141], v[188:189]
v_pk_mul_f32 v[142:143], v[142:143], v[190:191]
v_cvt_pk_bf16_f32 v248, v136, v137
v_cvt_pk_bf16_f32 v249, v138, v139
v_cvt_pk_bf16_f32 v250, v140, v141
v_cvt_pk_bf16_f32 v251, v142, v143
v_and_or_b32 v248, v248, -2, s7
s_add_u32 s66, s50, s70
s_add_u32 s66, s66, 12582912
s_cmp_eq_u32 s54, 0
s_cbranch_scc1 L_sc73
buffer_store_dwordx4 v[248:251], v1, s[32:35], s66 offen offset:0
L_sj74:
s_add_u32 s63, s3, 112
v_mov_b32 v37, s63
s_waitcnt vmcnt(11)
s_cmp_eq_u32 s54, 0
s_cbranch_scc1 L_sc75
buffer_store_dword v37, v27, s[32:35], s67 offen
L_sj76:
s_waitcnt vmcnt(9)
v_mfma_f32_32x32x16_bf16 v[152:167], a[68:71], v[72:75], 0
s_add_u32 s64, s90, 8388608
buffer_load_dwordx4 v[104:107], v2, s[32:35], s64 offen offset:0 sc1
v_mfma_f32_32x32x16_bf16 v[136:151], a[64:67], v[72:75], 0
buffer_load_dwordx4 v[108:111], v2, s[32:35], s64 offen offset:1024 sc1
s_waitcnt vmcnt(10)
v_mfma_f32_32x32x16_bf16 v[152:167], a[76:79], v[76:79], v[152:167]
s_and_b32 s65, s5, 4
s_lshl1_add_u32 s65, s49, s65
s_lshl_b32 s65, s65, 2
v_and_b32 v233, 0x64, v28
v_or_b32 v233, s65, v233
v_mfma_f32_32x32x16_bf16 v[136:151], a[72:75], v[76:79], v[136:151]
buffer_load_dwordx4 v[112:115], v2, s[32:35], s64 offen offset:2048 sc1
s_waitcnt vmcnt(10)
v_mfma_f32_32x32x16_bf16 v[152:167], a[84:87], v[80:83], v[152:167]
buffer_load_dwordx4 v[116:119], v2, s[32:35], s64 offen offset:3072 sc1
v_mfma_f32_32x32x16_bf16 v[136:151], a[80:83], v[80:83], v[136:151]
s_waitcnt vmcnt(10)
v_mfma_f32_32x32x16_bf16 v[152:167], a[92:95], v[84:87], v[152:167]
buffer_load_dwordx4 v[120:123], v3, s[32:35], s64 offen offset:0 sc1
s_barrier
v_mfma_f32_32x32x16_bf16 v[136:151], a[88:91], v[84:87], v[136:151]
ds_read_b64_tr_b16 a[4:5], v9 offset:0
ds_read_b64_tr_b16 a[6:7], v9 offset:1024
s_waitcnt vmcnt(10)
v_mfma_f32_32x32x16_bf16 v[152:167], a[100:103], v[88:91], v[152:167]
ds_read_b64_tr_b16 a[0:1], v8 offset:0
ds_read_b64_tr_b16 a[2:3], v8 offset:1024
buffer_load_dwordx4 v[124:127], v3, s[32:35], s64 offen offset:1024 sc1
v_mfma_f32_32x32x16_bf16 v[136:151], a[96:99], v[88:91], v[136:151]
ds_read_b64_tr_b16 a[12:13], v9 offset:2048
ds_read_b64_tr_b16 a[14:15], v9 offset:3072
buffer_load_dwordx4 v[128:131], v3, s[32:35], s64 offen offset:2048 sc1
s_waitcnt vmcnt(11)
v_mfma_f32_32x32x16_bf16 v[152:167], a[108:111], v[92:95], v[152:167]
ds_read_b64_tr_b16 a[8:9], v8 offset:2048
ds_read_b64_tr_b16 a[10:11], v8 offset:3072
buffer_load_dword v37, v233, s[32:35], s51 offen sc1
v_mfma_f32_32x32x16_bf16 v[136:151], a[104:107], v[92:95], v[136:151]
ds_read_b64_tr_b16 a[20:21], v9 offset:4096
buffer_load_dwordx4 v[132:135], v3, s[32:35], s64 offen offset:3072 sc1
s_waitcnt vmcnt(12)
v_mfma_f32_32x32x16_bf16 v[152:167], a[116:119], v[96:99], v[152:167]
ds_read_b64_tr_b16 a[22:23], v9 offset:5120
ds_read_b64_tr_b16 a[16:17], v8 offset:4096
v_mfma_f32_32x32x16_bf16 v[136:151], a[112:115], v[96:99], v[136:151]
ds_read_b64_tr_b16 a[18:19], v8 offset:5120
ds_read_b64_tr_b16 a[28:29], v9 offset:6144
buffer_load_dwordx4 v13, s[28:31], s86 offen offset:2048 lds
s_waitcnt vmcnt(12)
v_mfma_f32_32x32x16_bf16 v[152:167], a[124:127], v[100:103], v[152:167]
ds_read_b64_tr_b16 a[30:31], v9 offset:7168
ds_read_b64_tr_b16 a[24:25], v8 offset:6144
buffer_load_dwordx4 v14, s[28:31], s86 offen offset:3072 lds
v_mfma_f32_32x32x16_bf16 v[136:151], a[120:123], v[100:103], v[136:151]
ds_read_b64_tr_b16 a[26:27], v8 offset:7168
s_add_u32 m0, s56, 12288
s_nop 0
buffer_load_dwordx4 v11, s[28:31], s87 offen offset:0 lds
v_mfma_f32_32x32x16_bf16 v[216:231], a[132:135], v[72:75], 0
ds_read_b64_tr_b16 a[36:37], v9 offset:8192
ds_read_b64_tr_b16 a[38:39], v9 offset:9216
v_mfma_f32_32x32x16_bf16 v[200:215], a[128:131], v[72:75], 0
ds_read_b64_tr_b16 a[32:33], v8 offset:8192
ds_read_b64_tr_b16 a[34:35], v8 offset:9216
buffer_load_dwordx4 v12, s[28:31], s87 offen offset:1024 lds
v_mfma_f32_32x32x16_bf16 v[216:231], a[140:143], v[76:79], v[216:231]
ds_read_b64_tr_b16 a[44:45], v9 offset:10240
ds_read_b64_tr_b16 a[46:47], v9 offset:11264
buffer_load_dwordx4 v13, s[28:31], s87 offen offset:2048 lds
v_mfma_f32_32x32x16_bf16 v[200:215], a[136:139], v[76:79], v[200:215]
ds_read_b64_tr_b16 a[40:41], v8 offset:10240
ds_read_b64_tr_b16 a[42:43], v8 offset:11264
buffer_load_dwordx4 v14, s[28:31], s87 offen offset:3072 lds
v_mfma_f32_32x32x16_bf16 v[216:231], a[148:151], v[80:83], v[216:231]
ds_read_b64_tr_b16 a[52:53], v9 offset:12288
v_mfma_f32_32x32x16_bf16 v[200:215], a[144:147], v[80:83], v[200:215]
ds_read_b64_tr_b16 a[54:55], v9 offset:13312
ds_read_b64_tr_b16 a[48:49], v8 offset:12288
v_mfma_f32_32x32x16_bf16 v[216:231], a[156:159], v[84:87], v[216:231]
ds_read_b64_tr_b16 a[50:51], v8 offset:13312
ds_read_b64_tr_b16 a[60:61], v9 offset:14336
v_mfma_f32_32x32x16_bf16 v[200:215], a[152:155], v[84:87], v[200:215]
ds_read_b64_tr_b16 a[62:63], v9 offset:15360
ds_read_b64_tr_b16 a[56:57], v8 offset:14336
v_mfma_f32_32x32x16_bf16 v[216:231], a[164:167], v[88:91], v[216:231]
ds_read_b64_tr_b16 a[58:59], v8 offset:15360
v_mfma_f32_32x32x16_bf16 v[200:215], a[160:163], v[88:91], v[200:215]
ds_read_b64_tr_b16 a[68:69], v9 offset:16384
ds_read_b64_tr_b16 a[70:71], v9 offset:17408
v_mfma_f32_32x32x16_bf16 v[216:231], a[172:175], v[92:95], v[216:231]
ds_read_b64_tr_b16 a[64:65], v8 offset:16384
ds_read_b64_tr_b16 a[66:67], v8 offset:17408
v_mfma_f32_32x32x16_bf16 v[200:215], a[168:171], v[92:95], v[200:215]
ds_read_b64_tr_b16 a[76:77], v9 offset:18432
ds_read_b64_tr_b16 a[78:79], v9 offset:19456
v_mfma_f32_32x32x16_bf16 v[216:231], a[180:183], v[96:99], v[216:231]
ds_read_b64_tr_b16 a[72:73], v8 offset:18432
v_mfma_f32_32x32x16_bf16 v[200:215], a[176:179], v[96:99], v[200:215]
ds_read_b64_tr_b16 a[74:75], v8 offset:19456
ds_read_b64_tr_b16 a[84:85], v9 offset:20480
v_mfma_f32_32x32x16_bf16 v[216:231], a[188:191], v[100:103], v[216:231]
ds_read_b64_tr_b16 a[86:87], v9 offset:21504
ds_read_b64_tr_b16 a[80:81], v8 offset:20480
s_add_u32 s63, s52, 112
s_waitcnt vmcnt(7)
v_cmp_gt_u32 vcc, s63, v37
s_cbranch_vccnz L_pl77
L_pd78:
s_add_u32 s64, s90, 10485760
buffer_load_dwordx4 v[72:75], v2, s[32:35], s64 offen offset:0 sc1
v_mfma_f32_32x32x16_bf16 v[200:215], a[184:187], v[100:103], v[200:215]
ds_read_b64_tr_b16 a[82:83], v8 offset:21504
buffer_load_dwordx4 v[76:79], v2, s[32:35], s64 offen offset:1024 sc1
v_mfma_f32_32x32x16_bf16 v[152:167], a[196:199], v[104:107], v[152:167]
ds_read_b64_tr_b16 a[92:93], v9 offset:22528
ds_read_b64_tr_b16 a[94:95], v9 offset:23552
buffer_load_dwordx4 v[80:83], v2, s[32:35], s64 offen offset:2048 sc1
v_mfma_f32_32x32x16_bf16 v[136:151], a[192:195], v[104:107], v[136:151]
ds_read_b64_tr_b16 a[88:89], v8 offset:22528
ds_read_b64_tr_b16 a[90:91], v8 offset:23552
buffer_load_dwordx4 v[84:87], v2, s[32:35], s64 offen offset:3072 sc1
v_mfma_f32_32x32x16_bf16 v[152:167], a[204:207], v[108:111], v[152:167]
ds_read_b64_tr_b16 a[100:101], v9 offset:24576
buffer_load_dwordx4 v[88:91], v3, s[32:35], s64 offen offset:0 sc1
v_mfma_f32_32x32x16_bf16 v[136:151], a[200:203], v[108:111], v[136:151]
ds_read_b64_tr_b16 a[102:103], v9 offset:25600
ds_read_b64_tr_b16 a[96:97], v8 offset:24576
buffer_load_dwordx4 v[92:95], v3, s[32:35], s64 offen offset:1024 sc1
v_mfma_f32_32x32x16_bf16 v[152:167], a[212:215], v[112:115], v[152:167]
ds_read_b64_tr_b16 a[98:99], v8 offset:25600
ds_read_b64_tr_b16 a[108:109], v9 offset:26624
buffer_load_dwordx4 v[96:99], v3, s[32:35], s64 offen offset:2048 sc1
v_mfma_f32_32x32x16_bf16 v[136:151], a[208:211], v[112:115], v[136:151]
ds_read_b64_tr_b16 a[110:111], v9 offset:27648
buffer_load_dwordx4 v[100:103], v3, s[32:35], s64 offen offset:3072 sc1
v_mfma_f32_32x32x16_bf16 v[152:167], a[220:223], v[116:119], v[152:167]
ds_read_b64_tr_b16 a[104:105], v8 offset:26624
ds_read_b64_tr_b16 a[106:107], v8 offset:27648
s_add_u32 s64, s91, 12582912
buffer_load_dwordx4 v[56:59], v2, s[32:35], s64 offen offset:0 sc1
v_mfma_f32_32x32x16_bf16 v[136:151], a[216:219], v[116:119], v[136:151]
ds_read_b64_tr_b16 a[116:117], v9 offset:28672
ds_read_b64_tr_b16 a[118:119], v9 offset:29696
buffer_load_dwordx4 v[60:63], v2, s[32:35], s64 offen offset:1024 sc1
v_mfma_f32_32x32x16_bf16 v[152:167], a[228:231], v[120:123], v[152:167]
ds_read_b64_tr_b16 a[112:113], v8 offset:28672
buffer_load_dwordx4 v[64:67], v2, s[32:35], s64 offen offset:2048 sc1
v_mfma_f32_32x32x16_bf16 v[136:151], a[224:227], v[120:123], v[136:151]
ds_read_b64_tr_b16 a[114:115], v8 offset:29696
ds_read_b64_tr_b16 a[124:125], v9 offset:30720
buffer_load_dwordx4 v[68:71], v2, s[32:35], s64 offen offset:3072 sc1
v_mfma_f32_32x32x16_bf16 v[152:167], a[236:239], v[124:127], v[152:167]
ds_read_b64_tr_b16 a[126:127], v9 offset:31744
ds_read_b64_tr_b16 a[120:121], v8 offset:30720
v_mfma_f32_32x32x16_bf16 v[136:151], a[232:235], v[124:127], v[136:151]
ds_read_b64_tr_b16 a[122:123], v8 offset:31744
v_mfma_f32_32x32x16_bf16 v[152:167], a[244:247], v[128:131], v[152:167]
v_mfma_f32_32x32x16_bf16 v[136:151], a[240:243], v[128:131], v[136:151]
s_waitcnt vmcnt(18)
v_mfma_f32_32x32x16_bf16 v[152:167], a[252:255], v[132:135], v[152:167]
v_mfma_f32_32x32x16_bf16 v[136:151], a[248:251], v[132:135], v[136:151]
s_waitcnt vmcnt(11) lgkmcnt(15)
v_mfma_f32_32x32x16_bf16 v[152:167], a[4:7], v[72:75], v[152:167]
v_mfma_f32_32x32x16_bf16 v[136:151], a[0:3], v[72:75], v[136:151]
s_waitcnt vmcnt(10)
v_mfma_f32_32x32x16_bf16 v[152:167], a[12:15], v[76:79], v[152:167]
s_waitcnt lgkmcnt(0)
s_barrier
v_mfma_f32_32x32x16_bf16 v[136:151], a[8:11], v[76:79], v[136:151]
ds_read_b64_tr_b16 a[132:133], v7 offset:0
ds_read_b64_tr_b16 a[134:135], v7 offset:1024
ds_read_b64_tr_b16 a[128:129], v6 offset:0
s_add_u32 m0, s56, 65536
s_add_u32 s62, s57, 1024
buffer_load_dwordx4 v15, s[8:11], s62 offen offset:0 lds
s_waitcnt vmcnt(10)
v_mfma_f32_32x32x16_bf16 v[152:167], a[20:23], v[80:83], v[152:167]
ds_read_b64_tr_b16 a[130:131], v6 offset:1024
ds_read_b64_tr_b16 a[140:141], v7 offset:2048
ds_read_b64_tr_b16 a[142:143], v7 offset:3072
v_mfma_f32_32x32x16_bf16 v[136:151], a[16:19], v[80:83], v[136:151]
ds_read_b64_tr_b16 a[136:137], v6 offset:2048
ds_read_b64_tr_b16 a[138:139], v6 offset:3072
ds_read_b64_tr_b16 a[148:149], v7 offset:4096
buffer_load_dwordx4 v16, s[8:11], s62 offen offset:1024 lds
s_waitcnt vmcnt(10)
v_mfma_f32_32x32x16_bf16 v[152:167], a[28:31], v[84:87], v[152:167]
ds_read_b64_tr_b16 a[150:151], v7 offset:5120
ds_read_b64_tr_b16 a[144:145], v6 offset:4096
ds_read_b64_tr_b16 a[146:147], v6 offset:5120
v_mfma_f32_32x32x16_bf16 v[136:151], a[24:27], v[84:87], v[136:151]
ds_read_b64_tr_b16 a[156:157], v7 offset:6144
ds_read_b64_tr_b16 a[158:159], v7 offset:7168
ds_read_b64_tr_b16 a[152:153], v6 offset:6144
s_waitcnt vmcnt(9)
v_mfma_f32_32x32x16_bf16 v[152:167], a[36:39], v[88:91], v[152:167]
ds_read_b64_tr_b16 a[154:155], v6 offset:7168
ds_read_b64_tr_b16 a[164:165], v7 offset:8192
ds_read_b64_tr_b16 a[166:167], v7 offset:9216
buffer_load_dwordx4 v17, s[8:11], s62 offen offset:2048 lds
v_mfma_f32_32x32x16_bf16 v[136:151], a[32:35], v[88:91], v[136:151]
ds_read_b64_tr_b16 a[160:161], v6 offset:8192
ds_read_b64_tr_b16 a[162:163], v6 offset:9216
ds_read_b64_tr_b16 a[172:173], v7 offset:10240
s_waitcnt vmcnt(9)
v_mfma_f32_32x32x16_bf16 v[152:167], a[44:47], v[92:95], v[152:167]
ds_read_b64_tr_b16 a[174:175], v7 offset:11264
ds_read_b64_tr_b16 a[168:169], v6 offset:10240
ds_read_b64_tr_b16 a[170:171], v6 offset:11264
buffer_load_dwordx4 v18, s[8:11], s62 offen offset:3072 lds
s_lshr_b32 s65, s2, 3
s_add_u32 s65, s65, s6
s_cmp_lt_u32 s65, s7
s_cbranch_scc0 L_wb
buffer_wbl2 sc1
L_wb:
v_mfma_f32_32x32x16_bf16 v[136:151], a[40:43], v[92:95], v[136:151]
ds_read_b64_tr_b16 a[180:181], v7 offset:12288
ds_read_b64_tr_b16 a[182:183], v7 offset:13312
ds_read_b64_tr_b16 a[176:177], v6 offset:12288
s_waitcnt vmcnt(9)
v_mfma_f32_32x32x16_bf16 v[152:167], a[52:55], v[96:99], v[152:167]
ds_read_b64_tr_b16 a[178:179], v6 offset:13312
ds_read_b64_tr_b16 a[188:189], v7 offset:14336
ds_read_b64_tr_b16 a[190:191], v7 offset:15360
v_mfma_f32_32x32x16_bf16 v[136:151], a[48:51], v[96:99], v[136:151]
ds_read_b64_tr_b16 a[184:185], v6 offset:14336
ds_read_b64_tr_b16 a[186:187], v6 offset:15360
s_add_u32 m0, s56, 69632
s_add_u32 s62, s57, 99328
buffer_load_dwordx4 v15, s[8:11], s62 offen offset:0 lds
s_waitcnt vmcnt(9)
v_mfma_f32_32x32x16_bf16 v[152:167], a[60:63], v[100:103], v[152:167]
ds_read_b64_tr_b16 a[196:197], v7 offset:16384
ds_read_b64_tr_b16 a[198:199], v7 offset:17408
ds_read_b64_tr_b16 a[192:193], v6 offset:16384
v_mfma_f32_32x32x16_bf16 v[136:151], a[56:59], v[100:103], v[136:151]
s_waitcnt vmcnt(7)
v_bitop3_b32 v248, v56, v60, s7 bitop3:0x7e
v_and_b32 v248, 1, v248
v_cmp_ne_u32 vcc, 0, v248
s_cbranch_vccnz L_rt79
L_rb80:
ds_read_b64_tr_b16 a[194:195], v6 offset:17408
ds_read_b64_tr_b16 a[204:205], v7 offset:18432
ds_read_b64_tr_b16 a[206:207], v7 offset:19456
buffer_load_dwordx4 v16, s[8:11], s62 offen offset:1024 lds
v_mfma_f32_32x32x16_bf16 v[152:167], a[68:71], v[56:59], v[152:167]
ds_read_b64_tr_b16 a[200:201], v6 offset:18432
ds_read_b64_tr_b16 a[202:203], v6 offset:19456
ds_read_b64_tr_b16 a[212:213], v7 offset:20480
v_mfma_f32_32x32x16_bf16 v[136:151], a[64:67], v[56:59], v[136:151]
ds_read_b64_tr_b16 a[214:215], v7 offset:21504
ds_read_b64_tr_b16 a[208:209], v6 offset:20480
ds_read_b64_tr_b16 a[210:211], v6 offset:21504
v_mfma_f32_32x32x16_bf16 v[152:167], a[76:79], v[60:63], v[152:167]
ds_read_b64_tr_b16 a[220:221], v7 offset:22528
ds_read_b64_tr_b16 a[222:223], v7 offset:23552
ds_read_b64_tr_b16 a[216:217], v6 offset:22528
buffer_load_dwordx4 v17, s[8:11], s62 offen offset:2048 lds
v_mfma_f32_32x32x16_bf16 v[136:151], a[72:75], v[60:63], v[136:151]
s_waitcnt vmcnt(7)
v_bitop3_b32 v248, v64, v68, s7 bitop3:0x7e
v_and_b32 v248, 1, v248
v_cmp_ne_u32 vcc, 0, v248
s_cbranch_vccnz L_rt81
L_rb82:
ds_read_b64_tr_b16 a[218:219], v6 offset:23552
ds_read_b64_tr_b16 a[228:229], v7 offset:24576
ds_read_b64_tr_b16 a[230:231], v7 offset:25600
v_mfma_f32_32x32x16_bf16 v[152:167], a[84:87], v[64:67], v[152:167]
ds_read_b64_tr_b16 a[224:225], v6 offset:24576
ds_read_b64_tr_b16 a[226:227], v6 offset:25600
ds_read_b64_tr_b16 a[236:237], v7 offset:26624
buffer_load_dwordx4 v18, s[8:11], s62 offen offset:3072 lds
v_mfma_f32_32x32x16_bf16 v[136:151], a[80:83], v[64:67], v[136:151]
ds_read_b64_tr_b16 a[238:239], v7 offset:27648
ds_read_b64_tr_b16 a[232:233], v6 offset:26624
ds_read_b64_tr_b16 a[234:235], v6 offset:27648
v_mfma_f32_32x32x16_bf16 v[152:167], a[92:95], v[68:71], v[152:167]
ds_read_b64_tr_b16 a[244:245], v7 offset:28672
ds_read_b64_tr_b16 a[246:247], v7 offset:29696
ds_read_b64_tr_b16 a[240:241], v6 offset:28672
v_mfma_f32_32x32x16_bf16 v[136:151], a[88:91], v[68:71], v[136:151]
ds_read_b64_tr_b16 a[242:243], v6 offset:29696
ds_read_b64_tr_b16 a[252:253], v7 offset:30720
ds_read_b64_tr_b16 a[254:255], v7 offset:31744
v_mfma_f32_32x32x16_bf16 v[216:231], a[100:103], v[104:107], v[216:231]
ds_read_b64_tr_b16 a[248:249], v6 offset:30720
ds_read_b64_tr_b16 a[250:251], v6 offset:31744
v_mfma_f32_32x32x16_bf16 v[200:215], a[96:99], v[104:107], v[200:215]
v_mfma_f32_32x32x16_bf16 v[216:231], a[108:111], v[108:111], v[216:231]
ds_write_b128 v23, v[152:155] offset:0
ds_write_b128 v23, v[156:159] offset:1024
v_mfma_f32_32x32x16_bf16 v[200:215], a[104:107], v[108:111], v[200:215]
ds_write_b128 v23, v[160:163] offset:2048
ds_write_b128 v23, v[164:167] offset:3072
v_mfma_f32_32x32x16_bf16 v[216:231], a[116:119], v[112:115], v[216:231]
v_mfma_f32_32x32x16_bf16 v[200:215], a[112:115], v[112:115], v[200:215]
s_waitcnt lgkmcnt(0)
s_barrier
ds_read_b128 v[168:171], v24 offset:0
ds_read_b128 v[172:175], v24 offset:1024
ds_read_b128 v[176:179], v24 offset:2048
ds_read_b128 v[180:183], v24 offset:3072
v_mfma_f32_32x32x16_bf16 v[216:231], a[124:127], v[116:119], v[216:231]
v_mfma_f32_32x32x16_bf16 v[200:215], a[120:123], v[116:119], v[200:215]
v_mfma_f32_32x32x16_bf16 v[216:231], a[132:135], v[120:123], v[216:231]
s_waitcnt lgkmcnt(3)
v_add_f32 v136, v136, v168
v_add_f32 v137, v137, v169
v_add_f32 v138, v138, v170
v_add_f32 v139, v139, v171
v_mfma_f32_32x32x16_bf16 v[200:215], a[128:131], v[120:123], v[200:215]
s_waitcnt lgkmcnt(2)
v_add_f32 v140, v140, v172
v_add_f32 v141, v141, v173
v_add_f32 v142, v142, v174
v_mfma_f32_32x32x16_bf16 v[216:231], a[140:143], v[124:127], v[216:231]
v_add_f32 v143, v143, v175
s_waitcnt lgkmcnt(1)
v_add_f32 v144, v144, v176
v_add_f32 v145, v145, v177
v_mfma_f32_32x32x16_bf16 v[200:215], a[136:139], v[124:127], v[200:215]
v_add_f32 v146, v146, v178
v_add_f32 v147, v147, v179
s_waitcnt lgkmcnt(0)
v_add_f32 v148, v148, v180
v_mfma_f32_32x32x16_bf16 v[216:231], a[148:151], v[128:131], v[216:231]
v_add_f32 v149, v149, v181
v_add_f32 v150, v150, v182
v_add_f32 v151, v151, v183
v_mfma_f32_32x32x16_bf16 v[200:215], a[144:147], v[128:131], v[200:215]
v_cvt_pk_bf16_f32 v248, v136, v137
v_cvt_pk_bf16_f32 v249, v138, v139
v_cvt_pk_bf16_f32 v250, v140, v141
v_mfma_f32_32x32x16_bf16 v[216:231], a[156:159], v[132:135], v[216:231]
v_cvt_pk_bf16_f32 v251, v142, v143
v_cvt_pk_bf16_f32 v252, v144, v145
v_cvt_pk_bf16_f32 v253, v146, v147
v_mfma_f32_32x32x16_bf16 v[200:215], a[152:155], v[132:135], v[200:215]
v_cvt_pk_bf16_f32 v254, v148, v149
v_cvt_pk_bf16_f32 v255, v150, v151
v_and_b32 v248, -2, v248
v_mfma_f32_32x32x16_bf16 v[216:231], a[164:167], v[72:75], v[216:231]
v_and_b32 v252, -2, v252
s_xor_b32 s66, s55, 0x4000
s_add_u32 s66, s66, s50
s_add_u32 s66, s66, 4194304
s_cmp_eq_u32 s54, 0
s_cbranch_scc1 L_sc83
buffer_store_dwordx4 v[248:251], v1, s[32:35], s66 offen offset:0
buffer_store_dwordx4 v[252:255], v1, s[32:35], s66 offen offset:1024
L_sj84:
v_mfma_f32_32x32x16_bf16 v[200:215], a[160:163], v[72:75], v[200:215]
v_mfma_f32_32x32x16_bf16 v[216:231], a[172:175], v[76:79], v[216:231]
s_barrier
s_mul_i32 s63, s97, 12
s_load_dwordx2 s[0:1], s[8:9], s63 offset:11708
s_mul_i32 s63, s97, 12
s_load_dwordx2 s[0:1], s[8:9], s63 offset:444
s_load_dwordx2 s[0:1], s[8:9], s63 offset:3516
s_load_dwordx2 s[0:1], s[8:9], s63 offset:6588
s_load_dwordx2 s[0:1], s[8:9], s63 offset:9660
v_mfma_f32_32x32x16_bf16 v[200:215], a[168:171], v[76:79], v[200:215]
s_add_u32 m0, s56, 73728
s_add_u32 s62, s57, 197632
buffer_load_dwordx4 v15, s[8:11], s62 offen offset:0 lds
v_mfma_f32_32x32x16_bf16 v[216:231], a[180:183], v[80:83], v[216:231]
v_mfma_f32_32x32x16_bf16 v[200:215], a[176:179], v[80:83], v[200:215]
buffer_load_dwordx4 v16, s[8:11], s62 offen offset:1024 lds
v_mfma_f32_32x32x16_bf16 v[216:231], a[188:191], v[84:87], v[216:231]
v_mfma_f32_32x32x16_bf16 v[200:215], a[184:187], v[84:87], v[200:215]
buffer_load_dwordx4 v17, s[8:11], s62 offen offset:2048 lds
v_mfma_f32_32x32x16_bf16 v[216:231], a[196:199], v[88:91], v[216:231]
v_mfma_f32_32x32x16_bf16 v[200:215], a[192:195], v[88:91], v[200:215]
buffer_load_dwordx4 v18, s[8:11], s62 offen offset:3072 lds
v_mfma_f32_32x32x16_bf16 v[216:231], a[204:207], v[92:95], v[216:231]
v_mfma_f32_32x32x16_bf16 v[200:215], a[200:203], v[92:95], v[200:215]
v_mfma_f32_32x32x16_bf16 v[216:231], a[212:215], v[96:99], v[216:231]
v_mfma_f32_32x32x16_bf16 v[200:215], a[208:211], v[96:99], v[200:215]
v_mfma_f32_32x32x16_bf16 v[216:231], a[220:223], v[100:103], v[216:231]
v_mfma_f32_32x32x16_bf16 v[200:215], a[216:219], v[100:103], v[200:215]
v_mfma_f32_32x32x16_bf16 v[216:231], a[228:231], v[56:59], v[216:231]
s_add_u32 s65, s50, s55
s_add_u32 s65, s65, 4194304
buffer_load_dwordx4 v[184:187], v1, s[32:35], s65 offen offset:0 sc1
buffer_load_dwordx4 v[188:191], v1, s[32:35], s65 offen offset:1024 sc1
v_mfma_f32_32x32x16_bf16 v[200:215], a[224:227], v[56:59], v[200:215]
v_mfma_f32_32x32x16_bf16 v[216:231], a[236:239], v[60:63], v[216:231]
v_mfma_f32_32x32x16_bf16 v[200:215], a[232:235], v[60:63], v[200:215]
v_mfma_f32_32x32x16_bf16 v[216:231], a[244:247], v[64:67], v[216:231]
v_mfma_f32_32x32x16_bf16 v[200:215], a[240:243], v[64:67], v[200:215]
v_mfma_f32_32x32x16_bf16 v[216:231], a[252:255], v[68:71], v[216:231]
v_mfma_f32_32x32x16_bf16 v[200:215], a[248:251], v[68:71], v[200:215]
s_add_u32 m0, s56, 77824
s_add_u32 s62, s57, 295936
buffer_load_dwordx4 v15, s[8:11], s62 offen offset:0 lds
buffer_load_dwordx4 v16, s[8:11], s62 offen offset:1024 lds
s_nop 6
ds_write_b128 v23, v[216:219] offset:0
ds_write_b128 v23, v[220:223] offset:1024
ds_write_b128 v23, v[224:227] offset:2048
ds_write_b128 v23, v[228:231] offset:3072
s_waitcnt vmcnt(2)
v_or_b32 v248, v184, v188
v_and_b32 v248, 1, v248
v_cmp_ne_u32 vcc, 0, v248
s_cbranch_vccnz L_rt85
L_rb86:
v_lshlrev_b32 v232, 16, v184
v_lshlrev_b32 v234, 16, v185
v_lshlrev_b32 v236, 16, v186
v_lshlrev_b32 v238, 16, v187
v_lshlrev_b32 v240, 16, v188
v_lshlrev_b32 v242, 16, v189
v_lshlrev_b32 v244, 16, v190
v_lshlrev_b32 v246, 16, v191
v_and_b32 v233, 0xffff0000, v184
v_and_b32 v235, 0xffff0000, v185
v_and_b32 v237, 0xffff0000, v186
v_and_b32 v239, 0xffff0000, v187
v_and_b32 v241, 0xffff0000, v188
v_and_b32 v243, 0xffff0000, v189
v_and_b32 v245, 0xffff0000, v190
v_and_b32 v247, 0xffff0000, v191
v_pk_add_f32 v[40:41], v[40:41], v[232:233]
v_pk_add_f32 v[42:43], v[42:43], v[234:235]
v_pk_add_f32 v[44:45], v[44:45], v[236:237]
v_pk_add_f32 v[46:47], v[46:47], v[238:239]
v_pk_add_f32 v[48:49], v[48:49], v[240:241]
v_pk_add_f32 v[50:51], v[50:51], v[242:243]
v_pk_add_f32 v[52:53], v[52:53], v[244:245]
v_pk_add_f32 v[54:55], v[54:55], v[246:247]
s_waitcnt lgkmcnt(0)
s_barrier
buffer_load_dwordx4 v17, s[8:11], s62 offen offset:2048 lds
ds_read_b128 v[168:171], v24 offset:0
ds_read_b128 v[172:175], v24 offset:1024
ds_read_b128 v[176:179], v24 offset:2048
ds_read_b128 v[180:183], v24 offset:3072
v_pk_add_f32 v[40:41], v[40:41], v[200:201]
v_pk_add_f32 v[42:43], v[42:43], v[202:203]
v_pk_add_f32 v[44:45], v[44:45], v[204:205]
v_pk_add_f32 v[46:47], v[46:47], v[206:207]
v_pk_add_f32 v[48:49], v[48:49], v[208:209]
v_pk_add_f32 v[50:51], v[50:51], v[210:211]
v_pk_add_f32 v[52:53], v[52:53], v[212:213]
v_pk_add_f32 v[54:55], v[54:55], v[214:215]
s_add_u32 s63, s3, 272
v_mov_b32 v37, s63
s_cmp_eq_u32 s54, 0
s_cbranch_scc1 L_sc87
buffer_store_dword v37, v27, s[32:35], s67 offen
L_sj88:
s_waitcnt lgkmcnt(3)
v_pk_add_f32 v[40:41], v[40:41], v[168:169]
buffer_load_dwordx4 v18, s[8:11], s62 offen offset:3072 lds
v_pk_add_f32 v[42:43], v[42:43], v[170:171]
s_waitcnt lgkmcnt(2)
v_pk_add_f32 v[44:45], v[44:45], v[172:173]
v_pk_add_f32 v[46:47], v[46:47], v[174:175]
s_waitcnt lgkmcnt(1)
v_pk_add_f32 v[48:49], v[48:49], v[176:177]
v_pk_add_f32 v[50:51], v[50:51], v[178:179]
s_waitcnt lgkmcnt(0)
v_pk_add_f32 v[52:53], v[52:53], v[180:181]
v_pk_add_f32 v[54:55], v[54:55], v[182:183]
v_cvt_pk_bf16_f32 v248, v40, v41
v_cvt_pk_bf16_f32 v249, v42, v43
v_cvt_pk_bf16_f32 v250, v44, v45
v_cvt_pk_bf16_f32 v251, v46, v47
v_cvt_pk_bf16_f32 v252, v48, v49
v_cvt_pk_bf16_f32 v253, v50, v51
v_cvt_pk_bf16_f32 v254, v52, v53
v_cvt_pk_bf16_f32 v255, v54, v55
s_cmp_eq_u32 s7, 0
s_cbranch_scc0 L_out
s_mov_b32 s7, 1
s_mov_b32 s52, 256
s_add_u32 s3, s3, 256
s_mov_b32 s72, 33554432
s_add_u32 s96, s96, 33554432
v_bfe_u32 v37, v31, 24, 1
v_lshl_add_u32 v31, v37, 6, v31
v_bfe_u32 v37, v32, 24, 1
v_lshl_add_u32 v32, v37, 6, v32
v_add_u32 v38, 64, v38
v_or_b32 v248, 1, v248
v_or_b32 v252, 1, v252
s_add_u32 s66, s50, s55
s_add_u32 s66, s66, 4194304
s_cmp_eq_u32 s54, 0
s_cbranch_scc1 L_sc89
buffer_store_dwordx4 v[248:251], v1, s[32:35], s66 offen offset:0
buffer_store_dwordx4 v[252:255], v1, s[32:35], s66 offen offset:1024
L_sj90:
v_pk_add_f32 v[232:233], v[40:41], v[42:43]
v_pk_mul_f32 v[234:235], v[40:41], v[40:41]
v_pk_fma_f32 v[234:235], v[42:43], v[42:43], v[234:235]
v_pk_add_f32 v[232:233], v[232:233], v[44:45]
v_pk_fma_f32 v[234:235], v[44:45], v[44:45], v[234:235]
v_pk_add_f32 v[232:233], v[232:233], v[46:47]
v_pk_fma_f32 v[234:235], v[46:47], v[46:47], v[234:235]
v_pk_add_f32 v[232:233], v[232:233], v[48:49]
v_pk_fma_f32 v[234:235], v[48:49], v[48:49], v[234:235]
v_pk_add_f32 v[232:233], v[232:233], v[50:51]
v_pk_fma_f32 v[234:235], v[50:51], v[50:51], v[234:235]
v_pk_add_f32 v[232:233], v[232:233], v[52:53]
v_pk_fma_f32 v[234:235], v[52:53], v[52:53], v[234:235]
v_pk_add_f32 v[232:233], v[232:233], v[54:55]
v_pk_fma_f32 v[234:235], v[54:55], v[54:55], v[234:235]
v_add_f32 v232, v232, v233
v_add_f32 v234, v234, v235
s_add_u32 s65, s50, s68
s_add_u32 s65, s65, 14680064
v_permlane32_swap_b32 v232, v234
v_add_f32 v232, v232, v234
v_and_b32 v232, -2, v232
s_cmp_eq_u32 s54, 0
s_cbranch_scc1 L_sc91
buffer_store_dword v232, v1, s[32:35], s65 offen
L_sj92:
s_add_u32 m0, s56, 0
s_add_u32 s62, s57, 2048
buffer_load_dwordx4 v15, s[8:11], s62 offen offset:0 lds
buffer_load_dwordx4 v16, s[8:11], s62 offen offset:1024 lds
buffer_load_dwordx4 v17, s[8:11], s62 offen offset:2048 lds
buffer_load_dwordx4 v18, s[8:11], s62 offen offset:3072 lds
s_add_u32 m0, s56, 4096
s_add_u32 s62, s57, 100352
buffer_load_dwordx4 v15, s[8:11], s62 offen offset:0 lds
buffer_load_dwordx4 v16, s[8:11], s62 offen offset:1024 lds
buffer_load_dwordx4 v17, s[8:11], s62 offen offset:2048 lds
buffer_load_dwordx4 v18, s[8:11], s62 offen offset:3072 lds
s_waitcnt vmcnt(11)
s_barrier
ds_read_b64_tr_b16 a[4:5], v9 offset:0
buffer_load_dword v37, v28, s[32:35], s51 offen sc1
ds_read_b64_tr_b16 a[6:7], v9 offset:1024
s_add_u32 m0, s56, 8192
s_add_u32 s62, s57, 198656
buffer_load_dwordx4 v15, s[8:11], s62 offen offset:0 lds
ds_read_b64_tr_b16 a[0:1], v8 offset:0
ds_read_b64_tr_b16 a[2:3], v8 offset:1024
ds_read_b64_tr_b16 a[12:13], v9 offset:2048
ds_read_b64_tr_b16 a[14:15], v9 offset:3072
ds_read_b64_tr_b16 a[8:9], v8 offset:2048
ds_read_b64_tr_b16 a[10:11], v8 offset:3072
ds_read_b64_tr_b16 a[20:21], v9 offset:4096
buffer_load_dwordx4 v16, s[8:11], s62 offen offset:1024 lds
ds_read_b64_tr_b16 a[22:23], v9 offset:5120
ds_read_b64_tr_b16 a[16:17], v8 offset:4096
ds_read_b64_tr_b16 a[18:19], v8 offset:5120
ds_read_b64_tr_b16 a[28:29], v9 offset:6144
ds_read_b64_tr_b16 a[30:31], v9 offset:7168
ds_read_b64_tr_b16 a[24:25], v8 offset:6144
ds_read_b64_tr_b16 a[26:27], v8 offset:7168
ds_read_b64_tr_b16 a[36:37], v9 offset:8192
buffer_load_dwordx4 v17, s[8:11], s62 offen offset:2048 lds
ds_read_b64_tr_b16 a[38:39], v9 offset:9216
ds_read_b64_tr_b16 a[32:33], v8 offset:8192
ds_read_b64_tr_b16 a[34:35], v8 offset:9216
ds_read_b64_tr_b16 a[44:45], v9 offset:10240
ds_read_b64_tr_b16 a[46:47], v9 offset:11264
ds_read_b64_tr_b16 a[40:41], v8 offset:10240
ds_read_b64_tr_b16 a[42:43], v8 offset:11264
ds_read_b64_tr_b16 a[52:53], v9 offset:12288
buffer_load_dwordx4 v18, s[8:11], s62 offen offset:3072 lds
ds_read_b64_tr_b16 a[54:55], v9 offset:13312
ds_read_b64_tr_b16 a[48:49], v8 offset:12288
ds_read_b64_tr_b16 a[50:51], v8 offset:13312
ds_read_b64_tr_b16 a[60:61], v9 offset:14336
ds_read_b64_tr_b16 a[62:63], v9 offset:15360
ds_read_b64_tr_b16 a[56:57], v8 offset:14336
ds_read_b64_tr_b16 a[58:59], v8 offset:15360
ds_read_b64_tr_b16 a[68:69], v9 offset:16384
s_add_u32 m0, s56, 12288
s_add_u32 s62, s57, 296960
buffer_load_dwordx4 v15, s[8:11], s62 offen offset:0 lds
ds_read_b64_tr_b16 a[70:71], v9 offset:17408
ds_read_b64_tr_b16 a[64:65], v8 offset:16384
ds_read_b64_tr_b16 a[66:67], v8 offset:17408
ds_read_b64_tr_b16 a[76:77], v9 offset:18432
ds_read_b64_tr_b16 a[78:79], v9 offset:19456
ds_read_b64_tr_b16 a[72:73], v8 offset:18432
ds_read_b64_tr_b16 a[74:75], v8 offset:19456
ds_read_b64_tr_b16 a[84:85], v9 offset:20480
buffer_load_dwordx4 v16, s[8:11], s62 offen offset:1024 lds
ds_read_b64_tr_b16 a[86:87], v9 offset:21504
ds_read_b64_tr_b16 a[80:81], v8 offset:20480
ds_read_b64_tr_b16 a[82:83], v8 offset:21504
ds_read_b64_tr_b16 a[92:93], v9 offset:22528
ds_read_b64_tr_b16 a[94:95], v9 offset:23552
ds_read_b64_tr_b16 a[88:89], v8 offset:22528
ds_read_b64_tr_b16 a[90:91], v8 offset:23552
ds_read_b64_tr_b16 a[100:101], v9 offset:24576
buffer_load_dwordx4 v17, s[8:11], s62 offen offset:2048 lds
ds_read_b64_tr_b16 a[102:103], v9 offset:25600
ds_read_b64_tr_b16 a[96:97], v8 offset:24576
ds_read_b64_tr_b16 a[98:99], v8 offset:25600
ds_read_b64_tr_b16 a[108:109], v9 offset:26624
ds_read_b64_tr_b16 a[110:111], v9 offset:27648
ds_read_b64_tr_b16 a[104:105], v8 offset:26624
ds_read_b64_tr_b16 a[106:107], v8 offset:27648
ds_read_b64_tr_b16 a[116:117], v9 offset:28672
buffer_load_dwordx4 v18, s[8:11], s62 offen offset:3072 lds
ds_read_b64_tr_b16 a[118:119], v9 offset:29696
ds_read_b64_tr_b16 a[112:113], v8 offset:28672
ds_read_b64_tr_b16 a[114:115], v8 offset:29696
ds_read_b64_tr_b16 a[124:125], v9 offset:30720
ds_read_b64_tr_b16 a[126:127], v9 offset:31744
ds_read_b64_tr_b16 a[120:121], v8 offset:30720
ds_read_b64_tr_b16 a[122:123], v8 offset:31744
s_add_u32 s63, s52, 16
s_waitcnt vmcnt(8)
v_cmp_gt_u32 vcc, s63, v37
s_cbranch_vccnz L_pl93
L_pd94:
s_add_u32 s64, s50, 4194304
buffer_load_dwordx4 v[72:75], v2, s[32:35], s64 offen offset:0 sc1
buffer_load_dwordx4 v[76:79], v2, s[32:35], s64 offen offset:1024 sc1
buffer_load_dwordx4 v[80:83], v2, s[32:35], s64 offen offset:2048 sc1
buffer_load_dwordx4 v[84:87], v2, s[32:35], s64 offen offset:3072 sc1
buffer_load_dwordx4 v[88:91], v3, s[32:35], s64 offen offset:0 sc1
buffer_load_dwordx4 v[92:95], v3, s[32:35], s64 offen offset:1024 sc1
buffer_load_dwordx4 v[96:99], v3, s[32:35], s64 offen offset:2048 sc1
buffer_load_dwordx4 v[100:103], v3, s[32:35], s64 offen offset:3072 sc1
buffer_load_dwordx4 v[104:107], v4, s[32:35], s64 offen offset:0 sc1
buffer_load_dwordx4 v[108:111], v4, s[32:35], s64 offen offset:1024 sc1
s_waitcnt vmcnt(10)
s_waitcnt lgkmcnt(0)
s_barrier
s_lshl_b32 s63, s97, 2
s_load_dwordx2 s[0:1], s[12:13], s63 offset:444
s_load_dwordx2 s[0:1], s[12:13], s63 offset:1468
s_load_dwordx2 s[0:1], s[12:13], s63 offset:2492
s_load_dwordx2 s[0:1], s[12:13], s63 offset:3516
s_waitcnt vmcnt(9)
v_mfma_f32_32x32x16_bf16 v[152:167], a[4:7], v[72:75], 0
ds_read_b64_tr_b16 a[132:133], v7 offset:0
ds_read_b64_tr_b16 a[134:135], v7 offset:1024
ds_read_b64_tr_b16 a[128:129], v6 offset:0
buffer_load_dwordx4 v[112:115], v4, s[32:35], s64 offen offset:2048 sc1
v_mfma_f32_32x32x16_bf16 v[136:151], a[0:3], v[72:75], 0
ds_read_b64_tr_b16 a[130:131], v6 offset:1024
ds_read_b64_tr_b16 a[140:141], v7 offset:2048
s_waitcnt vmcnt(9)
v_mfma_f32_32x32x16_bf16 v[152:167], a[12:15], v[76:79], v[152:167]
ds_read_b64_tr_b16 a[142:143], v7 offset:3072
ds_read_b64_tr_b16 a[136:137], v6 offset:2048
buffer_load_dwordx4 v[116:119], v4, s[32:35], s64 offen offset:3072 sc1
v_mfma_f32_32x32x16_bf16 v[136:151], a[8:11], v[76:79], v[136:151]
ds_read_b64_tr_b16 a[138:139], v6 offset:3072
ds_read_b64_tr_b16 a[148:149], v7 offset:4096
ds_read_b64_tr_b16 a[150:151], v7 offset:5120
s_waitcnt vmcnt(9)
v_mfma_f32_32x32x16_bf16 v[152:167], a[20:23], v[80:83], v[152:167]
v_bitop3_b32 v248, v72, v76, v80 bitop3:0x7f
ds_read_b64_tr_b16 a[144:145], v6 offset:4096
ds_read_b64_tr_b16 a[146:147], v6 offset:5120
buffer_load_dwordx4 v[120:123], v5, s[32:35], s64 offen offset:0 sc1
v_mfma_f32_32x32x16_bf16 v[136:151], a[16:19], v[80:83], v[136:151]
ds_read_b64_tr_b16 a[156:157], v7 offset:6144
ds_read_b64_tr_b16 a[158:159], v7 offset:7168
s_waitcnt vmcnt(9)
v_mfma_f32_32x32x16_bf16 v[152:167], a[28:31], v[84:87], v[152:167]
ds_read_b64_tr_b16 a[152:153], v6 offset:6144
ds_read_b64_tr_b16 a[154:155], v6 offset:7168
buffer_load_dwordx4 v[124:127], v5, s[32:35], s64 offen offset:1024 sc1
v_mfma_f32_32x32x16_bf16 v[136:151], a[24:27], v[84:87], v[136:151]
ds_read_b64_tr_b16 a[164:165], v7 offset:8192
ds_read_b64_tr_b16 a[166:167], v7 offset:9216
ds_read_b64_tr_b16 a[160:161], v6 offset:8192
s_waitcnt vmcnt(9)
v_mfma_f32_32x32x16_bf16 v[152:167], a[36:39], v[88:91], v[152:167]
v_bitop3_b32 v248, v248, v84, v88 bitop3:0xf7
ds_read_b64_tr_b16 a[162:163], v6 offset:9216
ds_read_b64_tr_b16 a[172:173], v7 offset:10240
buffer_load_dwordx4 v[128:131], v5, s[32:35], s64 offen offset:2048 sc1
v_mfma_f32_32x32x16_bf16 v[136:151], a[32:35], v[88:91], v[136:151]
ds_read_b64_tr_b16 a[174:175], v7 offset:11264
ds_read_b64_tr_b16 a[168:169], v6 offset:10240
s_waitcnt vmcnt(9)
v_mfma_f32_32x32x16_bf16 v[152:167], a[44:47], v[92:95], v[152:167]
ds_read_b64_tr_b16 a[170:171], v6 offset:11264
ds_read_b64_tr_b16 a[180:181], v7 offset:12288
ds_read_b64_tr_b16 a[182:183], v7 offset:13312
buffer_load_dwordx4 v[132:135], v5, s[32:35], s64 offen offset:3072 sc1
v_mfma_f32_32x32x16_bf16 v[136:151], a[40:43], v[92:95], v[136:151]
ds_read_b64_tr_b16 a[176:177], v6 offset:12288
ds_read_b64_tr_b16 a[178:179], v6 offset:13312
s_waitcnt vmcnt(9)
v_mfma_f32_32x32x16_bf16 v[152:167], a[52:55], v[96:99], v[152:167]
v_bitop3_b32 v248, v248, v92, v96 bitop3:0xf7
ds_read_b64_tr_b16 a[188:189], v7 offset:14336
ds_read_b64_tr_b16 a[190:191], v7 offset:15360
s_lshl_b32 s65, s48, 12
s_add_u32 s65, s65, s50
s_add_u32 s65, s65, 14680064
buffer_load_dwordx4 v[232:235], v1, s[32:35], s65 offen offset:0 sc1
v_mfma_f32_32x32x16_bf16 v[136:151], a[48:51], v[96:99], v[136:151]
ds_read_b64_tr_b16 a[184:185], v6 offset:14336
ds_read_b64_tr_b16 a[186:187], v6 offset:15360
s_waitcnt vmcnt(9)
v_mfma_f32_32x32x16_bf16 v[152:167], a[60:63], v[100:103], v[152:167]
ds_read_b64_tr_b16 a[196:197], v7 offset:16384
ds_read_b64_tr_b16 a[198:199], v7 offset:17408
ds_read_b64_tr_b16 a[192:193], v6 offset:16384
buffer_load_dwordx4 v[236:239], v1, s[32:35], s65 offen offset:1024 sc1
v_mfma_f32_32x32x16_bf16 v[136:151], a[56:59], v[100:103], v[136:151]
ds_read_b64_tr_b16 a[194:195], v6 offset:17408
ds_read_b64_tr_b16 a[204:205], v7 offset:18432
s_waitcnt vmcnt(9)
v_mfma_f32_32x32x16_bf16 v[152:167], a[68:71], v[104:107], v[152:167]
v_bitop3_b32 v248, v248, v100, v104 bitop3:0xf7
ds_read_b64_tr_b16 a[206:207], v7 offset:19456
ds_read_b64_tr_b16 a[200:201], v6 offset:18432
buffer_load_dwordx4 v[240:243], v1, s[32:35], s65 offen offset:2048 sc1
v_mfma_f32_32x32x16_bf16 v[136:151], a[64:67], v[104:107], v[136:151]
ds_read_b64_tr_b16 a[202:203], v6 offset:19456
ds_read_b64_tr_b16 a[212:213], v7 offset:20480
ds_read_b64_tr_b16 a[214:215], v7 offset:21504
s_waitcnt vmcnt(9)
v_mfma_f32_32x32x16_bf16 v[152:167], a[76:79], v[108:111], v[152:167]
ds_read_b64_tr_b16 a[208:209], v6 offset:20480
ds_read_b64_tr_b16 a[210:211], v6 offset:21504
buffer_load_dwordx4 v[244:247], v1, s[32:35], s65 offen offset:3072 sc1
v_mfma_f32_32x32x16_bf16 v[136:151], a[72:75], v[108:111], v[136:151]
ds_read_b64_tr_b16 a[220:221], v7 offset:22528
ds_read_b64_tr_b16 a[222:223], v7 offset:23552
s_waitcnt vmcnt(9)
v_mfma_f32_32x32x16_bf16 v[152:167], a[84:87], v[112:115], v[152:167]
v_bitop3_b32 v248, v248, v108, v112 bitop3:0xf7
ds_read_b64_tr_b16 a[216:217], v6 offset:22528
ds_read_b64_tr_b16 a[218:219], v6 offset:23552
v_mfma_f32_32x32x16_bf16 v[136:151], a[80:83], v[112:115], v[136:151]
ds_read_b64_tr_b16 a[228:229], v7 offset:24576
ds_read_b64_tr_b16 a[230:231], v7 offset:25600
ds_read_b64_tr_b16 a[224:225], v6 offset:24576
s_add_u32 m0, s56, 65536
s_add_u32 s62, s57, 0
buffer_load_dwordx4 v15, s[8:11], s62 offen offset:0 lds
s_waitcnt vmcnt(9)
v_mfma_f32_32x32x16_bf16 v[152:167], a[92:95], v[116:119], v[152:167]
ds_read_b64_tr_b16 a[226:227], v6 offset:25600
ds_read_b64_tr_b16 a[236:237], v7 offset:26624
v_mfma_f32_32x32x16_bf16 v[136:151], a[88:91], v[116:119], v[136:151]
ds_read_b64_tr_b16 a[238:239], v7 offset:27648
ds_read_b64_tr_b16 a[232:233], v6 offset:26624
buffer_load_dwordx4 v16, s[8:11], s62 offen offset:1024 lds
s_waitcnt vmcnt(9)
v_mfma_f32_32x32x16_bf16 v[152:167], a[100:103], v[120:123], v[152:167]
v_bitop3_b32 v248, v248, v116, v120 bitop3:0xf7
ds_read_b64_tr_b16 a[234:235], v6 offset:27648
ds_read_b64_tr_b16 a[244:245], v7 offset:28672
ds_read_b64_tr_b16 a[246:247], v7 offset:29696
v_mfma_f32_32x32x16_bf16 v[136:151], a[96:99], v[120:123], v[136:151]
ds_read_b64_tr_b16 a[240:241], v6 offset:28672
ds_read_b64_tr_b16 a[242:243], v6 offset:29696
buffer_load_dwordx4 v17, s[8:11], s62 offen offset:2048 lds
s_waitcnt vmcnt(9)
v_mfma_f32_32x32x16_bf16 v[152:167], a[108:111], v[124:127], v[152:167]
ds_read_b64_tr_b16 a[252:253], v7 offset:30720
ds_read_b64_tr_b16 a[254:255], v7 offset:31744
v_mfma_f32_32x32x16_bf16 v[136:151], a[104:107], v[124:127], v[136:151]
ds_read_b64_tr_b16 a[248:249], v6 offset:30720
ds_read_b64_tr_b16 a[250:251], v6 offset:31744
buffer_load_dwordx4 v18, s[8:11], s62 offen offset:3072 lds
s_waitcnt vmcnt(9)
v_mfma_f32_32x32x16_bf16 v[152:167], a[116:119], v[128:131], v[152:167]
v_bitop3_b32 v248, v248, v124, v128 bitop3:0xf7
v_mfma_f32_32x32x16_bf16 v[136:151], a[112:115], v[128:131], v[136:151]
s_add_u32 m0, s56, 69632
s_add_u32 s62, s57, 98304
buffer_load_dwordx4 v15, s[8:11], s62 offen offset:0 lds
s_waitcnt vmcnt(9)
v_mfma_f32_32x32x16_bf16 v[152:167], a[124:127], v[132:135], v[152:167]
v_bitop3_b32 v248, v248, v132, v132 bitop3:0xf7
v_and_b32 v248, 1, v248
v_cmp_ne_u32 vcc, 0, v248
v_mfma_f32_32x32x16_bf16 v[136:151], a[120:123], v[132:135], v[136:151]
s_cbranch_vccnz L_rt95
L_rb96:
s_nop 6
ds_write_b128 v23, v[152:155] offset:0
ds_write_b128 v23, v[156:159] offset:1024
ds_write_b128 v23, v[160:163] offset:2048
ds_write_b128 v23, v[164:167] offset:3072
buffer_load_dwordx4 v16, s[8:11], s62 offen offset:1024 lds
s_waitcnt vmcnt(9)
v_bitop3_b32 v248, v232, v233, v234 bitop3:0xfe
s_waitcnt vmcnt(8)
v_bitop3_b32 v248, v248, v235, v236 bitop3:0xfe
v_bitop3_b32 v248, v248, v237, v238 bitop3:0xfe
s_waitcnt vmcnt(7)
v_bitop3_b32 v248, v248, v239, v240 bitop3:0xfe
v_bitop3_b32 v248, v248, v241, v242 bitop3:0xfe
s_waitcnt vmcnt(6)
v_bitop3_b32 v248, v248, v243, v244 bitop3:0xfe
v_bitop3_b32 v248, v248, v245, v246 bitop3:0xfe
v_bitop3_b32 v248, v248, v247, v247 bitop3:0xfe
v_and_b32 v248, 1, v248
v_cmp_ne_u32 vcc, 0, v248
s_cbranch_vccnz L_rt97
L_rb98:
v_add_f32 v232, v232, v240
v_add_f32 v233, v233, v241
v_add_f32 v234, v234, v242
v_add_f32 v235, v235, v243
v_add_f32 v236, v236, v244
v_add_f32 v237, v237, v245
v_add_f32 v238, v238, v246
v_add_f32 v239, v239, v247
v_add_f32 v232, v232, v236
v_add_f32 v233, v233, v237
v_add_f32 v234, v234, v238
v_add_f32 v235, v235, v239
v_add_f32 v232, v232, v234
v_add_f32 v233, v233, v235
v_add_f32 v232, v232, v233
v_mul_f32 v232, 0x3b000000, v232
v_mov_b32 v233, v232
s_nop 1
v_permlane32_swap_b32 v232, v233
v_mul_f32 v34, -1.0, v232
v_fmac_f32 v233, v34, v232
v_max_f32 v233, 0, v233
v_add_f32 v232, 0x3727c5ac, v233
v_rsq_f32 v35, v232
s_lshl_b32 s63, s6, 8
s_add_u32 s63, s63, 149504
v_lshl_add_u32 v248, v0, 2, s63
v_cmp_gt_u32 vcc, 32, v0
v_mul_f32 v36, 0x3eb8aa3b, v35
s_nop 0
v_cndmask_b32 v249, v34, v35, vcc
ds_write_b32 v248, v249
buffer_load_dwordx4 v17, s[8:11], s62 offen offset:2048 lds
s_waitcnt lgkmcnt(0)
s_barrier
s_branch L_top
L_out:
v_and_b32 v232, 31, v0
v_lshrrev_b32 v233, 5, v0
v_lshlrev_b32 v232, 10, v232
v_lshl_add_u32 v232, v233, 4, v232
v_permlane32_swap_b32 v248, v250
v_permlane32_swap_b32 v249, v251
v_permlane32_swap_b32 v252, v254
v_permlane32_swap_b32 v253, v255
buffer_store_dwordx4 v[248:251], v232, s[40:43], s69 offen offset:0
buffer_store_dwordx4 v[252:255], v232, s[40:43], s69 offen offset:32
s_waitcnt vmcnt(2)
L_end:
s_endpgm
L_pl4:
buffer_load_dword v37, v29, s[32:35], 0 offen sc1
s_sub_u32 s53, s53, 1
s_cbranch_scc1 L_end
s_waitcnt vmcnt(0)
v_cmp_gt_u32 vcc, s63, v37
s_cbranch_vccnz L_pl4
s_branch L_pd5
L_sp1:
buffer_load_dword v124, v123, s[32:35], s51 offen sc1
s_sub_u32 s53, s53, 1
s_waitcnt vmcnt(0)
s_cbranch_scc0 L_sp2
s_endpgm
L_sc6:
buffer_store_dwordx4 v[252:255], v1, s[32:35], s66 offen offset:0 sc1
s_branch L_sj7
L_sc8:
buffer_store_dword v37, v27, s[32:35], s67 offen sc1
s_branch L_sj9
L_sc10:
buffer_store_dwordx4 v[252:255], v1, s[32:35], s66 offen offset:0 sc1
s_branch L_sj11
L_sc12:
buffer_store_dword v37, v27, s[32:35], s67 offen sc1
s_branch L_sj13
L_rt16:
s_sub_u32 s53, s53, 64
s_cbranch_scc1 L_end
s_add_u32 s64, s50, 6291456
buffer_load_dwordx4 v[72:75], v2, s[32:35], s64 offen offset:0 sc1
buffer_load_dwordx4 v[76:79], v2, s[32:35], s64 offen offset:1024 sc1
buffer_load_dwordx4 v[80:83], v2, s[32:35], s64 offen offset:2048 sc1
buffer_load_dwordx4 v[84:87], v2, s[32:35], s64 offen offset:3072 sc1
buffer_load_dwordx4 v[88:91], v3, s[32:35], s64 offen offset:0 sc1
buffer_load_dwordx4 v[92:95], v3, s[32:35], s64 offen offset:1024 sc1
buffer_load_dwordx4 v[96:99], v3, s[32:35], s64 offen offset:2048 sc1
buffer_load_dwordx4 v[100:103], v3, s[32:35], s64 offen offset:3072 sc1
buffer_load_dwordx4 v[104:107], v4, s[32:35], s64 offen offset:0 sc1
buffer_load_dwordx4 v[108:111], v4, s[32:35], s64 offen offset:1024 sc1
buffer_load_dwordx4 v[112:115], v4, s[32:35], s64 offen offset:2048 sc1
buffer_load_dwordx4 v[116:119], v4, s[32:35], s64 offen offset:3072 sc1
buffer_load_dwordx4 v[120:123], v5, s[32:35], s64 offen offset:0 sc1
buffer_load_dwordx4 v[124:127], v5, s[32:35], s64 offen offset:1024 sc1
buffer_load_dwordx4 v[128:131], v5, s[32:35], s64 offen offset:2048 sc1
buffer_load_dwordx4 v[132:135], v5, s[32:35], s64 offen offset:3072 sc1
s_waitcnt vmcnt(15)
v_mfma_f32_32x32x16_bf16 v[216:231], a[4:7], v[72:75], 0
v_mfma_f32_32x32x16_bf16 v[200:215], a[0:3], v[72:75], 0
s_waitcnt vmcnt(14)
v_mfma_f32_32x32x16_bf16 v[216:231], a[12:15], v[76:79], v[216:231]
v_mfma_f32_32x32x16_bf16 v[200:215], a[8:11], v[76:79], v[200:215]
s_waitcnt vmcnt(13)
v_mfma_f32_32x32x16_bf16 v[216:231], a[20:23], v[80:83], v[216:231]
v_bitop3_b32 v248, v72, v76, v80 bitop3:0xfe
v_mfma_f32_32x32x16_bf16 v[200:215], a[16:19], v[80:83], v[200:215]
s_waitcnt vmcnt(12)
v_mfma_f32_32x32x16_bf16 v[216:231], a[28:31], v[84:87], v[216:231]
v_mfma_f32_32x32x16_bf16 v[200:215], a[24:27], v[84:87], v[200:215]
s_waitcnt vmcnt(11)
v_mfma_f32_32x32x16_bf16 v[216:231], a[36:39], v[88:91], v[216:231]
v_bitop3_b32 v248, v248, v84, v88 bitop3:0xfe
v_mfma_f32_32x32x16_bf16 v[200:215], a[32:35], v[88:91], v[200:215]
s_waitcnt vmcnt(10)
v_mfma_f32_32x32x16_bf16 v[216:231], a[44:47], v[92:95], v[216:231]
v_mfma_f32_32x32x16_bf16 v[200:215], a[40:43], v[92:95], v[200:215]
s_waitcnt vmcnt(9)
v_mfma_f32_32x32x16_bf16 v[216:231], a[52:55], v[96:99], v[216:231]
v_bitop3_b32 v248, v248, v92, v96 bitop3:0xfe
v_mfma_f32_32x32x16_bf16 v[200:215], a[48:51], v[96:99], v[200:215]
s_waitcnt vmcnt(8)
v_mfma_f32_32x32x16_bf16 v[216:231], a[60:63], v[100:103], v[216:231]
v_mfma_f32_32x32x16_bf16 v[200:215], a[56:59], v[100:103], v[200:215]
s_waitcnt vmcnt(7)
v_mfma_f32_32x32x16_bf16 v[216:231], a[68:71], v[104:107], v[216:231]
v_bitop3_b32 v248, v248, v100, v104 bitop3:0xfe
v_mfma_f32_32x32x16_bf16 v[200:215], a[64:67], v[104:107], v[200:215]
s_waitcnt vmcnt(6)
v_mfma_f32_32x32x16_bf16 v[216:231], a[76:79], v[108:111], v[216:231]
v_mfma_f32_32x32x16_bf16 v[200:215], a[72:75], v[108:111], v[200:215]
s_waitcnt vmcnt(5)
v_mfma_f32_32x32x16_bf16 v[216:231], a[84:87], v[112:115], v[216:231]
v_bitop3_b32 v248, v248, v108, v112 bitop3:0xfe
v_mfma_f32_32x32x16_bf16 v[200:215], a[80:83], v[112:115], v[200:215]
s_waitcnt vmcnt(4)
v_mfma_f32_32x32x16_bf16 v[216:231], a[92:95], v[116:119], v[216:231]
v_mfma_f32_32x32x16_bf16 v[200:215], a[88:91], v[116:119], v[200:215]
s_waitcnt vmcnt(3)
v_mfma_f32_32x32x16_bf16 v[216:231], a[100:103], v[120:123], v[216:231]
v_bitop3_b32 v248, v248, v116, v120 bitop3:0xfe
v_mfma_f32_32x32x16_bf16 v[200:215], a[96:99], v[120:123], v[200:215]
s_waitcnt vmcnt(2)
v_mfma_f32_32x32x16_bf16 v[216:231], a[108:111], v[124:127], v[216:231]
v_mfma_f32_32x32x16_bf16 v[200:215], a[104:107], v[124:127], v[200:215]
s_waitcnt vmcnt(1)
v_mfma_f32_32x32x16_bf16 v[216:231], a[116:119], v[128:131], v[216:231]
v_bitop3_b32 v248, v248, v124, v128 bitop3:0xfe
v_mfma_f32_32x32x16_bf16 v[200:215], a[112:115], v[128:131], v[200:215]
s_waitcnt vmcnt(0)
v_mfma_f32_32x32x16_bf16 v[216:231], a[124:127], v[132:135], v[216:231]
v_bitop3_b32 v248, v248, v132, v132 bitop3:0xfe
v_and_b32 v248, 1, v248
v_cmp_ne_u32 vcc, 0, v248
v_mfma_f32_32x32x16_bf16 v[200:215], a[120:123], v[132:135], v[200:215]
s_cbranch_vccnz L_rt16
s_nop 10
s_branch L_rb17
L_sc18:
buffer_store_dword v37, v27, s[32:35], s67 offen sc1
s_branch L_sj19
L_sc20:
buffer_store_dwordx4 v[248:251], v1, s[32:35], s66 offen offset:0 sc1
buffer_store_dwordx4 v[252:255], v1, s[32:35], s66 offen offset:1024 sc1
s_branch L_sj21
L_sc22:
buffer_store_dword v232, v1, s[32:35], s65 offen sc1
s_branch L_sj23
L_rt29:
s_sub_u32 s53, s53, 64
s_cbranch_scc1 L_end
s_add_u32 s64, s50, 4194304
buffer_load_dwordx4 v[72:75], v2, s[32:35], s64 offen offset:0 sc1
buffer_load_dwordx4 v[76:79], v2, s[32:35], s64 offen offset:1024 sc1
buffer_load_dwordx4 v[80:83], v2, s[32:35], s64 offen offset:2048 sc1
buffer_load_dwordx4 v[84:87], v2, s[32:35], s64 offen offset:3072 sc1
buffer_load_dwordx4 v[88:91], v3, s[32:35], s64 offen offset:0 sc1
buffer_load_dwordx4 v[92:95], v3, s[32:35], s64 offen offset:1024 sc1
buffer_load_dwordx4 v[96:99], v3, s[32:35], s64 offen offset:2048 sc1
buffer_load_dwordx4 v[100:103], v3, s[32:35], s64 offen offset:3072 sc1
buffer_load_dwordx4 v[104:107], v4, s[32:35], s64 offen offset:0 sc1
buffer_load_dwordx4 v[108:111], v4, s[32:35], s64 offen offset:1024 sc1
buffer_load_dwordx4 v[112:115], v4, s[32:35], s64 offen offset:2048 sc1
buffer_load_dwordx4 v[116:119], v4, s[32:35], s64 offen offset:3072 sc1
buffer_load_dwordx4 v[120:123], v5, s[32:35], s64 offen offset:0 sc1
buffer_load_dwordx4 v[124:127], v5, s[32:35], s64 offen offset:1024 sc1
buffer_load_dwordx4 v[128:131], v5, s[32:35], s64 offen offset:2048 sc1
buffer_load_dwordx4 v[132:135], v5, s[32:35], s64 offen offset:3072 sc1
s_waitcnt vmcnt(15)
v_mfma_f32_32x32x16_bf16 v[216:231], a[132:135], v[72:75], 0
v_mfma_f32_32x32x16_bf16 v[200:215], a[128:131], v[72:75], 0
s_waitcnt vmcnt(14)
v_mfma_f32_32x32x16_bf16 v[216:231], a[140:143], v[76:79], v[216:231]
v_mfma_f32_32x32x16_bf16 v[200:215], a[136:139], v[76:79], v[200:215]
s_waitcnt vmcnt(13)
v_mfma_f32_32x32x16_bf16 v[216:231], a[148:151], v[80:83], v[216:231]
v_bitop3_b32 v248, v72, v76, v80 bitop3:0xfe
v_mfma_f32_32x32x16_bf16 v[200:215], a[144:147], v[80:83], v[200:215]
s_waitcnt vmcnt(12)
v_mfma_f32_32x32x16_bf16 v[216:231], a[156:159], v[84:87], v[216:231]
v_mfma_f32_32x32x16_bf16 v[200:215], a[152:155], v[84:87], v[200:215]
s_waitcnt vmcnt(11)
v_mfma_f32_32x32x16_bf16 v[216:231], a[164:167], v[88:91], v[216:231]
v_bitop3_b32 v248, v248, v84, v88 bitop3:0xfe
v_mfma_f32_32x32x16_bf16 v[200:215], a[160:163], v[88:91], v[200:215]
s_waitcnt vmcnt(10)
v_mfma_f32_32x32x16_bf16 v[216:231], a[172:175], v[92:95], v[216:231]
v_mfma_f32_32x32x16_bf16 v[200:215], a[168:171], v[92:95], v[200:215]
s_waitcnt vmcnt(9)
v_mfma_f32_32x32x16_bf16 v[216:231], a[180:183], v[96:99], v[216:231]
v_bitop3_b32 v248, v248, v92, v96 bitop3:0xfe
v_mfma_f32_32x32x16_bf16 v[200:215], a[176:179], v[96:99], v[200:215]
s_waitcnt vmcnt(8)
v_mfma_f32_32x32x16_bf16 v[216:231], a[188:191], v[100:103], v[216:231]
v_mfma_f32_32x32x16_bf16 v[200:215], a[184:187], v[100:103], v[200:215]
s_waitcnt vmcnt(7)
v_mfma_f32_32x32x16_bf16 v[216:231], a[196:199], v[104:107], v[216:231]
v_bitop3_b32 v248, v248, v100, v104 bitop3:0xfe
v_mfma_f32_32x32x16_bf16 v[200:215], a[192:195], v[104:107], v[200:215]
s_waitcnt vmcnt(6)
v_mfma_f32_32x32x16_bf16 v[216:231], a[204:207], v[108:111], v[216:231]
v_mfma_f32_32x32x16_bf16 v[200:215], a[200:203], v[108:111], v[200:215]
s_waitcnt vmcnt(5)
v_mfma_f32_32x32x16_bf16 v[216:231], a[212:215], v[112:115], v[216:231]
v_bitop3_b32 v248, v248, v108, v112 bitop3:0xfe
v_mfma_f32_32x32x16_bf16 v[200:215], a[208:211], v[112:115], v[200:215]
s_waitcnt vmcnt(4)
v_mfma_f32_32x32x16_bf16 v[216:231], a[220:223], v[116:119], v[216:231]
v_mfma_f32_32x32x16_bf16 v[200:215], a[216:219], v[116:119], v[200:215]
s_waitcnt vmcnt(3)
v_mfma_f32_32x32x16_bf16 v[216:231], a[228:231], v[120:123], v[216:231]
v_bitop3_b32 v248, v248, v116, v120 bitop3:0xfe
v_mfma_f32_32x32x16_bf16 v[200:215], a[224:227], v[120:123], v[200:215]
s_waitcnt vmcnt(2)
v_mfma_f32_32x32x16_bf16 v[216:231], a[236:239], v[124:127], v[216:231]
v_mfma_f32_32x32x16_bf16 v[200:215], a[232:235], v[124:127], v[200:215]
s_waitcnt vmcnt(1)
v_mfma_f32_32x32x16_bf16 v[216:231], a[244:247], v[128:131], v[216:231]
v_bitop3_b32 v248, v248, v124, v128 bitop3:0xfe
v_mfma_f32_32x32x16_bf16 v[200:215], a[240:243], v[128:131], v[200:215]
s_waitcnt vmcnt(0)
v_mfma_f32_32x32x16_bf16 v[216:231], a[252:255], v[132:135], v[216:231]
v_bitop3_b32 v248, v248, v132, v132 bitop3:0xfe
v_and_b32 v248, 1, v248
v_cmp_ne_u32 vcc, 0, v248
v_mfma_f32_32x32x16_bf16 v[200:215], a[248:251], v[132:135], v[200:215]
s_cbranch_vccnz L_rt29
s_nop 10
s_branch L_rb30
L_rt31:
s_sub_u32 s53, s53, 64
s_cbranch_scc1 L_end
s_lshl_b32 s65, s48, 12
s_add_u32 s65, s65, s50
s_add_u32 s65, s65, 14680064
buffer_load_dwordx4 v[232:235], v1, s[32:35], s65 offen offset:0 sc1
buffer_load_dwordx4 v[236:239], v1, s[32:35], s65 offen offset:1024 sc1
buffer_load_dwordx4 v[240:243], v1, s[32:35], s65 offen offset:2048 sc1
buffer_load_dwordx4 v[244:247], v1, s[32:35], s65 offen offset:3072 sc1
s_waitcnt vmcnt(3)
v_bitop3_b32 v248, v232, v233, s7 bitop3:0x7e
v_bitop3_b32 v248, v248, v234, s7 bitop3:0xf6
v_bitop3_b32 v248, v248, v235, s7 bitop3:0xf6
s_waitcnt vmcnt(2)
v_bitop3_b32 v248, v248, v236, s7 bitop3:0xf6
v_bitop3_b32 v248, v248, v237, s7 bitop3:0xf6
v_bitop3_b32 v248, v248, v238, s7 bitop3:0xf6
v_bitop3_b32 v248, v248, v239, s7 bitop3:0xf6
s_waitcnt vmcnt(1)
v_bitop3_b32 v248, v248, v240, s7 bitop3:0xf6
v_bitop3_b32 v248, v248, v241, s7 bitop3:0xf6
v_bitop3_b32 v248, v248, v242, s7 bitop3:0xf6
v_bitop3_b32 v248, v248, v243, s7 bitop3:0xf6
s_waitcnt vmcnt(0)
v_bitop3_b32 v248, v248, v244, s7 bitop3:0xf6
v_bitop3_b32 v248, v248, v245, s7 bitop3:0xf6
v_bitop3_b32 v248, v248, v246, s7 bitop3:0xf6
v_bitop3_b32 v248, v248, v247, s7 bitop3:0xf6
v_and_b32 v248, 1, v248
v_cmp_ne_u32 vcc, 0, v248
s_cbranch_vccnz L_rt31
s_nop 3
s_branch L_rb32
L_sc33:
buffer_store_dword v37, v27, s[32:35], s67 offen sc1
s_branch L_sj34
L_sc35:
buffer_store_dwordx4 v[248:251], v1, s[32:35], s66 offen offset:0 sc1
buffer_store_dwordx4 v[252:255], v1, s[32:35], s66 offen offset:1024 sc1
s_branch L_sj36
L_rt39:
s_sub_u32 s53, s53, 64
s_cbranch_scc1 L_end
s_add_u32 s63, s52, 64
L_pl41:
buffer_load_dword v37, v30, s[32:35], 0 offen sc1
s_waitcnt vmcnt(0)
v_cmp_gt_u32 vcc, s63, v37
s_cbranch_vccz L_pd42
s_sub_u32 s53, s53, 1
s_cbranch_scc0 L_pl41
s_endpgm
L_pd42:
s_mov_b32 s64, 4096
buffer_load_dwordx4 v[72:75], v31, s[32:35], 0 offen offset:0 sc1
buffer_load_dwordx4 v[76:79], v31, s[32:35], 0 offen offset:1024 sc1
buffer_load_dwordx4 v[80:83], v31, s[32:35], 0 offen offset:2048 sc1
buffer_load_dwordx4 v[84:87], v31, s[32:35], 0 offen offset:3072 sc1
buffer_load_dwordx4 v[88:91], v31, s[32:35], s64 offen offset:0 sc1
buffer_load_dwordx4 v[92:95], v31, s[32:35], s64 offen offset:1024 sc1
buffer_load_dwordx4 v[96:99], v31, s[32:35], s64 offen offset:2048 sc1
buffer_load_dwordx4 v[100:103], v31, s[32:35], s64 offen offset:3072 sc1
buffer_load_dwordx4 v[104:107], v32, s[32:35], 0 offen offset:0 sc1
buffer_load_dwordx4 v[108:111], v32, s[32:35], 0 offen offset:1024 sc1
buffer_load_dwordx4 v[112:115], v32, s[32:35], 0 offen offset:2048 sc1
buffer_load_dwordx4 v[116:119], v32, s[32:35], 0 offen offset:3072 sc1
buffer_load_dwordx4 v[120:123], v32, s[32:35], s64 offen offset:0 sc1
buffer_load_dwordx4 v[124:127], v32, s[32:35], s64 offen offset:1024 sc1
buffer_load_dwordx4 v[128:131], v32, s[32:35], s64 offen offset:2048 sc1
buffer_load_dwordx4 v[132:135], v32, s[32:35], s64 offen offset:3072 sc1
s_waitcnt vmcnt(15)
v_mfma_f32_32x32x16_bf16 v[216:231], a[4:7], v[72:75], 0
v_mfma_f32_32x32x16_bf16 v[200:215], a[0:3], v[72:75], 0
s_waitcnt vmcnt(14)
v_mfma_f32_32x32x16_bf16 v[216:231], a[12:15], v[76:79], v[216:231]
v_mfma_f32_32x32x16_bf16 v[200:215], a[8:11], v[76:79], v[200:215]
s_waitcnt vmcnt(13)
v_mfma_f32_32x32x16_bf16 v[216:231], a[20:23], v[80:83], v[216:231]
v_bitop3_b32 v248, v72, v76, v80 bitop3:0x7f
v_mfma_f32_32x32x16_bf16 v[200:215], a[16:19], v[80:83], v[200:215]
s_waitcnt vmcnt(12)
v_mfma_f32_32x32x16_bf16 v[216:231], a[28:31], v[84:87], v[216:231]
v_mfma_f32_32x32x16_bf16 v[200:215], a[24:27], v[84:87], v[200:215]
s_waitcnt vmcnt(11)
v_mfma_f32_32x32x16_bf16 v[216:231], a[36:39], v[88:91], v[216:231]
v_bitop3_b32 v248, v248, v84, v88 bitop3:0xf7
v_mfma_f32_32x32x16_bf16 v[200:215], a[32:35], v[88:91], v[200:215]
s_waitcnt vmcnt(10)
v_mfma_f32_32x32x16_bf16 v[216:231], a[44:47], v[92:95], v[216:231]
v_mfma_f32_32x32x16_bf16 v[200:215], a[40:43], v[92:95], v[200:215]
s_waitcnt vmcnt(9)
v_mfma_f32_32x32x16_bf16 v[216:231], a[52:55], v[96:99], v[216:231]
v_bitop3_b32 v248, v248, v92, v96 bitop3:0xf7
v_mfma_f32_32x32x16_bf16 v[200:215], a[48:51], v[96:99], v[200:215]
s_waitcnt vmcnt(8)
v_mfma_f32_32x32x16_bf16 v[216:231], a[60:63], v[100:103], v[216:231]
v_bitop3_b32 v248, v248, v100, v100 bitop3:0xf7
v_mfma_f32_32x32x16_bf16 v[200:215], a[56:59], v[100:103], v[200:215]
s_waitcnt vmcnt(7)
v_mfma_f32_32x32x16_bf16 v[216:231], a[68:71], v[104:107], v[216:231]
v_lshrrev_b32 v250, 30, v31
v_bitop3_b32 v248, v248, v250, 1 bitop3:0x20
v_lshrrev_b32 v250, 30, v32
v_mfma_f32_32x32x16_bf16 v[200:215], a[64:67], v[104:107], v[200:215]
s_waitcnt vmcnt(6)
v_mfma_f32_32x32x16_bf16 v[216:231], a[76:79], v[108:111], v[216:231]
v_mfma_f32_32x32x16_bf16 v[200:215], a[72:75], v[108:111], v[200:215]
s_waitcnt vmcnt(5)
v_mfma_f32_32x32x16_bf16 v[216:231], a[84:87], v[112:115], v[216:231]
v_bitop3_b32 v249, v104, v108, v112 bitop3:0x7f
v_mfma_f32_32x32x16_bf16 v[200:215], a[80:83], v[112:115], v[200:215]
s_waitcnt vmcnt(4)
v_mfma_f32_32x32x16_bf16 v[216:231], a[92:95], v[116:119], v[216:231]
v_mfma_f32_32x32x16_bf16 v[200:215], a[88:91], v[116:119], v[200:215]
s_waitcnt vmcnt(3)
v_mfma_f32_32x32x16_bf16 v[216:231], a[100:103], v[120:123], v[216:231]
v_bitop3_b32 v249, v249, v116, v120 bitop3:0xf7
v_mfma_f32_32x32x16_bf16 v[200:215], a[96:99], v[120:123], v[200:215]
s_waitcnt vmcnt(2)
v_mfma_f32_32x32x16_bf16 v[216:231], a[108:111], v[124:127], v[216:231]
v_mfma_f32_32x32x16_bf16 v[200:215], a[104:107], v[124:127], v[200:215]
s_waitcnt vmcnt(1)
v_mfma_f32_32x32x16_bf16 v[216:231], a[116:119], v[128:131], v[216:231]
v_bitop3_b32 v249, v249, v124, v128 bitop3:0xf7
v_mfma_f32_32x32x16_bf16 v[200:215], a[112:115], v[128:131], v[200:215]
s_waitcnt vmcnt(0)
v_mfma_f32_32x32x16_bf16 v[216:231], a[124:127], v[132:135], v[216:231]
v_bitop3_b32 v249, v249, v132, v132 bitop3:0xf7
v_bitop3_b32 v249, v249, v250, 1 bitop3:0x20
v_or_b32 v248, v248, v249
v_cmp_ne_u32 vcc, 0, v248
v_mfma_f32_32x32x16_bf16 v[200:215], a[120:123], v[132:135], v[200:215]
s_cbranch_vccnz L_rt39
s_nop 10
s_branch L_rb40
L_sc43:
buffer_store_dword v37, v27, s[32:35], s67 offen sc1
s_branch L_sj44
L_sc45:
buffer_store_dwordx4 v[248:251], v1, s[32:35], s66 offen offset:0 sc1
buffer_store_dwordx4 v[252:255], v1, s[32:35], s66 offen offset:1024 sc1
s_branch L_sj46
L_sc47:
buffer_store_dword v232, v1, s[32:35], s65 offen sc1
s_branch L_sj48
L_rt53:
s_sub_u32 s53, s53, 64
s_cbranch_scc1 L_end
s_add_u32 s64, s50, 4194304
buffer_load_dwordx4 v[72:75], v2, s[32:35], s64 offen offset:0 sc1
buffer_load_dwordx4 v[76:79], v2, s[32:35], s64 offen offset:1024 sc1
buffer_load_dwordx4 v[80:83], v2, s[32:35], s64 offen offset:2048 sc1
buffer_load_dwordx4 v[84:87], v2, s[32:35], s64 offen offset:3072 sc1
buffer_load_dwordx4 v[88:91], v3, s[32:35], s64 offen offset:0 sc1
buffer_load_dwordx4 v[92:95], v3, s[32:35], s64 offen offset:1024 sc1
buffer_load_dwordx4 v[96:99], v3, s[32:35], s64 offen offset:2048 sc1
buffer_load_dwordx4 v[100:103], v3, s[32:35], s64 offen offset:3072 sc1
buffer_load_dwordx4 v[104:107], v4, s[32:35], s64 offen offset:0 sc1
buffer_load_dwordx4 v[108:111], v4, s[32:35], s64 offen offset:1024 sc1
buffer_load_dwordx4 v[112:115], v4, s[32:35], s64 offen offset:2048 sc1
buffer_load_dwordx4 v[116:119], v4, s[32:35], s64 offen offset:3072 sc1
buffer_load_dwordx4 v[120:123], v5, s[32:35], s64 offen offset:0 sc1
buffer_load_dwordx4 v[124:127], v5, s[32:35], s64 offen offset:1024 sc1
buffer_load_dwordx4 v[128:131], v5, s[32:35], s64 offen offset:2048 sc1
buffer_load_dwordx4 v[132:135], v5, s[32:35], s64 offen offset:3072 sc1
s_waitcnt vmcnt(15)
v_mfma_f32_32x32x16_bf16 v[216:231], a[132:135], v[72:75], 0
v_mfma_f32_32x32x16_bf16 v[200:215], a[128:131], v[72:75], 0
s_waitcnt vmcnt(14)
v_mfma_f32_32x32x16_bf16 v[216:231], a[140:143], v[76:79], v[216:231]
v_mfma_f32_32x32x16_bf16 v[200:215], a[136:139], v[76:79], v[200:215]
s_waitcnt vmcnt(13)
v_mfma_f32_32x32x16_bf16 v[216:231], a[148:151], v[80:83], v[216:231]
v_bitop3_b32 v248, v72, v76, v80 bitop3:0x7f
v_mfma_f32_32x32x16_bf16 v[200:215], a[144:147], v[80:83], v[200:215]
s_waitcnt vmcnt(12)
v_mfma_f32_32x32x16_bf16 v[216:231], a[156:159], v[84:87], v[216:231]
v_mfma_f32_32x32x16_bf16 v[200:215], a[152:155], v[84:87], v[200:215]
s_waitcnt vmcnt(11)
v_mfma_f32_32x32x16_bf16 v[216:231], a[164:167], v[88:91], v[216:231]
v_bitop3_b32 v248, v248, v84, v88 bitop3:0xf7
v_mfma_f32_32x32x16_bf16 v[200:215], a[160:163], v[88:91], v[200:215]
s_waitcnt vmcnt(10)
v_mfma_f32_32x32x16_bf16 v[216:231], a[172:175], v[92:95], v[216:231]
v_mfma_f32_32x32x16_bf16 v[200:215], a[168:171], v[92:95], v[200:215]
s_waitcnt vmcnt(9)
v_mfma_f32_32x32x16_bf16 v[216:231], a[180:183], v[96:99], v[216:231]
v_bitop3_b32 v248, v248, v92, v96 bitop3:0xf7
v_mfma_f32_32x32x16_bf16 v[200:215], a[176:179], v[96:99], v[200:215]
s_waitcnt vmcnt(8)
v_mfma_f32_32x32x16_bf16 v[216:231], a[188:191], v[100:103], v[216:231]
v_mfma_f32_32x32x16_bf16 v[200:215], a[184:187], v[100:103], v[200:215]
s_waitcnt vmcnt(7)
v_mfma_f32_32x32x16_bf16 v[216:231], a[196:199], v[104:107], v[216:231]
v_bitop3_b32 v248, v248, v100, v104 bitop3:0xf7
v_mfma_f32_32x32x16_bf16 v[200:215], a[192:195], v[104:107], v[200:215]
s_waitcnt vmcnt(6)
v_mfma_f32_32x32x16_bf16 v[216:231], a[204:207], v[108:111], v[216:231]
v_mfma_f32_32x32x16_bf16 v[200:215], a[200:203], v[108:111], v[200:215]
s_waitcnt vmcnt(5)
v_mfma_f32_32x32x16_bf16 v[216:231], a[212:215], v[112:115], v[216:231]
v_bitop3_b32 v248, v248, v108, v112 bitop3:0xf7
v_mfma_f32_32x32x16_bf16 v[200:215], a[208:211], v[112:115], v[200:215]
s_waitcnt vmcnt(4)
v_mfma_f32_32x32x16_bf16 v[216:231], a[220:223], v[116:119], v[216:231]
v_mfma_f32_32x32x16_bf16 v[200:215], a[216:219], v[116:119], v[200:215]
s_waitcnt vmcnt(3)
v_mfma_f32_32x32x16_bf16 v[216:231], a[228:231], v[120:123], v[216:231]
v_bitop3_b32 v248, v248, v116, v120 bitop3:0xf7
v_mfma_f32_32x32x16_bf16 v[200:215], a[224:227], v[120:123], v[200:215]
s_waitcnt vmcnt(2)
v_mfma_f32_32x32x16_bf16 v[216:231], a[236:239], v[124:127], v[216:231]
v_mfma_f32_32x32x16_bf16 v[200:215], a[232:235], v[124:127], v[200:215]
s_waitcnt vmcnt(1)
v_mfma_f32_32x32x16_bf16 v[216:231], a[244:247], v[128:131], v[216:231]
v_bitop3_b32 v248, v248, v124, v128 bitop3:0xf7
v_mfma_f32_32x32x16_bf16 v[200:215], a[240:243], v[128:131], v[200:215]
s_waitcnt vmcnt(0)
v_mfma_f32_32x32x16_bf16 v[216:231], a[252:255], v[132:135], v[216:231]
v_bitop3_b32 v248, v248, v132, v132 bitop3:0xf7
v_and_b32 v248, 1, v248
v_cmp_ne_u32 vcc, 0, v248
v_mfma_f32_32x32x16_bf16 v[200:215], a[248:251], v[132:135], v[200:215]
s_cbranch_vccnz L_rt53
s_nop 10
s_branch L_rb54
L_rt55:
s_sub_u32 s53, s53, 64
s_cbranch_scc1 L_end
s_lshl_b32 s65, s48, 12
s_add_u32 s65, s65, s50
s_add_u32 s65, s65, 14680064
buffer_load_dwordx4 v[232:235], v1, s[32:35], s65 offen offset:0 sc1
buffer_load_dwordx4 v[236:239], v1, s[32:35], s65 offen offset:1024 sc1
buffer_load_dwordx4 v[240:243], v1, s[32:35], s65 offen offset:2048 sc1
buffer_load_dwordx4 v[244:247], v1, s[32:35], s65 offen offset:3072 sc1
s_waitcnt vmcnt(3)
v_bitop3_b32 v248, v232, v233, s7 bitop3:0xbd
v_bitop3_b32 v248, v248, v234, s7 bitop3:0xf9
v_bitop3_b32 v248, v248, v235, s7 bitop3:0xf9
s_waitcnt vmcnt(2)
v_bitop3_b32 v248, v248, v236, s7 bitop3:0xf9
v_bitop3_b32 v248, v248, v237, s7 bitop3:0xf9
v_bitop3_b32 v248, v248, v238, s7 bitop3:0xf9
v_bitop3_b32 v248, v248, v239, s7 bitop3:0xf9
s_waitcnt vmcnt(1)
v_bitop3_b32 v248, v248, v240, s7 bitop3:0xf9
v_bitop3_b32 v248, v248, v241, s7 bitop3:0xf9
v_bitop3_b32 v248, v248, v242, s7 bitop3:0xf9
v_bitop3_b32 v248, v248, v243, s7 bitop3:0xf9
s_waitcnt vmcnt(0)
v_bitop3_b32 v248, v248, v244, s7 bitop3:0xf9
v_bitop3_b32 v248, v248, v245, s7 bitop3:0xf9
v_bitop3_b32 v248, v248, v246, s7 bitop3:0xf9
v_bitop3_b32 v248, v248, v247, s7 bitop3:0xf9
v_and_b32 v248, 1, v248
v_cmp_ne_u32 vcc, 0, v248
s_cbranch_vccnz L_rt55
s_nop 3
s_branch L_rb56
L_sc59:
buffer_store_dwordx4 v[248:251], v1, s[32:35], s66 offen offset:0 sc1
buffer_store_dwordx4 v[252:255], v1, s[32:35], s66 offen offset:1024 sc1
s_branch L_sj60
L_sc63:
buffer_store_dwordx4 v[248:251], v1, s[32:35], s66 offen offset:0 sc1
buffer_store_dwordx4 v[252:255], v1, s[32:35], s66 offen offset:1024 sc1
s_branch L_sj64
L_sc67:
buffer_store_dword v37, v27, s[32:35], s67 offen sc1
s_branch L_sj68
L_sc69:
buffer_store_dwordx4 v[248:251], v1, s[32:35], s66 offen offset:0 sc1
buffer_store_dwordx4 v[252:255], v1, s[32:35], s66 offen offset:1024 sc1
s_branch L_sj70
L_pl71:
buffer_load_dword v37, v28, s[32:35], s51 offen sc1
s_sub_u32 s53, s53, 1
s_cbranch_scc1 L_end
s_waitcnt vmcnt(0)
v_cmp_gt_u32 vcc, s63, v37
s_cbranch_vccnz L_pl71
s_branch L_pd72
L_sc73:
buffer_store_dwordx4 v[248:251], v1, s[32:35], s66 offen offset:0 sc1
s_branch L_sj74
L_sc75:
buffer_store_dword v37, v27, s[32:35], s67 offen sc1
s_branch L_sj76
L_pl77:
buffer_load_dword v37, v233, s[32:35], s51 offen sc1
s_sub_u32 s53, s53, 1
s_cbranch_scc1 L_end
s_waitcnt vmcnt(0)
v_cmp_gt_u32 vcc, s63, v37
s_cbranch_vccnz L_pl77
s_branch L_pd78
L_rt79:
s_sub_u32 s53, s53, 64
s_cbranch_scc1 L_end
s_add_u32 s65, s91, 12582912
buffer_load_dwordx4 v[56:59], v2, s[32:35], s65 offen offset:0 sc1
buffer_load_dwordx4 v[60:63], v2, s[32:35], s65 offen offset:1024 sc1
s_waitcnt vmcnt(0)
v_bitop3_b32 v248, v56, v60, s7 bitop3:0x7e
v_and_b32 v248, 1, v248
v_cmp_ne_u32 vcc, 0, v248
s_cbranch_vccnz L_rt79
s_nop 3
s_branch L_rb80
L_rt81:
s_sub_u32 s53, s53, 64
s_cbranch_scc1 L_end
s_add_u32 s65, s91, 12582912
buffer_load_dwordx4 v[64:67], v2, s[32:35], s65 offen offset:2048 sc1
buffer_load_dwordx4 v[68:71], v2, s[32:35], s65 offen offset:3072 sc1
s_waitcnt vmcnt(0)
v_bitop3_b32 v248, v64, v68, s7 bitop3:0x7e
v_and_b32 v248, 1, v248
v_cmp_ne_u32 vcc, 0, v248
s_cbranch_vccnz L_rt81
s_nop 3
s_branch L_rb82
L_sc83:
buffer_store_dwordx4 v[248:251], v1, s[32:35], s66 offen offset:0 sc1
buffer_store_dwordx4 v[252:255], v1, s[32:35], s66 offen offset:1024 sc1
s_branch L_sj84
L_rt85:
s_sub_u32 s53, s53, 64
s_cbranch_scc1 L_end
s_add_u32 s65, s50, s55
s_add_u32 s65, s65, 4194304
buffer_load_dwordx4 v[184:187], v1, s[32:35], s65 offen offset:0 sc1
buffer_load_dwordx4 v[188:191], v1, s[32:35], s65 offen offset:1024 sc1
s_waitcnt vmcnt(0)
v_or_b32 v248, v184, v188
v_and_b32 v248, 1, v248
v_cmp_ne_u32 vcc, 0, v248
s_cbranch_vccnz L_rt85
s_nop 3
s_branch L_rb86
L_sc87:
buffer_store_dword v37, v27, s[32:35], s67 offen sc1
s_branch L_sj88
L_sc89:
buffer_store_dwordx4 v[248:251], v1, s[32:35], s66 offen offset:0 sc1
buffer_store_dwordx4 v[252:255], v1, s[32:35], s66 offen offset:1024 sc1
s_branch L_sj90
L_sc91:
buffer_store_dword v232, v1, s[32:35], s65 offen sc1
s_branch L_sj92
L_pl93:
buffer_load_dword v37, v28, s[32:35], s51 offen sc1
s_sub_u32 s53, s53, 1
s_cbranch_scc1 L_end
s_waitcnt vmcnt(0)
v_cmp_gt_u32 vcc, s63, v37
s_cbranch_vccnz L_pl93
s_branch L_pd94
L_rt95:
s_sub_u32 s53, s53, 64
s_cbranch_scc1 L_end
s_add_u32 s64, s50, 4194304
buffer_load_dwordx4 v[72:75], v2, s[32:35], s64 offen offset:0 sc1
buffer_load_dwordx4 v[76:79], v2, s[32:35], s64 offen offset:1024 sc1
buffer_load_dwordx4 v[80:83], v2, s[32:35], s64 offen offset:2048 sc1
buffer_load_dwordx4 v[84:87], v2, s[32:35], s64 offen offset:3072 sc1
buffer_load_dwordx4 v[88:91], v3, s[32:35], s64 offen offset:0 sc1
buffer_load_dwordx4 v[92:95], v3, s[32:35], s64 offen offset:1024 sc1
buffer_load_dwordx4 v[96:99], v3, s[32:35], s64 offen offset:2048 sc1
buffer_load_dwordx4 v[100:103], v3, s[32:35], s64 offen offset:3072 sc1
buffer_load_dwordx4 v[104:107], v4, s[32:35], s64 offen offset:0 sc1
buffer_load_dwordx4 v[108:111], v4, s[32:35], s64 offen offset:1024 sc1
buffer_load_dwordx4 v[112:115], v4, s[32:35], s64 offen offset:2048 sc1
buffer_load_dwordx4 v[116:119], v4, s[32:35], s64 offen offset:3072 sc1
buffer_load_dwordx4 v[120:123], v5, s[32:35], s64 offen offset:0 sc1
buffer_load_dwordx4 v[124:127], v5, s[32:35], s64 offen offset:1024 sc1
buffer_load_dwordx4 v[128:131], v5, s[32:35], s64 offen offset:2048 sc1
buffer_load_dwordx4 v[132:135], v5, s[32:35], s64 offen offset:3072 sc1
s_waitcnt vmcnt(15)
v_mfma_f32_32x32x16_bf16 v[152:167], a[4:7], v[72:75], 0
v_mfma_f32_32x32x16_bf16 v[136:151], a[0:3], v[72:75], 0
s_waitcnt vmcnt(14)
v_mfma_f32_32x32x16_bf16 v[152:167], a[12:15], v[76:79], v[152:167]
v_mfma_f32_32x32x16_bf16 v[136:151], a[8:11], v[76:79], v[136:151]
s_waitcnt vmcnt(13)
v_mfma_f32_32x32x16_bf16 v[152:167], a[20:23], v[80:83], v[152:167]
v_bitop3_b32 v248, v72, v76, v80 bitop3:0x7f
v_mfma_f32_32x32x16_bf16 v[136:151], a[16:19], v[80:83], v[136:151]
s_waitcnt vmcnt(12)
v_mfma_f32_32x32x16_bf16 v[152:167], a[28:31], v[84:87], v[152:167]
v_mfma_f32_32x32x16_bf16 v[136:151], a[24:27], v[84:87], v[136:151]
s_waitcnt vmcnt(11)
v_mfma_f32_32x32x16_bf16 v[152:167], a[36:39], v[88:91], v[152:167]
v_bitop3_b32 v248, v248, v84, v88 bitop3:0xf7
v_mfma_f32_32x32x16_bf16 v[136:151], a[32:35], v[88:91], v[136:151]
s_waitcnt vmcnt(10)
v_mfma_f32_32x32x16_bf16 v[152:167], a[44:47], v[92:95], v[152:167]
v_mfma_f32_32x32x16_bf16 v[136:151], a[40:43], v[92:95], v[136:151]
s_waitcnt vmcnt(9)
v_mfma_f32_32x32x16_bf16 v[152:167], a[52:55], v[96:99], v[152:167]
v_bitop3_b32 v248, v248, v92, v96 bitop3:0xf7
v_mfma_f32_32x32x16_bf16 v[136:151], a[48:51], v[96:99], v[136:151]
s_waitcnt vmcnt(8)
v_mfma_f32_32x32x16_bf16 v[152:167], a[60:63], v[100:103], v[152:167]
v_mfma_f32_32x32x16_bf16 v[136:151], a[56:59], v[100:103], v[136:151]
s_waitcnt vmcnt(7)
v_mfma_f32_32x32x16_bf16 v[152:167], a[68:71], v[104:107], v[152:167]
v_bitop3_b32 v248, v248, v100, v104 bitop3:0xf7
v_mfma_f32_32x32x16_bf16 v[136:151], a[64:67], v[104:107], v[136:151]
s_waitcnt vmcnt(6)
v_mfma_f32_32x32x16_bf16 v[152:167], a[76:79], v[108:111], v[152:167]
v_mfma_f32_32x32x16_bf16 v[136:151], a[72:75], v[108:111], v[136:151]
s_waitcnt vmcnt(5)
v_mfma_f32_32x32x16_bf16 v[152:167], a[84:87], v[112:115], v[152:167]
v_bitop3_b32 v248, v248, v108, v112 bitop3:0xf7
v_mfma_f32_32x32x16_bf16 v[136:151], a[80:83], v[112:115], v[136:151]
s_waitcnt vmcnt(4)
v_mfma_f32_32x32x16_bf16 v[152:167], a[92:95], v[116:119], v[152:167]
v_mfma_f32_32x32x16_bf16 v[136:151], a[88:91], v[116:119], v[136:151]
s_waitcnt vmcnt(3)
v_mfma_f32_32x32x16_bf16 v[152:167], a[100:103], v[120:123], v[152:167]
v_bitop3_b32 v248, v248, v116, v120 bitop3:0xf7
v_mfma_f32_32x32x16_bf16 v[136:151], a[96:99], v[120:123], v[136:151]
s_waitcnt vmcnt(2)
v_mfma_f32_32x32x16_bf16 v[152:167], a[108:111], v[124:127], v[152:167]
v_mfma_f32_32x32x16_bf16 v[136:151], a[104:107], v[124:127], v[136:151]
s_waitcnt vmcnt(1)
v_mfma_f32_32x32x16_bf16 v[152:167], a[116:119], v[128:131], v[152:167]
v_bitop3_b32 v248, v248, v124, v128 bitop3:0xf7
v_mfma_f32_32x32x16_bf16 v[136:151], a[112:115], v[128:131], v[136:151]
s_waitcnt vmcnt(0)
v_mfma_f32_32x32x16_bf16 v[152:167], a[124:127], v[132:135], v[152:167]
v_bitop3_b32 v248, v248, v132, v132 bitop3:0xf7
v_and_b32 v248, 1, v248
v_cmp_ne_u32 vcc, 0, v248
v_mfma_f32_32x32x16_bf16 v[136:151], a[120:123], v[132:135], v[136:151]
s_cbranch_vccnz L_rt95
s_nop 10
s_branch L_rb96
L_rt97:
s_sub_u32 s53, s53, 64
s_cbranch_scc1 L_end
s_lshl_b32 s65, s48, 12
s_add_u32 s65, s65, s50
s_add_u32 s65, s65, 14680064
buffer_load_dwordx4 v[232:235], v1, s[32:35], s65 offen offset:0 sc1
buffer_load_dwordx4 v[236:239], v1, s[32:35], s65 offen offset:1024 sc1
buffer_load_dwordx4 v[240:243], v1, s[32:35], s65 offen offset:2048 sc1
buffer_load_dwordx4 v[244:247], v1, s[32:35], s65 offen offset:3072 sc1
s_waitcnt vmcnt(3)
v_bitop3_b32 v248, v232, v233, v234 bitop3:0xfe
s_waitcnt vmcnt(2)
v_bitop3_b32 v248, v248, v235, v236 bitop3:0xfe
v_bitop3_b32 v248, v248, v237, v238 bitop3:0xfe
s_waitcnt vmcnt(1)
v_bitop3_b32 v248, v248, v239, v240 bitop3:0xfe
v_bitop3_b32 v248, v248, v241, v242 bitop3:0xfe
s_waitcnt vmcnt(0)
v_bitop3_b32 v248, v248, v243, v244 bitop3:0xfe
v_bitop3_b32 v248, v248, v245, v246 bitop3:0xfe
v_bitop3_b32 v248, v248, v247, v247 bitop3:0xfe
v_and_b32 v248, 1, v248
v_cmp_ne_u32 vcc, 0, v248
s_cbranch_vccnz L_rt97
s_nop 3
s_branch L_rb98
L_code_end:
.section .rodata,"a"
.p2align 6
.amdhsa_kernel interleave_layers__sliding_block__mixer_s_mlp__prompt_kernel
  .amdhsa_next_free_vgpr 512
  .amdhsa_next_free_sgpr 102
  .amdhsa_accum_offset 256
  .amdhsa_group_segment_fixed_size 0
  .amdhsa_kernarg_size 88
  .amdhsa_user_sgpr_count 2
  .amdhsa_user_sgpr_kernarg_segment_ptr 1
  .amdhsa_system_sgpr_workgroup_id_x 1
.end_amdhsa_kernel
```
